```python
import torch

def _softmax(x, axis=-1):
    return torch.softmax(x, dim=axis)

def _gelu(x):
    return torch.nn.functional.gelu(x, approximate='tanh')

def _silu(x):
    return torch.nn.functional.silu(x)

def _sigmoid(x):
    return torch.sigmoid(x)

def _layernorm(x, axis=-1, eps=1e-05):
    m = x.mean(dim=axis, keepdim=True)
    v = x.var(dim=axis, keepdim=True, unbiased=False)
    return (x - m) / torch.sqrt(v + eps)

def _scatter_add(tgt, idx, src, axis=0):
    return tgt.clone().index_add_(axis, idx, src)

def _segment_sum(src, seg, n):
    out = torch.zeros((n,) + src.shape[1:], dtype=src.dtype)
    return out.index_add_(0, seg, src)

def _pad(x, pw):
    flat = tuple((v for pair in reversed(pw) for v in pair))
    return torch.nn.functional.pad(x, flat)
kernel_name = 'gated_mix__memory_aug_recurrent_mem_tr__ssm_conv_s5__prompt'

def setup_inputs():

    _w = lambda a: (lambda t: t.to(torch.bfloat16) if t.is_floating_point() else t)(torch.as_tensor(a))

    def _A_setup():
        B, S, Dm = (1, 2048, 640)
        H, Dh = (32, 192)
        M, seg = (8, 32)
        seg = min(seg, S)
        S = S // seg * seg
        return {'x': _w((lambda *s: torch.randn(*s, dtype=torch.bfloat16) * 0.05)(B, S, Dm)), 'mem0': _w((lambda *s: torch.randn(*s, dtype=torch.bfloat16) * 0.8)(B, M, Dm)), 'Wq': _w((lambda *s: torch.randn(*s, dtype=torch.bfloat16) * 1.6)(Dm, H, Dh) * Dm ** (-0.5)), 'Wk': _w((lambda *s: torch.randn(*s, dtype=torch.bfloat16) * 1.6)(Dm, H, Dh) * Dm ** (-0.5)), 'Wv': _w((lambda *s: torch.randn(*s, dtype=torch.bfloat16) * 0.8)(Dm, H, Dh) * Dm ** (-0.5)), 'Wo': _w((lambda *s: torch.randn(*s, dtype=torch.bfloat16) * 0.8)(H, Dh, Dm) * (H * Dh) ** (-0.5)), 'seg_len': seg}
    _A_in = _A_setup()

    def _B_setup():
        B, S, D = (1, 2048, 640)
        P = D
        Lambda_re = -0.5 * (lambda _x: torch.exp(torch.as_tensor(_x)))((lambda *s: torch.randn(*s, dtype=torch.bfloat16) * 0.8)(P))
        Lambda_im = (lambda *s: torch.randn(*s, dtype=torch.bfloat16) * 0.8)(P) * 1.0
        B_re = (lambda *s: torch.randn(*s, dtype=torch.bfloat16) * 0.8)(P, D) * D ** (-0.5)
        B_im = (lambda *s: torch.randn(*s, dtype=torch.bfloat16) * 0.8)(P, D) * D ** (-0.5)
        C_re = (lambda *s: torch.randn(*s, dtype=torch.bfloat16) * 0.8)(D, P) * P ** (-0.5)
        C_im = (lambda *s: torch.randn(*s, dtype=torch.bfloat16) * 0.8)(D, P) * P ** (-0.5)
        log_dt = (lambda *s: torch.randn(*s, dtype=torch.bfloat16) * 0.8)(P) * 0.3 - 2.0
        Dskip = (lambda *s: torch.randn(*s, dtype=torch.bfloat16) * 0.8)(D)
        return {'x': _w((lambda *s: torch.randn(*s, dtype=torch.bfloat16) * 0.05)(B, S, D)), 'Lambda_re': _w(Lambda_re), 'Lambda_im': _w(Lambda_im), 'B_re': _w(B_re), 'B_im': _w(B_im), 'C_re': _w(C_re), 'C_im': _w(C_im), 'log_dt': _w(log_dt), 'Dskip': _w(Dskip)}
    _B_in = _B_setup()
    return {'A_x': _A_in['x'], 'A_mem0': _A_in['mem0'], 'A_Wq': _A_in['Wq'], 'A_Wk': _A_in['Wk'], 'A_Wv': _A_in['Wv'], 'A_Wo': _A_in['Wo'], 'A_seg_len': _A_in['seg_len'], 'B_x': _B_in['x'], 'B_Lambda_re': _B_in['Lambda_re'], 'B_Lambda_im': _B_in['Lambda_im'], 'B_B_re': _B_in['B_re'], 'B_B_im': _B_in['B_im'], 'B_C_re': _B_in['C_re'], 'B_C_im': _B_in['C_im'], 'B_log_dt': _B_in['log_dt'], 'B_Dskip': _B_in['Dskip'], 'gate_w': _w((lambda *s: torch.randn(*s, dtype=torch.bfloat16) * 0.05)(640) * 16.0)}

def reference(A_x, A_mem0, A_Wq, A_Wk, A_Wv, A_Wo, A_seg_len, B_x, B_Lambda_re, B_Lambda_im, B_B_re, B_B_im, B_C_re, B_C_im, B_log_dt, B_Dskip, gate_w):

    def _A_ref(x, mem0, Wq, Wk, Wv, Wo, seg_len):
        B, S, Dm = x.shape
        H, Dh = (Wq.shape[1], Wq.shape[2])
        M = mem0.shape[1]
        scale = Dh ** (-0.5)
        n_seg = S // seg_len
        L = M + seg_len
        idx = torch.arange(L)
        mask = (idx[:, None] < M) | (idx[:, None] >= idx[None, :])
        mem = mem0
        outs = []
        for s in range(n_seg):
            xs = x[:, s * seg_len:(s + 1) * seg_len, :].clone()
            h = torch.concatenate([mem, xs], axis=1)
            q = torch.einsum('btd,dhe->bhte', h, Wq)
            k = torch.einsum('btd,dhe->bhte', h, Wk)
            v = torch.einsum('btd,dhe->bhte', h, Wv)
            scores = torch.einsum('bhqe,bhke->bhqk', q, k) * scale
            scores = torch.where(mask[None, None], scores, -1000000000.0)
            p = _softmax(scores, axis=-1)
            o = torch.einsum('bhqk,bhke->bhqe', p, v)
            o = torch.einsum('bhte,hed->btd', o, Wo)
            mem = o[:, :M, :].clone()
            outs.append(o[:, M:, :])
        return torch.concatenate(outs, axis=1)

    def _B_ref(x, Lambda_re, Lambda_im, B_re, B_im, C_re, C_im, log_dt, Dskip):
        Bsz, L, H = x.shape
        Lam = Lambda_re + 1j * Lambda_im
        Bmat = B_re + 1j * B_im
        Cmat = C_re + 1j * C_im
        dt = torch.exp(log_dt)
        Lam_bar = torch.exp(dt * Lam)
        B_bar = ((Lam_bar - 1.0) / Lam)[:, None] * Bmat
        Bu = torch.einsum('bld,pd->blp', x + 0j, B_bar)
        h = torch.zeros_like(Bu[:, 0, :])
        hs = []
        for t in range(L):
            h = Lam_bar[None, :] * h + Bu[:, t, :]
            hs.append(h)
        hseq = torch.stack(hs, 1)
        y = 2.0 * torch.einsum('blp,dp->bld', hseq, Cmat).real + x * Dskip[None, None, :]
        return y
    x = A_x
    g = _sigmoid((x * gate_w).sum(-1, keepdims=True))
    a = _A_ref(x, A_mem0, A_Wq, A_Wk, A_Wv, A_Wo, A_seg_len)
    b = _B_ref(x, B_Lambda_re, B_Lambda_im, B_B_re, B_B_im, B_C_re, B_C_im, B_log_dt, B_Dskip)
    return g * a + (1 - g) * b
```

```asm
; @launch grid=(256,1,1) block=(256,1,1) lds=163840
.amdgcn_target "amdgcn-amd-amdhsa--gfx950"
.text
.globl gated_mix__memory_aug_recurrent_mem_tr__ssm_conv_s5__prompt_kernel
.p2align 8
.type gated_mix__memory_aug_recurrent_mem_tr__ssm_conv_s5__prompt_kernel,@function
gated_mix__memory_aug_recurrent_mem_tr__ssm_conv_s5__prompt_kernel:
    s_cmp_ge_u32 s2, 256
    s_cbranch_scc1 L_exit
    s_load_dwordx16 s[32:47], s[0:1], 0
    s_load_dwordx16 s[48:63], s[0:1], 64
    s_load_dwordx8 s[64:71], s[0:1], 128
    s_getreg_b32 s3, hwreg(HW_REG_XCC_ID, 0, 3)
    s_sub_u32 s3, s3, s2
    s_and_b32 s3, s3, 7
    s_add_u32 s3, s3, 1
    v_lshrrev_b32 v5, 6, v0
    v_and_b32 v1, 63, v0
    v_and_b32 v2, 15, v0
    v_readfirstlane_b32 s24, v5
    v_lshrrev_b32 v3, 4, v1
    v_lshlrev_b32 v4, 4, v1
    s_mov_b32 s27, 0x100000
L_slot:
    s_getpc_b64 s[28:29]
L_pc:
    s_add_u32 s28, s28, L_tab-L_pc
    s_addc_u32 s29, s29, 0
    s_add_u32 s30, s2, s3
    s_sub_u32 s30, s30, 1
    s_and_b32 s30, s30, 7
    s_and_b32 s31, s2, 0xf8
    s_or_b32 s30, s30, s31
    s_lshl_b32 s30, s30, 2
    s_load_dword s72, s[28:29], s30
    s_mov_b32 s26, 0
    s_waitcnt lgkmcnt(0)
    s_mov_b32 s4, s70
    s_mov_b32 s5, s71
    s_mov_b32 s6, 0x10000000
    s_mov_b32 s7, 0x20000
    s_mov_b32 s8, s32
    s_mov_b32 s9, s33
    s_mov_b32 s10, 0x280000
    s_mov_b32 s11, 0x20000
    s_mov_b32 s20, s68
    s_mov_b32 s21, s69
    s_mov_b32 s22, 0x100
    s_mov_b32 s23, 0x20000
    s_or_b32 s28, s2, s24
    s_cbranch_scc1 L_npub
    v_mov_b32 v5, 0
    v_mov_b32 v6, s3
    s_mov_b64 exec, 1
    buffer_store_dword v6, v5, s[20:23], 0 offen offset:144 sc1
    s_mov_b64 exec, -1
L_npub:
    s_lshr_b32 s73, s72, 16
    s_bfe_u32 s25, s72, 0x80008
    s_and_b32 s72, s72, 0xff
    s_cmp_ge_u32 s73, 224
    s_cbranch_scc1 L_dispatch
    s_cmp_ge_u32 s73, 160
    s_cbranch_scc1 L_repack
    s_mov_b32 s12, s40
    s_mov_b32 s13, s41
    s_mov_b32 s14, 0x780000
    s_mov_b32 s15, 0x20000
    s_mov_b32 s16, s42
    s_mov_b32 s17, s43
    s_mov_b32 s18, 0x780000
    s_mov_b32 s19, 0x20000
    s_mul_i32 s74, s73, 52429
    s_lshr_b32 s74, s74, 18
    s_mul_i32 s29, s74, 5
    s_sub_u32 s75, s73, s29
    s_lshr_b32 s28, s24, 1
    s_lshl_b32 s28, s28, 2
    v_add_u32 v5, s28, v3
    v_lshlrev_b32 v5, 1, v5
    v_xor_b32 v5, v5, v2
    v_mul_u32_u24 v30, 1280, v3
    v_lshl_add_u32 v30, v5, 4, v30
    s_mul_i32 s76, s74, 245760
    s_lshl_b32 s28, s75, 8
    s_add_u32 s76, s76, s28
    s_mul_i32 s28, s24, 5120
    s_add_u32 s76, s76, s28
    s_lshl_b32 m0, s24, 10
    s_nop 0
    buffer_load_dwordx4 v30, s[16:19], s76 offen lds
    s_add_u32 m0, m0, 4096
    s_add_u32 s76, s76, 20480
    buffer_load_dwordx4 v30, s[16:19], s76 offen lds
    s_add_u32 m0, m0, 4096
    s_add_u32 s76, s76, 20480
    buffer_load_dwordx4 v30, s[16:19], s76 offen lds
    s_add_u32 m0, m0, 4096
    s_add_u32 s76, s76, 20480
    buffer_load_dwordx4 v30, s[16:19], s76 offen lds
    s_add_u32 m0, m0, 4096
    s_add_u32 s76, s76, 20480
    buffer_load_dwordx4 v30, s[16:19], s76 offen lds
    s_add_u32 m0, m0, 4096
    s_add_u32 s76, s76, 20480
    buffer_load_dwordx4 v30, s[16:19], s76 offen lds
    s_add_u32 m0, m0, 4096
    s_add_u32 s76, s76, 20480
    buffer_load_dwordx4 v30, s[16:19], s76 offen lds
    s_add_u32 m0, m0, 4096
    s_add_u32 s76, s76, 20480
    buffer_load_dwordx4 v30, s[16:19], s76 offen lds
    s_add_u32 m0, m0, 4096
    s_add_u32 s76, s76, 20480
    buffer_load_dwordx4 v30, s[16:19], s76 offen lds
    s_add_u32 m0, m0, 4096
    s_add_u32 s76, s76, 20480
    buffer_load_dwordx4 v30, s[16:19], s76 offen lds
    s_add_u32 m0, m0, 4096
    s_add_u32 s76, s76, 20480
    buffer_load_dwordx4 v30, s[16:19], s76 offen lds
    s_add_u32 m0, m0, 4096
    s_add_u32 s76, s76, 20480
    buffer_load_dwordx4 v30, s[16:19], s76 offen lds
    v_lshrrev_b32 v5, 3, v1
    v_mul_u32_u24 v5, 12288, v5
    v_and_b32 v6, 1, v3
    v_and_b32 v7, 7, v1
    v_xor_b32 v6, v6, v7
    v_xor_b32 v7, 0, v6
    v_lshl_add_u32 v24, v7, 4, v5
    v_xor_b32 v7, 2, v6
    v_lshl_add_u32 v25, v7, 4, v5
    v_add_u32 v25, 98304, v25
    v_xor_b32 v7, 4, v6
    v_lshl_add_u32 v26, v7, 4, v5
    v_add_u32 v26, 196608, v26
    v_xor_b32 v7, 6, v6
    v_lshl_add_u32 v27, v7, 4, v5
    v_add_u32 v27, 294912, v27
    s_add_u32 s79, s75, 0
    s_cmp_ge_u32 s79, 5
    s_cselect_b32 s28, 5, 0
    s_sub_u32 s79, s79, s28
    s_add_u32 s80, s75, 1
    s_cmp_ge_u32 s80, 5
    s_cselect_b32 s28, 5, 0
    s_sub_u32 s80, s80, s28
    s_add_u32 s81, s75, 2
    s_cmp_ge_u32 s81, 5
    s_cselect_b32 s28, 5, 0
    s_sub_u32 s81, s81, s28
    s_add_u32 s82, s75, 3
    s_cmp_ge_u32 s82, 5
    s_cselect_b32 s28, 5, 0
    s_sub_u32 s82, s82, s28
    s_add_u32 s83, s75, 4
    s_cmp_ge_u32 s83, 5
    s_cselect_b32 s28, 5, 0
    s_sub_u32 s83, s83, s28
    s_mul_i32 s76, s24, 1966080
    s_mul_i32 s28, s74, 384
    s_add_u32 s76, s76, s28
    s_mul_i32 s78, s24, 24576
    s_add_u32 s78, s78, 49152
    s_mul_i32 s84, s24, 12288
    s_mul_i32 s29, s79, 393216
    s_add_u32 s29, s29, s76
    s_add_u32 m0, s78, 0
    s_nop 0
    buffer_load_dwordx4 v24, s[12:15], s29 offen offset:0 lds
    s_add_u32 m0, s78, 896
    s_nop 0
    buffer_load_dwordx4 v24, s[12:15], s29 offen offset:128 lds
    s_add_u32 m0, s78, 1792
    s_nop 0
    buffer_load_dwordx4 v24, s[12:15], s29 offen offset:256 lds
    s_add_u32 m0, s78, 3072
    s_nop 0
    buffer_load_dwordx4 v25, s[12:15], s29 offen offset:0 lds
    s_add_u32 m0, s78, 3968
    s_nop 0
    buffer_load_dwordx4 v25, s[12:15], s29 offen offset:128 lds
    s_add_u32 m0, s78, 4864
    s_nop 0
    buffer_load_dwordx4 v25, s[12:15], s29 offen offset:256 lds
    s_add_u32 m0, s78, 6144
    s_nop 0
    buffer_load_dwordx4 v26, s[12:15], s29 offen offset:0 lds
    s_add_u32 m0, s78, 7040
    s_nop 0
    buffer_load_dwordx4 v26, s[12:15], s29 offen offset:128 lds
    s_add_u32 m0, s78, 7936
    s_nop 0
    buffer_load_dwordx4 v26, s[12:15], s29 offen offset:256 lds
    s_add_u32 m0, s78, 9216
    s_nop 0
    buffer_load_dwordx4 v27, s[12:15], s29 offen offset:0 lds
    s_add_u32 m0, s78, 10112
    s_nop 0
    buffer_load_dwordx4 v27, s[12:15], s29 offen offset:128 lds
    s_add_u32 m0, s78, 11008
    s_nop 0
    buffer_load_dwordx4 v27, s[12:15], s29 offen offset:256 lds
    v_lshrrev_b32 v5, 2, v2
    v_and_b32 v6, 1, v3
    v_lshl_add_u32 v6, v6, 2, v5
    v_lshl_add_u32 v5, v3, 3, v5
    v_lshlrev_b32 v5, 8, v5
    v_and_b32 v7, 3, v2
    v_lshl_add_u32 v5, v7, 3, v5
    v_xor_b32 v7, 0, v6
    v_lshl_add_u32 v16, v7, 5, v5
    v_xor_b32 v7, 1, v6
    v_lshl_add_u32 v17, v7, 5, v5
    v_xor_b32 v7, 2, v6
    v_lshl_add_u32 v18, v7, 5, v5
    v_xor_b32 v7, 3, v6
    v_lshl_add_u32 v19, v7, 5, v5
    v_xor_b32 v7, 4, v6
    v_lshl_add_u32 v20, v7, 5, v5
    v_xor_b32 v7, 5, v6
    v_lshl_add_u32 v21, v7, 5, v5
    v_xor_b32 v7, 6, v6
    v_lshl_add_u32 v22, v7, 5, v5
    v_xor_b32 v7, 7, v6
    v_lshl_add_u32 v23, v7, 5, v5
    v_lshrrev_b32 v5, 1, v2
    v_xor_b32 v5, v5, v3
    v_lshlrev_b32 v5, 4, v5
    v_and_b32 v7, 3, v2
    v_lshl_add_u32 v5, v7, 7, v5
    v_lshrrev_b32 v7, 2, v2
    v_mul_u32_u24 v7, 3072, v7
    v_add_u32 v5, v5, v7
    v_xor_b32 v29, 64, v5
    v_add_u32 v224, s84, v5
    v_add_u32 v225, s84, v29
    v_add_u32 v28, s78, v5
    v_add_u32 v29, s78, v29
    v_lshrrev_b32 v5, 3, v2
    v_mul_u32_u24 v31, 327680, v5
    v_lshl_add_u32 v31, v3, 8, v31
    v_and_b32 v5, 7, v2
    v_lshl_add_u32 v31, v5, 4, v31
    s_mul_i32 s77, s75, 5242880
    s_lshr_b32 s28, s74, 1
    s_mul_i32 s28, s28, 20480
    s_add_u32 s77, s77, s28
    s_and_b32 s28, s74, 1
    s_lshl_b32 s28, s28, 7
    s_add_u32 s77, s77, s28
    s_mul_i32 s28, s24, 5120
    s_add_u32 s77, s77, s28
    s_add_u32 s77, s77, 0x1000000
    v_mov_b32 v5, 0
    buffer_load_dword v255, v5, s[20:23], 0 offen offset:144 sc1
    s_waitcnt vmcnt(13)
    s_barrier
    ds_read_b64_tr_b16 a[0:1], v16 offset:0
    ds_read_b64_tr_b16 a[2:3], v16 offset:1024
    ds_read_b64_tr_b16 a[4:5], v16 offset:8192
    ds_read_b64_tr_b16 a[6:7], v16 offset:9216
    ds_read_b64_tr_b16 a[8:9], v16 offset:16384
    ds_read_b64_tr_b16 a[10:11], v16 offset:17408
    ds_read_b64_tr_b16 a[12:13], v16 offset:24576
    ds_read_b64_tr_b16 a[14:15], v16 offset:25600
    ds_read_b64_tr_b16 a[16:17], v16 offset:32768
    ds_read_b64_tr_b16 a[18:19], v16 offset:33792
    ds_read_b64_tr_b16 a[20:21], v16 offset:40960
    ds_read_b64_tr_b16 a[22:23], v16 offset:41984
    s_waitcnt lgkmcnt(2)
    ds_read_b64_tr_b16 a[24:25], v17 offset:0
    ds_read_b64_tr_b16 a[26:27], v17 offset:1024
    ds_read_b64_tr_b16 a[28:29], v17 offset:8192
    ds_read_b64_tr_b16 a[30:31], v17 offset:9216
    ds_read_b64_tr_b16 a[32:33], v17 offset:16384
    ds_read_b64_tr_b16 a[34:35], v17 offset:17408
    ds_read_b64_tr_b16 a[36:37], v17 offset:24576
    ds_read_b64_tr_b16 a[38:39], v17 offset:25600
    ds_read_b64_tr_b16 a[40:41], v17 offset:32768
    ds_read_b64_tr_b16 a[42:43], v17 offset:33792
    ds_read_b64_tr_b16 a[44:45], v17 offset:40960
    ds_read_b64_tr_b16 a[46:47], v17 offset:41984
    s_waitcnt lgkmcnt(2)
    ds_read_b64_tr_b16 a[48:49], v18 offset:0
    ds_read_b64_tr_b16 a[50:51], v18 offset:1024
    ds_read_b64_tr_b16 a[52:53], v18 offset:8192
    ds_read_b64_tr_b16 a[54:55], v18 offset:9216
    ds_read_b64_tr_b16 a[56:57], v18 offset:16384
    ds_read_b64_tr_b16 a[58:59], v18 offset:17408
    ds_read_b64_tr_b16 a[60:61], v18 offset:24576
    ds_read_b64_tr_b16 a[62:63], v18 offset:25600
    ds_read_b64_tr_b16 a[64:65], v18 offset:32768
    ds_read_b64_tr_b16 a[66:67], v18 offset:33792
    ds_read_b64_tr_b16 a[68:69], v18 offset:40960
    ds_read_b64_tr_b16 a[70:71], v18 offset:41984
    s_waitcnt lgkmcnt(2)
    ds_read_b64_tr_b16 a[72:73], v19 offset:0
    ds_read_b64_tr_b16 a[74:75], v19 offset:1024
    ds_read_b64_tr_b16 a[76:77], v19 offset:8192
    ds_read_b64_tr_b16 a[78:79], v19 offset:9216
    ds_read_b64_tr_b16 a[80:81], v19 offset:16384
    ds_read_b64_tr_b16 a[82:83], v19 offset:17408
    ds_read_b64_tr_b16 a[84:85], v19 offset:24576
    ds_read_b64_tr_b16 a[86:87], v19 offset:25600
    ds_read_b64_tr_b16 a[88:89], v19 offset:32768
    ds_read_b64_tr_b16 a[90:91], v19 offset:33792
    ds_read_b64_tr_b16 a[92:93], v19 offset:40960
    ds_read_b64_tr_b16 a[94:95], v19 offset:41984
    s_waitcnt lgkmcnt(2)
    ds_read_b64_tr_b16 a[96:97], v20 offset:0
    ds_read_b64_tr_b16 a[98:99], v20 offset:1024
    ds_read_b64_tr_b16 a[100:101], v20 offset:8192
    ds_read_b64_tr_b16 a[102:103], v20 offset:9216
    ds_read_b64_tr_b16 a[104:105], v20 offset:16384
    ds_read_b64_tr_b16 a[106:107], v20 offset:17408
    ds_read_b64_tr_b16 a[108:109], v20 offset:24576
    ds_read_b64_tr_b16 a[110:111], v20 offset:25600
    ds_read_b64_tr_b16 a[112:113], v20 offset:32768
    ds_read_b64_tr_b16 a[114:115], v20 offset:33792
    ds_read_b64_tr_b16 a[116:117], v20 offset:40960
    ds_read_b64_tr_b16 a[118:119], v20 offset:41984
    s_waitcnt lgkmcnt(2)
    ds_read_b64_tr_b16 a[120:121], v21 offset:0
    ds_read_b64_tr_b16 a[122:123], v21 offset:1024
    ds_read_b64_tr_b16 a[124:125], v21 offset:8192
    ds_read_b64_tr_b16 a[126:127], v21 offset:9216
    ds_read_b64_tr_b16 a[128:129], v21 offset:16384
    ds_read_b64_tr_b16 a[130:131], v21 offset:17408
    ds_read_b64_tr_b16 a[132:133], v21 offset:24576
    ds_read_b64_tr_b16 a[134:135], v21 offset:25600
    ds_read_b64_tr_b16 a[136:137], v21 offset:32768
    ds_read_b64_tr_b16 a[138:139], v21 offset:33792
    ds_read_b64_tr_b16 a[140:141], v21 offset:40960
    ds_read_b64_tr_b16 a[142:143], v21 offset:41984
    s_waitcnt lgkmcnt(2)
    ds_read_b64_tr_b16 a[144:145], v22 offset:0
    ds_read_b64_tr_b16 a[146:147], v22 offset:1024
    ds_read_b64_tr_b16 a[148:149], v22 offset:8192
    ds_read_b64_tr_b16 a[150:151], v22 offset:9216
    ds_read_b64_tr_b16 a[152:153], v22 offset:16384
    ds_read_b64_tr_b16 a[154:155], v22 offset:17408
    ds_read_b64_tr_b16 a[156:157], v22 offset:24576
    ds_read_b64_tr_b16 a[158:159], v22 offset:25600
    ds_read_b64_tr_b16 a[160:161], v22 offset:32768
    ds_read_b64_tr_b16 a[162:163], v22 offset:33792
    ds_read_b64_tr_b16 a[164:165], v22 offset:40960
    ds_read_b64_tr_b16 a[166:167], v22 offset:41984
    s_waitcnt lgkmcnt(2)
    ds_read_b64_tr_b16 a[168:169], v23 offset:0
    ds_read_b64_tr_b16 a[170:171], v23 offset:1024
    ds_read_b64_tr_b16 a[172:173], v23 offset:8192
    ds_read_b64_tr_b16 a[174:175], v23 offset:9216
    ds_read_b64_tr_b16 a[176:177], v23 offset:16384
    ds_read_b64_tr_b16 a[178:179], v23 offset:17408
    ds_read_b64_tr_b16 a[180:181], v23 offset:24576
    ds_read_b64_tr_b16 a[182:183], v23 offset:25600
    ds_read_b64_tr_b16 a[184:185], v23 offset:32768
    ds_read_b64_tr_b16 a[186:187], v23 offset:33792
    ds_read_b64_tr_b16 a[188:189], v23 offset:40960
    ds_read_b64_tr_b16 a[190:191], v23 offset:41984
    s_waitcnt lgkmcnt(2)
    s_mul_i32 s29, s80, 393216
    s_add_u32 s29, s29, s76
    s_add_u32 m0, s78, 12288
    s_nop 0
    buffer_load_dwordx4 v24, s[12:15], s29 offen offset:0 lds
    s_add_u32 m0, s78, 13184
    s_nop 0
    buffer_load_dwordx4 v24, s[12:15], s29 offen offset:128 lds
    s_add_u32 m0, s78, 14080
    s_nop 0
    buffer_load_dwordx4 v24, s[12:15], s29 offen offset:256 lds
    s_add_u32 m0, s78, 15360
    s_nop 0
    buffer_load_dwordx4 v25, s[12:15], s29 offen offset:0 lds
    s_add_u32 m0, s78, 16256
    s_nop 0
    buffer_load_dwordx4 v25, s[12:15], s29 offen offset:128 lds
    s_add_u32 m0, s78, 17152
    s_nop 0
    buffer_load_dwordx4 v25, s[12:15], s29 offen offset:256 lds
    s_add_u32 m0, s78, 18432
    s_nop 0
    buffer_load_dwordx4 v26, s[12:15], s29 offen offset:0 lds
    s_add_u32 m0, s78, 19328
    s_nop 0
    buffer_load_dwordx4 v26, s[12:15], s29 offen offset:128 lds
    s_add_u32 m0, s78, 20224
    s_nop 0
    buffer_load_dwordx4 v26, s[12:15], s29 offen offset:256 lds
    s_add_u32 m0, s78, 21504
    s_nop 0
    buffer_load_dwordx4 v27, s[12:15], s29 offen offset:0 lds
    s_add_u32 m0, s78, 22400
    s_nop 0
    buffer_load_dwordx4 v27, s[12:15], s29 offen offset:128 lds
    s_add_u32 m0, s78, 23296
    s_nop 0
    buffer_load_dwordx4 v27, s[12:15], s29 offen offset:256 lds
    s_waitcnt lgkmcnt(0)
    s_barrier
    s_waitcnt vmcnt(12)
    v_readfirstlane_b32 s28, v255
    s_nop 0
    s_cmp_lg_u32 s28, 0
    s_cbranch_scc1 Lcfd_2
    v_mov_b32 v5, 0
Lcf_1:
    s_sleep 4
    buffer_load_dword v255, v5, s[20:23], 0 offen offset:144 sc1
    s_sub_u32 s27, s27, 1
    s_cbranch_scc1 L_exit
    s_waitcnt vmcnt(0)
    v_readfirstlane_b32 s28, v255
    s_nop 0
    s_cmp_eq_u32 s28, 0
    s_cbranch_scc1 Lcf_1
Lcfd_2:
    s_cmp_lg_u32 s28, s3
    s_cbranch_scc1 L_redo
    ds_read_b128 v[32:35], v28 offset:0
    ds_read_b128 v[36:39], v29 offset:0
    ds_read_b128 v[40:43], v28 offset:1024
    ds_read_b128 v[44:47], v29 offset:1024
    ds_read_b128 v[48:51], v28 offset:2048
    ds_read_b128 v[52:55], v29 offset:2048
    ds_read_b128 v[56:59], v28 offset:512
    ds_read_b128 v[60:63], v29 offset:512
    ds_read_b128 v[64:67], v28 offset:1536
    ds_read_b128 v[68:71], v29 offset:1536
    ds_read_b128 v[72:75], v28 offset:2560
    ds_read_b128 v[76:79], v29 offset:2560
    s_waitcnt lgkmcnt(0)
    s_lshl_b32 s30, s79, 10
    s_add_u32 s30, s30, s77
    v_mfma_f32_16x16x32_bf16 v[128:131], v[32:35], a[0:3], 0
    v_mfma_f32_16x16x32_bf16 v[132:135], v[56:59], a[0:3], 0
    v_mfma_f32_16x16x32_bf16 v[136:139], v[32:35], a[24:27], 0
    v_mfma_f32_16x16x32_bf16 v[140:143], v[56:59], a[24:27], 0
    s_mul_i32 s29, s81, 393216
    s_add_u32 s29, s29, s76
    s_add_u32 m0, s84, 0
    s_nop 0
    buffer_load_dwordx4 v24, s[12:15], s29 offen offset:0 lds
    v_mfma_f32_16x16x32_bf16 v[144:147], v[32:35], a[48:51], 0
    v_mfma_f32_16x16x32_bf16 v[148:151], v[56:59], a[48:51], 0
    v_mfma_f32_16x16x32_bf16 v[152:155], v[32:35], a[72:75], 0
    v_mfma_f32_16x16x32_bf16 v[156:159], v[56:59], a[72:75], 0
    s_add_u32 m0, s84, 896
    s_nop 0
    buffer_load_dwordx4 v24, s[12:15], s29 offen offset:128 lds
    v_mfma_f32_16x16x32_bf16 v[128:131], v[36:39], a[4:7], v[128:131]
    v_mfma_f32_16x16x32_bf16 v[132:135], v[60:63], a[4:7], v[132:135]
    v_mfma_f32_16x16x32_bf16 v[136:139], v[36:39], a[28:31], v[136:139]
    v_mfma_f32_16x16x32_bf16 v[140:143], v[60:63], a[28:31], v[140:143]
    s_add_u32 m0, s84, 1792
    s_nop 0
    buffer_load_dwordx4 v24, s[12:15], s29 offen offset:256 lds
    v_mfma_f32_16x16x32_bf16 v[144:147], v[36:39], a[52:55], v[144:147]
    v_mfma_f32_16x16x32_bf16 v[148:151], v[60:63], a[52:55], v[148:151]
    v_mfma_f32_16x16x32_bf16 v[152:155], v[36:39], a[76:79], v[152:155]
    v_mfma_f32_16x16x32_bf16 v[156:159], v[60:63], a[76:79], v[156:159]
    s_add_u32 m0, s84, 3072
    s_nop 0
    buffer_load_dwordx4 v25, s[12:15], s29 offen offset:0 lds
    v_mfma_f32_16x16x32_bf16 v[128:131], v[40:43], a[8:11], v[128:131]
    v_mfma_f32_16x16x32_bf16 v[132:135], v[64:67], a[8:11], v[132:135]
    v_mfma_f32_16x16x32_bf16 v[136:139], v[40:43], a[32:35], v[136:139]
    v_mfma_f32_16x16x32_bf16 v[140:143], v[64:67], a[32:35], v[140:143]
    s_add_u32 m0, s84, 3968
    s_nop 0
    buffer_load_dwordx4 v25, s[12:15], s29 offen offset:128 lds
    v_mfma_f32_16x16x32_bf16 v[144:147], v[40:43], a[56:59], v[144:147]
    v_mfma_f32_16x16x32_bf16 v[148:151], v[64:67], a[56:59], v[148:151]
    v_mfma_f32_16x16x32_bf16 v[152:155], v[40:43], a[80:83], v[152:155]
    v_mfma_f32_16x16x32_bf16 v[156:159], v[64:67], a[80:83], v[156:159]
    s_add_u32 m0, s84, 4864
    s_nop 0
    buffer_load_dwordx4 v25, s[12:15], s29 offen offset:256 lds
    v_mfma_f32_16x16x32_bf16 v[128:131], v[44:47], a[12:15], v[128:131]
    v_mfma_f32_16x16x32_bf16 v[132:135], v[68:71], a[12:15], v[132:135]
    v_mfma_f32_16x16x32_bf16 v[136:139], v[44:47], a[36:39], v[136:139]
    v_mfma_f32_16x16x32_bf16 v[140:143], v[68:71], a[36:39], v[140:143]
    s_add_u32 m0, s84, 6144
    s_nop 0
    buffer_load_dwordx4 v26, s[12:15], s29 offen offset:0 lds
    v_mfma_f32_16x16x32_bf16 v[144:147], v[44:47], a[60:63], v[144:147]
    v_mfma_f32_16x16x32_bf16 v[148:151], v[68:71], a[60:63], v[148:151]
    v_mfma_f32_16x16x32_bf16 v[152:155], v[44:47], a[84:87], v[152:155]
    v_mfma_f32_16x16x32_bf16 v[156:159], v[68:71], a[84:87], v[156:159]
    s_add_u32 m0, s84, 7040
    s_nop 0
    buffer_load_dwordx4 v26, s[12:15], s29 offen offset:128 lds
    v_mfma_f32_16x16x32_bf16 v[128:131], v[48:51], a[16:19], v[128:131]
    v_mfma_f32_16x16x32_bf16 v[132:135], v[72:75], a[16:19], v[132:135]
    v_mfma_f32_16x16x32_bf16 v[136:139], v[48:51], a[40:43], v[136:139]
    v_mfma_f32_16x16x32_bf16 v[140:143], v[72:75], a[40:43], v[140:143]
    s_add_u32 m0, s84, 7936
    s_nop 0
    buffer_load_dwordx4 v26, s[12:15], s29 offen offset:256 lds
    v_mfma_f32_16x16x32_bf16 v[144:147], v[48:51], a[64:67], v[144:147]
    v_mfma_f32_16x16x32_bf16 v[148:151], v[72:75], a[64:67], v[148:151]
    v_mfma_f32_16x16x32_bf16 v[152:155], v[48:51], a[88:91], v[152:155]
    v_mfma_f32_16x16x32_bf16 v[156:159], v[72:75], a[88:91], v[156:159]
    s_add_u32 m0, s84, 9216
    s_nop 0
    buffer_load_dwordx4 v27, s[12:15], s29 offen offset:0 lds
    v_mfma_f32_16x16x32_bf16 v[128:131], v[52:55], a[20:23], v[128:131]
    v_mfma_f32_16x16x32_bf16 v[132:135], v[76:79], a[20:23], v[132:135]
    v_mfma_f32_16x16x32_bf16 v[136:139], v[52:55], a[44:47], v[136:139]
    v_mfma_f32_16x16x32_bf16 v[140:143], v[76:79], a[44:47], v[140:143]
    s_add_u32 m0, s84, 10112
    s_nop 0
    buffer_load_dwordx4 v27, s[12:15], s29 offen offset:128 lds
    v_mfma_f32_16x16x32_bf16 v[144:147], v[52:55], a[68:71], v[144:147]
    v_mfma_f32_16x16x32_bf16 v[148:151], v[76:79], a[68:71], v[148:151]
    v_mfma_f32_16x16x32_bf16 v[152:155], v[52:55], a[92:95], v[152:155]
    v_mfma_f32_16x16x32_bf16 v[156:159], v[76:79], a[92:95], v[156:159]
    s_add_u32 m0, s84, 11008
    s_nop 0
    buffer_load_dwordx4 v27, s[12:15], s29 offen offset:256 lds
    s_waitcnt vmcnt(12)
    ds_read_b128 v[80:83], v28 offset:12288
    ds_read_b128 v[84:87], v29 offset:12288
    ds_read_b128 v[88:91], v28 offset:13312
    ds_read_b128 v[92:95], v29 offset:13312
    ds_read_b128 v[96:99], v28 offset:14336
    ds_read_b128 v[100:103], v29 offset:14336
    ds_read_b128 v[104:107], v28 offset:12800
    ds_read_b128 v[108:111], v29 offset:12800
    ds_read_b128 v[112:115], v28 offset:13824
    ds_read_b128 v[116:119], v29 offset:13824
    ds_read_b128 v[120:123], v28 offset:14848
    ds_read_b128 v[124:127], v29 offset:14848
    v_mfma_f32_16x16x32_bf16 v[160:163], v[32:35], a[96:99], 0
    v_mfma_f32_16x16x32_bf16 v[164:167], v[56:59], a[96:99], 0
    v_mfma_f32_16x16x32_bf16 v[168:171], v[32:35], a[120:123], 0
    v_mfma_f32_16x16x32_bf16 v[172:175], v[56:59], a[120:123], 0
    s_mul_i32 s29, s82, 393216
    s_add_u32 s29, s29, s76
    s_add_u32 m0, s78, 0
    s_nop 0
    buffer_load_dwordx4 v24, s[12:15], s29 offen offset:0 lds
    v_mfma_f32_16x16x32_bf16 v[176:179], v[32:35], a[144:147], 0
    v_mfma_f32_16x16x32_bf16 v[180:183], v[56:59], a[144:147], 0
    v_mfma_f32_16x16x32_bf16 v[184:187], v[32:35], a[168:171], 0
    v_mfma_f32_16x16x32_bf16 v[188:191], v[56:59], a[168:171], 0
    s_add_u32 m0, s78, 896
    s_nop 0
    buffer_load_dwordx4 v24, s[12:15], s29 offen offset:128 lds
    v_cvt_pk_bf16_f32 v192, v128, v129
    v_cvt_pk_bf16_f32 v193, v130, v131
    v_cvt_pk_bf16_f32 v194, v132, v133
    v_cvt_pk_bf16_f32 v195, v134, v135
    s_add_u32 s28, s30, 0
    buffer_store_dwordx4 v[192:195], v31, s[4:7], s28 offen sc1
    v_mfma_f32_16x16x32_bf16 v[160:163], v[36:39], a[100:103], v[160:163]
    v_mfma_f32_16x16x32_bf16 v[164:167], v[60:63], a[100:103], v[164:167]
    v_mfma_f32_16x16x32_bf16 v[168:171], v[36:39], a[124:127], v[168:171]
    v_mfma_f32_16x16x32_bf16 v[172:175], v[60:63], a[124:127], v[172:175]
    s_add_u32 m0, s78, 1792
    s_nop 0
    buffer_load_dwordx4 v24, s[12:15], s29 offen offset:256 lds
    v_mfma_f32_16x16x32_bf16 v[176:179], v[36:39], a[148:151], v[176:179]
    v_mfma_f32_16x16x32_bf16 v[180:183], v[60:63], a[148:151], v[180:183]
    v_mfma_f32_16x16x32_bf16 v[184:187], v[36:39], a[172:175], v[184:187]
    v_mfma_f32_16x16x32_bf16 v[188:191], v[60:63], a[172:175], v[188:191]
    s_add_u32 m0, s78, 3072
    s_nop 0
    buffer_load_dwordx4 v25, s[12:15], s29 offen offset:0 lds
    v_cvt_pk_bf16_f32 v196, v136, v137
    v_cvt_pk_bf16_f32 v197, v138, v139
    v_cvt_pk_bf16_f32 v198, v140, v141
    v_cvt_pk_bf16_f32 v199, v142, v143
    s_add_u32 s28, s30, 655360
    buffer_store_dwordx4 v[196:199], v31, s[4:7], s28 offen sc1
    v_mfma_f32_16x16x32_bf16 v[160:163], v[40:43], a[104:107], v[160:163]
    v_mfma_f32_16x16x32_bf16 v[164:167], v[64:67], a[104:107], v[164:167]
    v_mfma_f32_16x16x32_bf16 v[168:171], v[40:43], a[128:131], v[168:171]
    v_mfma_f32_16x16x32_bf16 v[172:175], v[64:67], a[128:131], v[172:175]
    s_add_u32 m0, s78, 3968
    s_nop 0
    buffer_load_dwordx4 v25, s[12:15], s29 offen offset:128 lds
    v_mfma_f32_16x16x32_bf16 v[176:179], v[40:43], a[152:155], v[176:179]
    v_mfma_f32_16x16x32_bf16 v[180:183], v[64:67], a[152:155], v[180:183]
    v_mfma_f32_16x16x32_bf16 v[184:187], v[40:43], a[176:179], v[184:187]
    v_mfma_f32_16x16x32_bf16 v[188:191], v[64:67], a[176:179], v[188:191]
    s_add_u32 m0, s78, 4864
    s_nop 0
    buffer_load_dwordx4 v25, s[12:15], s29 offen offset:256 lds
    v_cvt_pk_bf16_f32 v200, v144, v145
    v_cvt_pk_bf16_f32 v201, v146, v147
    v_cvt_pk_bf16_f32 v202, v148, v149
    v_cvt_pk_bf16_f32 v203, v150, v151
    s_add_u32 s28, s30, 1310720
    buffer_store_dwordx4 v[200:203], v31, s[4:7], s28 offen sc1
    v_mfma_f32_16x16x32_bf16 v[160:163], v[44:47], a[108:111], v[160:163]
    v_mfma_f32_16x16x32_bf16 v[164:167], v[68:71], a[108:111], v[164:167]
    v_mfma_f32_16x16x32_bf16 v[168:171], v[44:47], a[132:135], v[168:171]
    v_mfma_f32_16x16x32_bf16 v[172:175], v[68:71], a[132:135], v[172:175]
    s_add_u32 m0, s78, 6144
    s_nop 0
    buffer_load_dwordx4 v26, s[12:15], s29 offen offset:0 lds
    v_mfma_f32_16x16x32_bf16 v[176:179], v[44:47], a[156:159], v[176:179]
    v_mfma_f32_16x16x32_bf16 v[180:183], v[68:71], a[156:159], v[180:183]
    v_mfma_f32_16x16x32_bf16 v[184:187], v[44:47], a[180:183], v[184:187]
    v_mfma_f32_16x16x32_bf16 v[188:191], v[68:71], a[180:183], v[188:191]
    s_add_u32 m0, s78, 7040
    s_nop 0
    buffer_load_dwordx4 v26, s[12:15], s29 offen offset:128 lds
    v_cvt_pk_bf16_f32 v204, v152, v153
    v_cvt_pk_bf16_f32 v205, v154, v155
    v_cvt_pk_bf16_f32 v206, v156, v157
    v_cvt_pk_bf16_f32 v207, v158, v159
    s_add_u32 s28, s30, 1966080
    buffer_store_dwordx4 v[204:207], v31, s[4:7], s28 offen sc1
    v_mfma_f32_16x16x32_bf16 v[160:163], v[48:51], a[112:115], v[160:163]
    v_mfma_f32_16x16x32_bf16 v[164:167], v[72:75], a[112:115], v[164:167]
    v_mfma_f32_16x16x32_bf16 v[168:171], v[48:51], a[136:139], v[168:171]
    v_mfma_f32_16x16x32_bf16 v[172:175], v[72:75], a[136:139], v[172:175]
    s_add_u32 m0, s78, 7936
    s_nop 0
    buffer_load_dwordx4 v26, s[12:15], s29 offen offset:256 lds
    v_mfma_f32_16x16x32_bf16 v[176:179], v[48:51], a[160:163], v[176:179]
    v_mfma_f32_16x16x32_bf16 v[180:183], v[72:75], a[160:163], v[180:183]
    v_mfma_f32_16x16x32_bf16 v[184:187], v[48:51], a[184:187], v[184:187]
    v_mfma_f32_16x16x32_bf16 v[188:191], v[72:75], a[184:187], v[188:191]
    s_add_u32 m0, s78, 9216
    s_nop 0
    buffer_load_dwordx4 v27, s[12:15], s29 offen offset:0 lds
    v_mfma_f32_16x16x32_bf16 v[160:163], v[52:55], a[116:119], v[160:163]
    v_mfma_f32_16x16x32_bf16 v[164:167], v[76:79], a[116:119], v[164:167]
    v_mfma_f32_16x16x32_bf16 v[168:171], v[52:55], a[140:143], v[168:171]
    v_mfma_f32_16x16x32_bf16 v[172:175], v[76:79], a[140:143], v[172:175]
    s_add_u32 m0, s78, 10112
    s_nop 0
    buffer_load_dwordx4 v27, s[12:15], s29 offen offset:128 lds
    v_mfma_f32_16x16x32_bf16 v[176:179], v[52:55], a[164:167], v[176:179]
    v_mfma_f32_16x16x32_bf16 v[180:183], v[76:79], a[164:167], v[180:183]
    v_mfma_f32_16x16x32_bf16 v[184:187], v[52:55], a[188:191], v[184:187]
    v_mfma_f32_16x16x32_bf16 v[188:191], v[76:79], a[188:191], v[188:191]
    s_add_u32 m0, s78, 11008
    s_nop 0
    buffer_load_dwordx4 v27, s[12:15], s29 offen offset:256 lds
    s_mov_b32 s31, s30
    s_waitcnt lgkmcnt(0)
    s_lshl_b32 s30, s80, 10
    s_add_u32 s30, s30, s77
    v_mfma_f32_16x16x32_bf16 v[128:131], v[80:83], a[0:3], 0
    v_mfma_f32_16x16x32_bf16 v[132:135], v[104:107], a[0:3], 0
    v_mfma_f32_16x16x32_bf16 v[136:139], v[80:83], a[24:27], 0
    v_mfma_f32_16x16x32_bf16 v[140:143], v[104:107], a[24:27], 0
    s_mul_i32 s29, s83, 393216
    s_add_u32 s29, s29, s76
    s_add_u32 m0, s78, 12288
    s_nop 0
    buffer_load_dwordx4 v24, s[12:15], s29 offen offset:0 lds
    v_mfma_f32_16x16x32_bf16 v[144:147], v[80:83], a[48:51], 0
    v_mfma_f32_16x16x32_bf16 v[148:151], v[104:107], a[48:51], 0
    v_mfma_f32_16x16x32_bf16 v[152:155], v[80:83], a[72:75], 0
    v_mfma_f32_16x16x32_bf16 v[156:159], v[104:107], a[72:75], 0
    s_add_u32 m0, s78, 13184
    s_nop 0
    buffer_load_dwordx4 v24, s[12:15], s29 offen offset:128 lds
    v_cvt_pk_bf16_f32 v208, v160, v161
    v_cvt_pk_bf16_f32 v209, v162, v163
    v_cvt_pk_bf16_f32 v210, v164, v165
    v_cvt_pk_bf16_f32 v211, v166, v167
    s_add_u32 s28, s31, 2621440
    buffer_store_dwordx4 v[208:211], v31, s[4:7], s28 offen sc1
    v_mfma_f32_16x16x32_bf16 v[128:131], v[84:87], a[4:7], v[128:131]
    v_mfma_f32_16x16x32_bf16 v[132:135], v[108:111], a[4:7], v[132:135]
    v_mfma_f32_16x16x32_bf16 v[136:139], v[84:87], a[28:31], v[136:139]
    v_mfma_f32_16x16x32_bf16 v[140:143], v[108:111], a[28:31], v[140:143]
    s_add_u32 m0, s78, 14080
    s_nop 0
    buffer_load_dwordx4 v24, s[12:15], s29 offen offset:256 lds
    v_mfma_f32_16x16x32_bf16 v[144:147], v[84:87], a[52:55], v[144:147]
    v_mfma_f32_16x16x32_bf16 v[148:151], v[108:111], a[52:55], v[148:151]
    v_mfma_f32_16x16x32_bf16 v[152:155], v[84:87], a[76:79], v[152:155]
    v_mfma_f32_16x16x32_bf16 v[156:159], v[108:111], a[76:79], v[156:159]
    s_add_u32 m0, s78, 15360
    s_nop 0
    buffer_load_dwordx4 v25, s[12:15], s29 offen offset:0 lds
    v_cvt_pk_bf16_f32 v212, v168, v169
    v_cvt_pk_bf16_f32 v213, v170, v171
    v_cvt_pk_bf16_f32 v214, v172, v173
    v_cvt_pk_bf16_f32 v215, v174, v175
    s_add_u32 s28, s31, 3276800
    buffer_store_dwordx4 v[212:215], v31, s[4:7], s28 offen sc1
    v_mfma_f32_16x16x32_bf16 v[128:131], v[88:91], a[8:11], v[128:131]
    v_mfma_f32_16x16x32_bf16 v[132:135], v[112:115], a[8:11], v[132:135]
    v_mfma_f32_16x16x32_bf16 v[136:139], v[88:91], a[32:35], v[136:139]
    v_mfma_f32_16x16x32_bf16 v[140:143], v[112:115], a[32:35], v[140:143]
    s_add_u32 m0, s78, 16256
    s_nop 0
    buffer_load_dwordx4 v25, s[12:15], s29 offen offset:128 lds
    v_mfma_f32_16x16x32_bf16 v[144:147], v[88:91], a[56:59], v[144:147]
    v_mfma_f32_16x16x32_bf16 v[148:151], v[112:115], a[56:59], v[148:151]
    v_mfma_f32_16x16x32_bf16 v[152:155], v[88:91], a[80:83], v[152:155]
    v_mfma_f32_16x16x32_bf16 v[156:159], v[112:115], a[80:83], v[156:159]
    s_add_u32 m0, s78, 17152
    s_nop 0
    buffer_load_dwordx4 v25, s[12:15], s29 offen offset:256 lds
    v_cvt_pk_bf16_f32 v216, v176, v177
    v_cvt_pk_bf16_f32 v217, v178, v179
    v_cvt_pk_bf16_f32 v218, v180, v181
    v_cvt_pk_bf16_f32 v219, v182, v183
    s_add_u32 s28, s31, 3932160
    buffer_store_dwordx4 v[216:219], v31, s[4:7], s28 offen sc1
    v_mfma_f32_16x16x32_bf16 v[128:131], v[92:95], a[12:15], v[128:131]
    v_mfma_f32_16x16x32_bf16 v[132:135], v[116:119], a[12:15], v[132:135]
    v_mfma_f32_16x16x32_bf16 v[136:139], v[92:95], a[36:39], v[136:139]
    v_mfma_f32_16x16x32_bf16 v[140:143], v[116:119], a[36:39], v[140:143]
    s_add_u32 m0, s78, 18432
    s_nop 0
    buffer_load_dwordx4 v26, s[12:15], s29 offen offset:0 lds
    v_mfma_f32_16x16x32_bf16 v[144:147], v[92:95], a[60:63], v[144:147]
    v_mfma_f32_16x16x32_bf16 v[148:151], v[116:119], a[60:63], v[148:151]
    v_mfma_f32_16x16x32_bf16 v[152:155], v[92:95], a[84:87], v[152:155]
    v_mfma_f32_16x16x32_bf16 v[156:159], v[116:119], a[84:87], v[156:159]
    s_add_u32 m0, s78, 19328
    s_nop 0
    buffer_load_dwordx4 v26, s[12:15], s29 offen offset:128 lds
    v_cvt_pk_bf16_f32 v220, v184, v185
    v_cvt_pk_bf16_f32 v221, v186, v187
    v_cvt_pk_bf16_f32 v222, v188, v189
    v_cvt_pk_bf16_f32 v223, v190, v191
    s_add_u32 s28, s31, 4587520
    buffer_store_dwordx4 v[220:223], v31, s[4:7], s28 offen sc1
    v_mfma_f32_16x16x32_bf16 v[128:131], v[96:99], a[16:19], v[128:131]
    v_mfma_f32_16x16x32_bf16 v[132:135], v[120:123], a[16:19], v[132:135]
    v_mfma_f32_16x16x32_bf16 v[136:139], v[96:99], a[40:43], v[136:139]
    v_mfma_f32_16x16x32_bf16 v[140:143], v[120:123], a[40:43], v[140:143]
    s_add_u32 m0, s78, 20224
    s_nop 0
    buffer_load_dwordx4 v26, s[12:15], s29 offen offset:256 lds
    v_mfma_f32_16x16x32_bf16 v[144:147], v[96:99], a[64:67], v[144:147]
    v_mfma_f32_16x16x32_bf16 v[148:151], v[120:123], a[64:67], v[148:151]
    v_mfma_f32_16x16x32_bf16 v[152:155], v[96:99], a[88:91], v[152:155]
    v_mfma_f32_16x16x32_bf16 v[156:159], v[120:123], a[88:91], v[156:159]
    s_add_u32 m0, s78, 21504
    s_nop 0
    buffer_load_dwordx4 v27, s[12:15], s29 offen offset:0 lds
    v_mfma_f32_16x16x32_bf16 v[128:131], v[100:103], a[20:23], v[128:131]
    v_mfma_f32_16x16x32_bf16 v[132:135], v[124:127], a[20:23], v[132:135]
    v_mfma_f32_16x16x32_bf16 v[136:139], v[100:103], a[44:47], v[136:139]
    v_mfma_f32_16x16x32_bf16 v[140:143], v[124:127], a[44:47], v[140:143]
    s_add_u32 m0, s78, 22400
    s_nop 0
    buffer_load_dwordx4 v27, s[12:15], s29 offen offset:128 lds
    v_mfma_f32_16x16x32_bf16 v[144:147], v[100:103], a[68:71], v[144:147]
    v_mfma_f32_16x16x32_bf16 v[148:151], v[124:127], a[68:71], v[148:151]
    v_mfma_f32_16x16x32_bf16 v[152:155], v[100:103], a[92:95], v[152:155]
    v_mfma_f32_16x16x32_bf16 v[156:159], v[124:127], a[92:95], v[156:159]
    s_add_u32 m0, s78, 23296
    s_nop 0
    buffer_load_dwordx4 v27, s[12:15], s29 offen offset:256 lds
    s_waitcnt vmcnt(32)
    ds_read_b128 v[32:35], v224 offset:0
    ds_read_b128 v[36:39], v225 offset:0
    ds_read_b128 v[40:43], v224 offset:1024
    ds_read_b128 v[44:47], v225 offset:1024
    ds_read_b128 v[48:51], v224 offset:2048
    ds_read_b128 v[52:55], v225 offset:2048
    ds_read_b128 v[56:59], v224 offset:512
    ds_read_b128 v[60:63], v225 offset:512
    ds_read_b128 v[64:67], v224 offset:1536
    ds_read_b128 v[68:71], v225 offset:1536
    ds_read_b128 v[72:75], v224 offset:2560
    ds_read_b128 v[76:79], v225 offset:2560
    v_mfma_f32_16x16x32_bf16 v[160:163], v[80:83], a[96:99], 0
    v_mfma_f32_16x16x32_bf16 v[164:167], v[104:107], a[96:99], 0
    v_mfma_f32_16x16x32_bf16 v[168:171], v[80:83], a[120:123], 0
    v_mfma_f32_16x16x32_bf16 v[172:175], v[104:107], a[120:123], 0
    v_mfma_f32_16x16x32_bf16 v[176:179], v[80:83], a[144:147], 0
    v_mfma_f32_16x16x32_bf16 v[180:183], v[104:107], a[144:147], 0
    v_mfma_f32_16x16x32_bf16 v[184:187], v[80:83], a[168:171], 0
    v_mfma_f32_16x16x32_bf16 v[188:191], v[104:107], a[168:171], 0
    v_cvt_pk_bf16_f32 v192, v128, v129
    v_cvt_pk_bf16_f32 v193, v130, v131
    v_cvt_pk_bf16_f32 v194, v132, v133
    v_cvt_pk_bf16_f32 v195, v134, v135
    s_add_u32 s28, s30, 0
    buffer_store_dwordx4 v[192:195], v31, s[4:7], s28 offen sc1
    v_mfma_f32_16x16x32_bf16 v[160:163], v[84:87], a[100:103], v[160:163]
    v_mfma_f32_16x16x32_bf16 v[164:167], v[108:111], a[100:103], v[164:167]
    v_mfma_f32_16x16x32_bf16 v[168:171], v[84:87], a[124:127], v[168:171]
    v_mfma_f32_16x16x32_bf16 v[172:175], v[108:111], a[124:127], v[172:175]
    v_mfma_f32_16x16x32_bf16 v[176:179], v[84:87], a[148:151], v[176:179]
    v_mfma_f32_16x16x32_bf16 v[180:183], v[108:111], a[148:151], v[180:183]
    v_mfma_f32_16x16x32_bf16 v[184:187], v[84:87], a[172:175], v[184:187]
    v_mfma_f32_16x16x32_bf16 v[188:191], v[108:111], a[172:175], v[188:191]
    v_cvt_pk_bf16_f32 v196, v136, v137
    v_cvt_pk_bf16_f32 v197, v138, v139
    v_cvt_pk_bf16_f32 v198, v140, v141
    v_cvt_pk_bf16_f32 v199, v142, v143
    s_add_u32 s28, s30, 655360
    buffer_store_dwordx4 v[196:199], v31, s[4:7], s28 offen sc1
    v_mfma_f32_16x16x32_bf16 v[160:163], v[88:91], a[104:107], v[160:163]
    v_mfma_f32_16x16x32_bf16 v[164:167], v[112:115], a[104:107], v[164:167]
    v_mfma_f32_16x16x32_bf16 v[168:171], v[88:91], a[128:131], v[168:171]
    v_mfma_f32_16x16x32_bf16 v[172:175], v[112:115], a[128:131], v[172:175]
    v_mfma_f32_16x16x32_bf16 v[176:179], v[88:91], a[152:155], v[176:179]
    v_mfma_f32_16x16x32_bf16 v[180:183], v[112:115], a[152:155], v[180:183]
    v_mfma_f32_16x16x32_bf16 v[184:187], v[88:91], a[176:179], v[184:187]
    v_mfma_f32_16x16x32_bf16 v[188:191], v[112:115], a[176:179], v[188:191]
    v_cvt_pk_bf16_f32 v200, v144, v145
    v_cvt_pk_bf16_f32 v201, v146, v147
    v_cvt_pk_bf16_f32 v202, v148, v149
    v_cvt_pk_bf16_f32 v203, v150, v151
    s_add_u32 s28, s30, 1310720
    buffer_store_dwordx4 v[200:203], v31, s[4:7], s28 offen sc1
    v_mfma_f32_16x16x32_bf16 v[160:163], v[92:95], a[108:111], v[160:163]
    v_mfma_f32_16x16x32_bf16 v[164:167], v[116:119], a[108:111], v[164:167]
    v_mfma_f32_16x16x32_bf16 v[168:171], v[92:95], a[132:135], v[168:171]
    v_mfma_f32_16x16x32_bf16 v[172:175], v[116:119], a[132:135], v[172:175]
    v_mfma_f32_16x16x32_bf16 v[176:179], v[92:95], a[156:159], v[176:179]
    v_mfma_f32_16x16x32_bf16 v[180:183], v[116:119], a[156:159], v[180:183]
    v_mfma_f32_16x16x32_bf16 v[184:187], v[92:95], a[180:183], v[184:187]
    v_mfma_f32_16x16x32_bf16 v[188:191], v[116:119], a[180:183], v[188:191]
    v_cvt_pk_bf16_f32 v204, v152, v153
    v_cvt_pk_bf16_f32 v205, v154, v155
    v_cvt_pk_bf16_f32 v206, v156, v157
    v_cvt_pk_bf16_f32 v207, v158, v159
    s_add_u32 s28, s30, 1966080
    buffer_store_dwordx4 v[204:207], v31, s[4:7], s28 offen sc1
    v_mfma_f32_16x16x32_bf16 v[160:163], v[96:99], a[112:115], v[160:163]
    v_mfma_f32_16x16x32_bf16 v[164:167], v[120:123], a[112:115], v[164:167]
    v_mfma_f32_16x16x32_bf16 v[168:171], v[96:99], a[136:139], v[168:171]
    v_mfma_f32_16x16x32_bf16 v[172:175], v[120:123], a[136:139], v[172:175]
    v_mfma_f32_16x16x32_bf16 v[176:179], v[96:99], a[160:163], v[176:179]
    v_mfma_f32_16x16x32_bf16 v[180:183], v[120:123], a[160:163], v[180:183]
    v_mfma_f32_16x16x32_bf16 v[184:187], v[96:99], a[184:187], v[184:187]
    v_mfma_f32_16x16x32_bf16 v[188:191], v[120:123], a[184:187], v[188:191]
    v_mfma_f32_16x16x32_bf16 v[160:163], v[100:103], a[116:119], v[160:163]
    v_mfma_f32_16x16x32_bf16 v[164:167], v[124:127], a[116:119], v[164:167]
    v_mfma_f32_16x16x32_bf16 v[168:171], v[100:103], a[140:143], v[168:171]
    v_mfma_f32_16x16x32_bf16 v[172:175], v[124:127], a[140:143], v[172:175]
    v_mfma_f32_16x16x32_bf16 v[176:179], v[100:103], a[164:167], v[176:179]
    v_mfma_f32_16x16x32_bf16 v[180:183], v[124:127], a[164:167], v[180:183]
    v_mfma_f32_16x16x32_bf16 v[184:187], v[100:103], a[188:191], v[184:187]
    v_mfma_f32_16x16x32_bf16 v[188:191], v[124:127], a[188:191], v[188:191]
    s_mov_b32 s31, s30
    s_waitcnt lgkmcnt(0)
    s_lshl_b32 s30, s81, 10
    s_add_u32 s30, s30, s77
    v_mfma_f32_16x16x32_bf16 v[128:131], v[32:35], a[0:3], 0
    v_mfma_f32_16x16x32_bf16 v[132:135], v[56:59], a[0:3], 0
    v_mfma_f32_16x16x32_bf16 v[136:139], v[32:35], a[24:27], 0
    v_mfma_f32_16x16x32_bf16 v[140:143], v[56:59], a[24:27], 0
    v_mfma_f32_16x16x32_bf16 v[144:147], v[32:35], a[48:51], 0
    v_mfma_f32_16x16x32_bf16 v[148:151], v[56:59], a[48:51], 0
    v_mfma_f32_16x16x32_bf16 v[152:155], v[32:35], a[72:75], 0
    v_mfma_f32_16x16x32_bf16 v[156:159], v[56:59], a[72:75], 0
    v_cvt_pk_bf16_f32 v208, v160, v161
    v_cvt_pk_bf16_f32 v209, v162, v163
    v_cvt_pk_bf16_f32 v210, v164, v165
    v_cvt_pk_bf16_f32 v211, v166, v167
    s_add_u32 s28, s31, 2621440
    buffer_store_dwordx4 v[208:211], v31, s[4:7], s28 offen sc1
    v_mfma_f32_16x16x32_bf16 v[128:131], v[36:39], a[4:7], v[128:131]
    v_mfma_f32_16x16x32_bf16 v[132:135], v[60:63], a[4:7], v[132:135]
    v_mfma_f32_16x16x32_bf16 v[136:139], v[36:39], a[28:31], v[136:139]
    v_mfma_f32_16x16x32_bf16 v[140:143], v[60:63], a[28:31], v[140:143]
    v_mfma_f32_16x16x32_bf16 v[144:147], v[36:39], a[52:55], v[144:147]
    v_mfma_f32_16x16x32_bf16 v[148:151], v[60:63], a[52:55], v[148:151]
    v_mfma_f32_16x16x32_bf16 v[152:155], v[36:39], a[76:79], v[152:155]
    v_mfma_f32_16x16x32_bf16 v[156:159], v[60:63], a[76:79], v[156:159]
    v_cvt_pk_bf16_f32 v212, v168, v169
    v_cvt_pk_bf16_f32 v213, v170, v171
    v_cvt_pk_bf16_f32 v214, v172, v173
    v_cvt_pk_bf16_f32 v215, v174, v175
    s_add_u32 s28, s31, 3276800
    buffer_store_dwordx4 v[212:215], v31, s[4:7], s28 offen sc1
    v_mfma_f32_16x16x32_bf16 v[128:131], v[40:43], a[8:11], v[128:131]
    v_mfma_f32_16x16x32_bf16 v[132:135], v[64:67], a[8:11], v[132:135]
    v_mfma_f32_16x16x32_bf16 v[136:139], v[40:43], a[32:35], v[136:139]
    v_mfma_f32_16x16x32_bf16 v[140:143], v[64:67], a[32:35], v[140:143]
    v_mfma_f32_16x16x32_bf16 v[144:147], v[40:43], a[56:59], v[144:147]
    v_mfma_f32_16x16x32_bf16 v[148:151], v[64:67], a[56:59], v[148:151]
    v_mfma_f32_16x16x32_bf16 v[152:155], v[40:43], a[80:83], v[152:155]
    v_mfma_f32_16x16x32_bf16 v[156:159], v[64:67], a[80:83], v[156:159]
    v_cvt_pk_bf16_f32 v216, v176, v177
    v_cvt_pk_bf16_f32 v217, v178, v179
    v_cvt_pk_bf16_f32 v218, v180, v181
    v_cvt_pk_bf16_f32 v219, v182, v183
    s_add_u32 s28, s31, 3932160
    buffer_store_dwordx4 v[216:219], v31, s[4:7], s28 offen sc1
    v_mfma_f32_16x16x32_bf16 v[128:131], v[44:47], a[12:15], v[128:131]
    v_mfma_f32_16x16x32_bf16 v[132:135], v[68:71], a[12:15], v[132:135]
    v_mfma_f32_16x16x32_bf16 v[136:139], v[44:47], a[36:39], v[136:139]
    v_mfma_f32_16x16x32_bf16 v[140:143], v[68:71], a[36:39], v[140:143]
    v_mfma_f32_16x16x32_bf16 v[144:147], v[44:47], a[60:63], v[144:147]
    v_mfma_f32_16x16x32_bf16 v[148:151], v[68:71], a[60:63], v[148:151]
    v_mfma_f32_16x16x32_bf16 v[152:155], v[44:47], a[84:87], v[152:155]
    v_mfma_f32_16x16x32_bf16 v[156:159], v[68:71], a[84:87], v[156:159]
    v_cvt_pk_bf16_f32 v220, v184, v185
    v_cvt_pk_bf16_f32 v221, v186, v187
    v_cvt_pk_bf16_f32 v222, v188, v189
    v_cvt_pk_bf16_f32 v223, v190, v191
    s_add_u32 s28, s31, 4587520
    buffer_store_dwordx4 v[220:223], v31, s[4:7], s28 offen sc1
    v_mfma_f32_16x16x32_bf16 v[128:131], v[48:51], a[16:19], v[128:131]
    v_mfma_f32_16x16x32_bf16 v[132:135], v[72:75], a[16:19], v[132:135]
    v_mfma_f32_16x16x32_bf16 v[136:139], v[48:51], a[40:43], v[136:139]
    v_mfma_f32_16x16x32_bf16 v[140:143], v[72:75], a[40:43], v[140:143]
    v_mfma_f32_16x16x32_bf16 v[144:147], v[48:51], a[64:67], v[144:147]
    v_mfma_f32_16x16x32_bf16 v[148:151], v[72:75], a[64:67], v[148:151]
    v_mfma_f32_16x16x32_bf16 v[152:155], v[48:51], a[88:91], v[152:155]
    v_mfma_f32_16x16x32_bf16 v[156:159], v[72:75], a[88:91], v[156:159]
    v_mfma_f32_16x16x32_bf16 v[128:131], v[52:55], a[20:23], v[128:131]
    v_mfma_f32_16x16x32_bf16 v[132:135], v[76:79], a[20:23], v[132:135]
    v_mfma_f32_16x16x32_bf16 v[136:139], v[52:55], a[44:47], v[136:139]
    v_mfma_f32_16x16x32_bf16 v[140:143], v[76:79], a[44:47], v[140:143]
    v_mfma_f32_16x16x32_bf16 v[144:147], v[52:55], a[68:71], v[144:147]
    v_mfma_f32_16x16x32_bf16 v[148:151], v[76:79], a[68:71], v[148:151]
    v_mfma_f32_16x16x32_bf16 v[152:155], v[52:55], a[92:95], v[152:155]
    v_mfma_f32_16x16x32_bf16 v[156:159], v[76:79], a[92:95], v[156:159]
    s_waitcnt vmcnt(24)
    ds_read_b128 v[80:83], v28 offset:0
    ds_read_b128 v[84:87], v29 offset:0
    ds_read_b128 v[88:91], v28 offset:1024
    ds_read_b128 v[92:95], v29 offset:1024
    ds_read_b128 v[96:99], v28 offset:2048
    ds_read_b128 v[100:103], v29 offset:2048
    ds_read_b128 v[104:107], v28 offset:512
    ds_read_b128 v[108:111], v29 offset:512
    ds_read_b128 v[112:115], v28 offset:1536
    ds_read_b128 v[116:119], v29 offset:1536
    ds_read_b128 v[120:123], v28 offset:2560
    ds_read_b128 v[124:127], v29 offset:2560
    v_mfma_f32_16x16x32_bf16 v[160:163], v[32:35], a[96:99], 0
    v_mfma_f32_16x16x32_bf16 v[164:167], v[56:59], a[96:99], 0
    v_mfma_f32_16x16x32_bf16 v[168:171], v[32:35], a[120:123], 0
    v_mfma_f32_16x16x32_bf16 v[172:175], v[56:59], a[120:123], 0
    v_mfma_f32_16x16x32_bf16 v[176:179], v[32:35], a[144:147], 0
    v_mfma_f32_16x16x32_bf16 v[180:183], v[56:59], a[144:147], 0
    v_mfma_f32_16x16x32_bf16 v[184:187], v[32:35], a[168:171], 0
    v_mfma_f32_16x16x32_bf16 v[188:191], v[56:59], a[168:171], 0
    v_cvt_pk_bf16_f32 v192, v128, v129
    v_cvt_pk_bf16_f32 v193, v130, v131
    v_cvt_pk_bf16_f32 v194, v132, v133
    v_cvt_pk_bf16_f32 v195, v134, v135
    s_add_u32 s28, s30, 0
    buffer_store_dwordx4 v[192:195], v31, s[4:7], s28 offen sc1
    v_mfma_f32_16x16x32_bf16 v[160:163], v[36:39], a[100:103], v[160:163]
    v_mfma_f32_16x16x32_bf16 v[164:167], v[60:63], a[100:103], v[164:167]
    v_mfma_f32_16x16x32_bf16 v[168:171], v[36:39], a[124:127], v[168:171]
    v_mfma_f32_16x16x32_bf16 v[172:175], v[60:63], a[124:127], v[172:175]
    v_mfma_f32_16x16x32_bf16 v[176:179], v[36:39], a[148:151], v[176:179]
    v_mfma_f32_16x16x32_bf16 v[180:183], v[60:63], a[148:151], v[180:183]
    v_mfma_f32_16x16x32_bf16 v[184:187], v[36:39], a[172:175], v[184:187]
    v_mfma_f32_16x16x32_bf16 v[188:191], v[60:63], a[172:175], v[188:191]
    v_cvt_pk_bf16_f32 v196, v136, v137
    v_cvt_pk_bf16_f32 v197, v138, v139
    v_cvt_pk_bf16_f32 v198, v140, v141
    v_cvt_pk_bf16_f32 v199, v142, v143
    s_add_u32 s28, s30, 655360
    buffer_store_dwordx4 v[196:199], v31, s[4:7], s28 offen sc1
    v_mfma_f32_16x16x32_bf16 v[160:163], v[40:43], a[104:107], v[160:163]
    v_mfma_f32_16x16x32_bf16 v[164:167], v[64:67], a[104:107], v[164:167]
    v_mfma_f32_16x16x32_bf16 v[168:171], v[40:43], a[128:131], v[168:171]
    v_mfma_f32_16x16x32_bf16 v[172:175], v[64:67], a[128:131], v[172:175]
    v_mfma_f32_16x16x32_bf16 v[176:179], v[40:43], a[152:155], v[176:179]
    v_mfma_f32_16x16x32_bf16 v[180:183], v[64:67], a[152:155], v[180:183]
    v_mfma_f32_16x16x32_bf16 v[184:187], v[40:43], a[176:179], v[184:187]
    v_mfma_f32_16x16x32_bf16 v[188:191], v[64:67], a[176:179], v[188:191]
    v_cvt_pk_bf16_f32 v200, v144, v145
    v_cvt_pk_bf16_f32 v201, v146, v147
    v_cvt_pk_bf16_f32 v202, v148, v149
    v_cvt_pk_bf16_f32 v203, v150, v151
    s_add_u32 s28, s30, 1310720
    buffer_store_dwordx4 v[200:203], v31, s[4:7], s28 offen sc1
    v_mfma_f32_16x16x32_bf16 v[160:163], v[44:47], a[108:111], v[160:163]
    v_mfma_f32_16x16x32_bf16 v[164:167], v[68:71], a[108:111], v[164:167]
    v_mfma_f32_16x16x32_bf16 v[168:171], v[44:47], a[132:135], v[168:171]
    v_mfma_f32_16x16x32_bf16 v[172:175], v[68:71], a[132:135], v[172:175]
    v_mfma_f32_16x16x32_bf16 v[176:179], v[44:47], a[156:159], v[176:179]
    v_mfma_f32_16x16x32_bf16 v[180:183], v[68:71], a[156:159], v[180:183]
    v_mfma_f32_16x16x32_bf16 v[184:187], v[44:47], a[180:183], v[184:187]
    v_mfma_f32_16x16x32_bf16 v[188:191], v[68:71], a[180:183], v[188:191]
    v_cvt_pk_bf16_f32 v204, v152, v153
    v_cvt_pk_bf16_f32 v205, v154, v155
    v_cvt_pk_bf16_f32 v206, v156, v157
    v_cvt_pk_bf16_f32 v207, v158, v159
    s_add_u32 s28, s30, 1966080
    buffer_store_dwordx4 v[204:207], v31, s[4:7], s28 offen sc1
    v_mfma_f32_16x16x32_bf16 v[160:163], v[48:51], a[112:115], v[160:163]
    v_mfma_f32_16x16x32_bf16 v[164:167], v[72:75], a[112:115], v[164:167]
    v_mfma_f32_16x16x32_bf16 v[168:171], v[48:51], a[136:139], v[168:171]
    v_mfma_f32_16x16x32_bf16 v[172:175], v[72:75], a[136:139], v[172:175]
    v_mfma_f32_16x16x32_bf16 v[176:179], v[48:51], a[160:163], v[176:179]
    v_mfma_f32_16x16x32_bf16 v[180:183], v[72:75], a[160:163], v[180:183]
    v_mfma_f32_16x16x32_bf16 v[184:187], v[48:51], a[184:187], v[184:187]
    v_mfma_f32_16x16x32_bf16 v[188:191], v[72:75], a[184:187], v[188:191]
    v_mfma_f32_16x16x32_bf16 v[160:163], v[52:55], a[116:119], v[160:163]
    v_mfma_f32_16x16x32_bf16 v[164:167], v[76:79], a[116:119], v[164:167]
    v_mfma_f32_16x16x32_bf16 v[168:171], v[52:55], a[140:143], v[168:171]
    v_mfma_f32_16x16x32_bf16 v[172:175], v[76:79], a[140:143], v[172:175]
    v_mfma_f32_16x16x32_bf16 v[176:179], v[52:55], a[164:167], v[176:179]
    v_mfma_f32_16x16x32_bf16 v[180:183], v[76:79], a[164:167], v[180:183]
    v_mfma_f32_16x16x32_bf16 v[184:187], v[52:55], a[188:191], v[184:187]
    v_mfma_f32_16x16x32_bf16 v[188:191], v[76:79], a[188:191], v[188:191]
    s_mov_b32 s31, s30
    s_waitcnt lgkmcnt(0)
    s_lshl_b32 s30, s82, 10
    s_add_u32 s30, s30, s77
    v_mfma_f32_16x16x32_bf16 v[128:131], v[80:83], a[0:3], 0
    v_mfma_f32_16x16x32_bf16 v[132:135], v[104:107], a[0:3], 0
    v_mfma_f32_16x16x32_bf16 v[136:139], v[80:83], a[24:27], 0
    v_mfma_f32_16x16x32_bf16 v[140:143], v[104:107], a[24:27], 0
    v_mfma_f32_16x16x32_bf16 v[144:147], v[80:83], a[48:51], 0
    v_mfma_f32_16x16x32_bf16 v[148:151], v[104:107], a[48:51], 0
    v_mfma_f32_16x16x32_bf16 v[152:155], v[80:83], a[72:75], 0
    v_mfma_f32_16x16x32_bf16 v[156:159], v[104:107], a[72:75], 0
    v_cvt_pk_bf16_f32 v208, v160, v161
    v_cvt_pk_bf16_f32 v209, v162, v163
    v_cvt_pk_bf16_f32 v210, v164, v165
    v_cvt_pk_bf16_f32 v211, v166, v167
    s_add_u32 s28, s31, 2621440
    buffer_store_dwordx4 v[208:211], v31, s[4:7], s28 offen sc1
    v_mfma_f32_16x16x32_bf16 v[128:131], v[84:87], a[4:7], v[128:131]
    v_mfma_f32_16x16x32_bf16 v[132:135], v[108:111], a[4:7], v[132:135]
    v_mfma_f32_16x16x32_bf16 v[136:139], v[84:87], a[28:31], v[136:139]
    v_mfma_f32_16x16x32_bf16 v[140:143], v[108:111], a[28:31], v[140:143]
    v_mfma_f32_16x16x32_bf16 v[144:147], v[84:87], a[52:55], v[144:147]
    v_mfma_f32_16x16x32_bf16 v[148:151], v[108:111], a[52:55], v[148:151]
    v_mfma_f32_16x16x32_bf16 v[152:155], v[84:87], a[76:79], v[152:155]
    v_mfma_f32_16x16x32_bf16 v[156:159], v[108:111], a[76:79], v[156:159]
    v_cvt_pk_bf16_f32 v212, v168, v169
    v_cvt_pk_bf16_f32 v213, v170, v171
    v_cvt_pk_bf16_f32 v214, v172, v173
    v_cvt_pk_bf16_f32 v215, v174, v175
    s_add_u32 s28, s31, 3276800
    buffer_store_dwordx4 v[212:215], v31, s[4:7], s28 offen sc1
    v_mfma_f32_16x16x32_bf16 v[128:131], v[88:91], a[8:11], v[128:131]
    v_mfma_f32_16x16x32_bf16 v[132:135], v[112:115], a[8:11], v[132:135]
    v_mfma_f32_16x16x32_bf16 v[136:139], v[88:91], a[32:35], v[136:139]
    v_mfma_f32_16x16x32_bf16 v[140:143], v[112:115], a[32:35], v[140:143]
    v_mfma_f32_16x16x32_bf16 v[144:147], v[88:91], a[56:59], v[144:147]
    v_mfma_f32_16x16x32_bf16 v[148:151], v[112:115], a[56:59], v[148:151]
    v_mfma_f32_16x16x32_bf16 v[152:155], v[88:91], a[80:83], v[152:155]
    v_mfma_f32_16x16x32_bf16 v[156:159], v[112:115], a[80:83], v[156:159]
    v_cvt_pk_bf16_f32 v216, v176, v177
    v_cvt_pk_bf16_f32 v217, v178, v179
    v_cvt_pk_bf16_f32 v218, v180, v181
    v_cvt_pk_bf16_f32 v219, v182, v183
    s_add_u32 s28, s31, 3932160
    buffer_store_dwordx4 v[216:219], v31, s[4:7], s28 offen sc1
    v_mfma_f32_16x16x32_bf16 v[128:131], v[92:95], a[12:15], v[128:131]
    v_mfma_f32_16x16x32_bf16 v[132:135], v[116:119], a[12:15], v[132:135]
    v_mfma_f32_16x16x32_bf16 v[136:139], v[92:95], a[36:39], v[136:139]
    v_mfma_f32_16x16x32_bf16 v[140:143], v[116:119], a[36:39], v[140:143]
    v_mfma_f32_16x16x32_bf16 v[144:147], v[92:95], a[60:63], v[144:147]
    v_mfma_f32_16x16x32_bf16 v[148:151], v[116:119], a[60:63], v[148:151]
    v_mfma_f32_16x16x32_bf16 v[152:155], v[92:95], a[84:87], v[152:155]
    v_mfma_f32_16x16x32_bf16 v[156:159], v[116:119], a[84:87], v[156:159]
    v_cvt_pk_bf16_f32 v220, v184, v185
    v_cvt_pk_bf16_f32 v221, v186, v187
    v_cvt_pk_bf16_f32 v222, v188, v189
    v_cvt_pk_bf16_f32 v223, v190, v191
    s_add_u32 s28, s31, 4587520
    buffer_store_dwordx4 v[220:223], v31, s[4:7], s28 offen sc1
    v_mfma_f32_16x16x32_bf16 v[128:131], v[96:99], a[16:19], v[128:131]
    v_mfma_f32_16x16x32_bf16 v[132:135], v[120:123], a[16:19], v[132:135]
    v_mfma_f32_16x16x32_bf16 v[136:139], v[96:99], a[40:43], v[136:139]
    v_mfma_f32_16x16x32_bf16 v[140:143], v[120:123], a[40:43], v[140:143]
    v_mfma_f32_16x16x32_bf16 v[144:147], v[96:99], a[64:67], v[144:147]
    v_mfma_f32_16x16x32_bf16 v[148:151], v[120:123], a[64:67], v[148:151]
    v_mfma_f32_16x16x32_bf16 v[152:155], v[96:99], a[88:91], v[152:155]
    v_mfma_f32_16x16x32_bf16 v[156:159], v[120:123], a[88:91], v[156:159]
    v_mfma_f32_16x16x32_bf16 v[128:131], v[100:103], a[20:23], v[128:131]
    v_mfma_f32_16x16x32_bf16 v[132:135], v[124:127], a[20:23], v[132:135]
    v_mfma_f32_16x16x32_bf16 v[136:139], v[100:103], a[44:47], v[136:139]
    v_mfma_f32_16x16x32_bf16 v[140:143], v[124:127], a[44:47], v[140:143]
    v_mfma_f32_16x16x32_bf16 v[144:147], v[100:103], a[68:71], v[144:147]
    v_mfma_f32_16x16x32_bf16 v[148:151], v[124:127], a[68:71], v[148:151]
    v_mfma_f32_16x16x32_bf16 v[152:155], v[100:103], a[92:95], v[152:155]
    v_mfma_f32_16x16x32_bf16 v[156:159], v[124:127], a[92:95], v[156:159]
    s_waitcnt vmcnt(16)
    ds_read_b128 v[32:35], v28 offset:12288
    ds_read_b128 v[36:39], v29 offset:12288
    ds_read_b128 v[40:43], v28 offset:13312
    ds_read_b128 v[44:47], v29 offset:13312
    ds_read_b128 v[48:51], v28 offset:14336
    ds_read_b128 v[52:55], v29 offset:14336
    ds_read_b128 v[56:59], v28 offset:12800
    ds_read_b128 v[60:63], v29 offset:12800
    ds_read_b128 v[64:67], v28 offset:13824
    ds_read_b128 v[68:71], v29 offset:13824
    ds_read_b128 v[72:75], v28 offset:14848
    ds_read_b128 v[76:79], v29 offset:14848
    v_mfma_f32_16x16x32_bf16 v[160:163], v[80:83], a[96:99], 0
    v_mfma_f32_16x16x32_bf16 v[164:167], v[104:107], a[96:99], 0
    v_mfma_f32_16x16x32_bf16 v[168:171], v[80:83], a[120:123], 0
    v_mfma_f32_16x16x32_bf16 v[172:175], v[104:107], a[120:123], 0
    v_mfma_f32_16x16x32_bf16 v[176:179], v[80:83], a[144:147], 0
    v_mfma_f32_16x16x32_bf16 v[180:183], v[104:107], a[144:147], 0
    v_mfma_f32_16x16x32_bf16 v[184:187], v[80:83], a[168:171], 0
    v_mfma_f32_16x16x32_bf16 v[188:191], v[104:107], a[168:171], 0
    v_cvt_pk_bf16_f32 v192, v128, v129
    v_cvt_pk_bf16_f32 v193, v130, v131
    v_cvt_pk_bf16_f32 v194, v132, v133
    v_cvt_pk_bf16_f32 v195, v134, v135
    s_add_u32 s28, s30, 0
    buffer_store_dwordx4 v[192:195], v31, s[4:7], s28 offen sc1
    v_mfma_f32_16x16x32_bf16 v[160:163], v[84:87], a[100:103], v[160:163]
    v_mfma_f32_16x16x32_bf16 v[164:167], v[108:111], a[100:103], v[164:167]
    v_mfma_f32_16x16x32_bf16 v[168:171], v[84:87], a[124:127], v[168:171]
    v_mfma_f32_16x16x32_bf16 v[172:175], v[108:111], a[124:127], v[172:175]
    v_mfma_f32_16x16x32_bf16 v[176:179], v[84:87], a[148:151], v[176:179]
    v_mfma_f32_16x16x32_bf16 v[180:183], v[108:111], a[148:151], v[180:183]
    v_mfma_f32_16x16x32_bf16 v[184:187], v[84:87], a[172:175], v[184:187]
    v_mfma_f32_16x16x32_bf16 v[188:191], v[108:111], a[172:175], v[188:191]
    v_cvt_pk_bf16_f32 v196, v136, v137
    v_cvt_pk_bf16_f32 v197, v138, v139
    v_cvt_pk_bf16_f32 v198, v140, v141
    v_cvt_pk_bf16_f32 v199, v142, v143
    s_add_u32 s28, s30, 655360
    buffer_store_dwordx4 v[196:199], v31, s[4:7], s28 offen sc1
    v_mfma_f32_16x16x32_bf16 v[160:163], v[88:91], a[104:107], v[160:163]
    v_mfma_f32_16x16x32_bf16 v[164:167], v[112:115], a[104:107], v[164:167]
    v_mfma_f32_16x16x32_bf16 v[168:171], v[88:91], a[128:131], v[168:171]
    v_mfma_f32_16x16x32_bf16 v[172:175], v[112:115], a[128:131], v[172:175]
    v_mfma_f32_16x16x32_bf16 v[176:179], v[88:91], a[152:155], v[176:179]
    v_mfma_f32_16x16x32_bf16 v[180:183], v[112:115], a[152:155], v[180:183]
    v_mfma_f32_16x16x32_bf16 v[184:187], v[88:91], a[176:179], v[184:187]
    v_mfma_f32_16x16x32_bf16 v[188:191], v[112:115], a[176:179], v[188:191]
    v_cvt_pk_bf16_f32 v200, v144, v145
    v_cvt_pk_bf16_f32 v201, v146, v147
    v_cvt_pk_bf16_f32 v202, v148, v149
    v_cvt_pk_bf16_f32 v203, v150, v151
    s_add_u32 s28, s30, 1310720
    buffer_store_dwordx4 v[200:203], v31, s[4:7], s28 offen sc1
    v_mfma_f32_16x16x32_bf16 v[160:163], v[92:95], a[108:111], v[160:163]
    v_mfma_f32_16x16x32_bf16 v[164:167], v[116:119], a[108:111], v[164:167]
    v_mfma_f32_16x16x32_bf16 v[168:171], v[92:95], a[132:135], v[168:171]
    v_mfma_f32_16x16x32_bf16 v[172:175], v[116:119], a[132:135], v[172:175]
    v_mfma_f32_16x16x32_bf16 v[176:179], v[92:95], a[156:159], v[176:179]
    v_mfma_f32_16x16x32_bf16 v[180:183], v[116:119], a[156:159], v[180:183]
    v_mfma_f32_16x16x32_bf16 v[184:187], v[92:95], a[180:183], v[184:187]
    v_mfma_f32_16x16x32_bf16 v[188:191], v[116:119], a[180:183], v[188:191]
    v_cvt_pk_bf16_f32 v204, v152, v153
    v_cvt_pk_bf16_f32 v205, v154, v155
    v_cvt_pk_bf16_f32 v206, v156, v157
    v_cvt_pk_bf16_f32 v207, v158, v159
    s_add_u32 s28, s30, 1966080
    buffer_store_dwordx4 v[204:207], v31, s[4:7], s28 offen sc1
    v_mfma_f32_16x16x32_bf16 v[160:163], v[96:99], a[112:115], v[160:163]
    v_mfma_f32_16x16x32_bf16 v[164:167], v[120:123], a[112:115], v[164:167]
    v_mfma_f32_16x16x32_bf16 v[168:171], v[96:99], a[136:139], v[168:171]
    v_mfma_f32_16x16x32_bf16 v[172:175], v[120:123], a[136:139], v[172:175]
    v_mfma_f32_16x16x32_bf16 v[176:179], v[96:99], a[160:163], v[176:179]
    v_mfma_f32_16x16x32_bf16 v[180:183], v[120:123], a[160:163], v[180:183]
    v_mfma_f32_16x16x32_bf16 v[184:187], v[96:99], a[184:187], v[184:187]
    v_mfma_f32_16x16x32_bf16 v[188:191], v[120:123], a[184:187], v[188:191]
    v_mfma_f32_16x16x32_bf16 v[160:163], v[100:103], a[116:119], v[160:163]
    v_mfma_f32_16x16x32_bf16 v[164:167], v[124:127], a[116:119], v[164:167]
    v_mfma_f32_16x16x32_bf16 v[168:171], v[100:103], a[140:143], v[168:171]
    v_mfma_f32_16x16x32_bf16 v[172:175], v[124:127], a[140:143], v[172:175]
    v_mfma_f32_16x16x32_bf16 v[176:179], v[100:103], a[164:167], v[176:179]
    v_mfma_f32_16x16x32_bf16 v[180:183], v[124:127], a[164:167], v[180:183]
    v_mfma_f32_16x16x32_bf16 v[184:187], v[100:103], a[188:191], v[184:187]
    v_mfma_f32_16x16x32_bf16 v[188:191], v[124:127], a[188:191], v[188:191]
    s_mov_b32 s31, s30
    s_waitcnt lgkmcnt(0)
    s_lshl_b32 s30, s83, 10
    s_add_u32 s30, s30, s77
    v_mfma_f32_16x16x32_bf16 v[128:131], v[32:35], a[0:3], 0
    v_mfma_f32_16x16x32_bf16 v[132:135], v[56:59], a[0:3], 0
    v_mfma_f32_16x16x32_bf16 v[136:139], v[32:35], a[24:27], 0
    v_mfma_f32_16x16x32_bf16 v[140:143], v[56:59], a[24:27], 0
    v_mfma_f32_16x16x32_bf16 v[144:147], v[32:35], a[48:51], 0
    v_mfma_f32_16x16x32_bf16 v[148:151], v[56:59], a[48:51], 0
    v_mfma_f32_16x16x32_bf16 v[152:155], v[32:35], a[72:75], 0
    v_mfma_f32_16x16x32_bf16 v[156:159], v[56:59], a[72:75], 0
    v_cvt_pk_bf16_f32 v208, v160, v161
    v_cvt_pk_bf16_f32 v209, v162, v163
    v_cvt_pk_bf16_f32 v210, v164, v165
    v_cvt_pk_bf16_f32 v211, v166, v167
    s_add_u32 s28, s31, 2621440
    buffer_store_dwordx4 v[208:211], v31, s[4:7], s28 offen sc1
    v_mfma_f32_16x16x32_bf16 v[128:131], v[36:39], a[4:7], v[128:131]
    v_mfma_f32_16x16x32_bf16 v[132:135], v[60:63], a[4:7], v[132:135]
    v_mfma_f32_16x16x32_bf16 v[136:139], v[36:39], a[28:31], v[136:139]
    v_mfma_f32_16x16x32_bf16 v[140:143], v[60:63], a[28:31], v[140:143]
    v_mfma_f32_16x16x32_bf16 v[144:147], v[36:39], a[52:55], v[144:147]
    v_mfma_f32_16x16x32_bf16 v[148:151], v[60:63], a[52:55], v[148:151]
    v_mfma_f32_16x16x32_bf16 v[152:155], v[36:39], a[76:79], v[152:155]
    v_mfma_f32_16x16x32_bf16 v[156:159], v[60:63], a[76:79], v[156:159]
    v_cvt_pk_bf16_f32 v212, v168, v169
    v_cvt_pk_bf16_f32 v213, v170, v171
    v_cvt_pk_bf16_f32 v214, v172, v173
    v_cvt_pk_bf16_f32 v215, v174, v175
    s_add_u32 s28, s31, 3276800
    buffer_store_dwordx4 v[212:215], v31, s[4:7], s28 offen sc1
    v_mfma_f32_16x16x32_bf16 v[128:131], v[40:43], a[8:11], v[128:131]
    v_mfma_f32_16x16x32_bf16 v[132:135], v[64:67], a[8:11], v[132:135]
    v_mfma_f32_16x16x32_bf16 v[136:139], v[40:43], a[32:35], v[136:139]
    v_mfma_f32_16x16x32_bf16 v[140:143], v[64:67], a[32:35], v[140:143]
    v_mfma_f32_16x16x32_bf16 v[144:147], v[40:43], a[56:59], v[144:147]
    v_mfma_f32_16x16x32_bf16 v[148:151], v[64:67], a[56:59], v[148:151]
    v_mfma_f32_16x16x32_bf16 v[152:155], v[40:43], a[80:83], v[152:155]
    v_mfma_f32_16x16x32_bf16 v[156:159], v[64:67], a[80:83], v[156:159]
    v_cvt_pk_bf16_f32 v216, v176, v177
    v_cvt_pk_bf16_f32 v217, v178, v179
    v_cvt_pk_bf16_f32 v218, v180, v181
    v_cvt_pk_bf16_f32 v219, v182, v183
    s_add_u32 s28, s31, 3932160
    buffer_store_dwordx4 v[216:219], v31, s[4:7], s28 offen sc1
    v_mfma_f32_16x16x32_bf16 v[128:131], v[44:47], a[12:15], v[128:131]
    v_mfma_f32_16x16x32_bf16 v[132:135], v[68:71], a[12:15], v[132:135]
    v_mfma_f32_16x16x32_bf16 v[136:139], v[44:47], a[36:39], v[136:139]
    v_mfma_f32_16x16x32_bf16 v[140:143], v[68:71], a[36:39], v[140:143]
    v_mfma_f32_16x16x32_bf16 v[144:147], v[44:47], a[60:63], v[144:147]
    v_mfma_f32_16x16x32_bf16 v[148:151], v[68:71], a[60:63], v[148:151]
    v_mfma_f32_16x16x32_bf16 v[152:155], v[44:47], a[84:87], v[152:155]
    v_mfma_f32_16x16x32_bf16 v[156:159], v[68:71], a[84:87], v[156:159]
    v_cvt_pk_bf16_f32 v220, v184, v185
    v_cvt_pk_bf16_f32 v221, v186, v187
    v_cvt_pk_bf16_f32 v222, v188, v189
    v_cvt_pk_bf16_f32 v223, v190, v191
    s_add_u32 s28, s31, 4587520
    buffer_store_dwordx4 v[220:223], v31, s[4:7], s28 offen sc1
    v_mfma_f32_16x16x32_bf16 v[128:131], v[48:51], a[16:19], v[128:131]
    v_mfma_f32_16x16x32_bf16 v[132:135], v[72:75], a[16:19], v[132:135]
    v_mfma_f32_16x16x32_bf16 v[136:139], v[48:51], a[40:43], v[136:139]
    v_mfma_f32_16x16x32_bf16 v[140:143], v[72:75], a[40:43], v[140:143]
    v_mfma_f32_16x16x32_bf16 v[144:147], v[48:51], a[64:67], v[144:147]
    v_mfma_f32_16x16x32_bf16 v[148:151], v[72:75], a[64:67], v[148:151]
    v_mfma_f32_16x16x32_bf16 v[152:155], v[48:51], a[88:91], v[152:155]
    v_mfma_f32_16x16x32_bf16 v[156:159], v[72:75], a[88:91], v[156:159]
    v_mfma_f32_16x16x32_bf16 v[128:131], v[52:55], a[20:23], v[128:131]
    v_mfma_f32_16x16x32_bf16 v[132:135], v[76:79], a[20:23], v[132:135]
    v_mfma_f32_16x16x32_bf16 v[136:139], v[52:55], a[44:47], v[136:139]
    v_mfma_f32_16x16x32_bf16 v[140:143], v[76:79], a[44:47], v[140:143]
    v_mfma_f32_16x16x32_bf16 v[144:147], v[52:55], a[68:71], v[144:147]
    v_mfma_f32_16x16x32_bf16 v[148:151], v[76:79], a[68:71], v[148:151]
    v_mfma_f32_16x16x32_bf16 v[152:155], v[52:55], a[92:95], v[152:155]
    v_mfma_f32_16x16x32_bf16 v[156:159], v[76:79], a[92:95], v[156:159]
    v_mfma_f32_16x16x32_bf16 v[160:163], v[32:35], a[96:99], 0
    v_mfma_f32_16x16x32_bf16 v[164:167], v[56:59], a[96:99], 0
    v_mfma_f32_16x16x32_bf16 v[168:171], v[32:35], a[120:123], 0
    v_mfma_f32_16x16x32_bf16 v[172:175], v[56:59], a[120:123], 0
    v_mfma_f32_16x16x32_bf16 v[176:179], v[32:35], a[144:147], 0
    v_mfma_f32_16x16x32_bf16 v[180:183], v[56:59], a[144:147], 0
    v_mfma_f32_16x16x32_bf16 v[184:187], v[32:35], a[168:171], 0
    v_mfma_f32_16x16x32_bf16 v[188:191], v[56:59], a[168:171], 0
    v_cvt_pk_bf16_f32 v192, v128, v129
    v_cvt_pk_bf16_f32 v193, v130, v131
    v_cvt_pk_bf16_f32 v194, v132, v133
    v_cvt_pk_bf16_f32 v195, v134, v135
    s_add_u32 s28, s30, 0
    buffer_store_dwordx4 v[192:195], v31, s[4:7], s28 offen sc1
    v_mfma_f32_16x16x32_bf16 v[160:163], v[36:39], a[100:103], v[160:163]
    v_mfma_f32_16x16x32_bf16 v[164:167], v[60:63], a[100:103], v[164:167]
    v_mfma_f32_16x16x32_bf16 v[168:171], v[36:39], a[124:127], v[168:171]
    v_mfma_f32_16x16x32_bf16 v[172:175], v[60:63], a[124:127], v[172:175]
    v_mfma_f32_16x16x32_bf16 v[176:179], v[36:39], a[148:151], v[176:179]
    v_mfma_f32_16x16x32_bf16 v[180:183], v[60:63], a[148:151], v[180:183]
    v_mfma_f32_16x16x32_bf16 v[184:187], v[36:39], a[172:175], v[184:187]
    v_mfma_f32_16x16x32_bf16 v[188:191], v[60:63], a[172:175], v[188:191]
    v_cvt_pk_bf16_f32 v196, v136, v137
    v_cvt_pk_bf16_f32 v197, v138, v139
    v_cvt_pk_bf16_f32 v198, v140, v141
    v_cvt_pk_bf16_f32 v199, v142, v143
    s_add_u32 s28, s30, 655360
    buffer_store_dwordx4 v[196:199], v31, s[4:7], s28 offen sc1
    v_mfma_f32_16x16x32_bf16 v[160:163], v[40:43], a[104:107], v[160:163]
    v_mfma_f32_16x16x32_bf16 v[164:167], v[64:67], a[104:107], v[164:167]
    v_mfma_f32_16x16x32_bf16 v[168:171], v[40:43], a[128:131], v[168:171]
    v_mfma_f32_16x16x32_bf16 v[172:175], v[64:67], a[128:131], v[172:175]
    v_mfma_f32_16x16x32_bf16 v[176:179], v[40:43], a[152:155], v[176:179]
    v_mfma_f32_16x16x32_bf16 v[180:183], v[64:67], a[152:155], v[180:183]
    v_mfma_f32_16x16x32_bf16 v[184:187], v[40:43], a[176:179], v[184:187]
    v_mfma_f32_16x16x32_bf16 v[188:191], v[64:67], a[176:179], v[188:191]
    v_cvt_pk_bf16_f32 v200, v144, v145
    v_cvt_pk_bf16_f32 v201, v146, v147
    v_cvt_pk_bf16_f32 v202, v148, v149
    v_cvt_pk_bf16_f32 v203, v150, v151
    s_add_u32 s28, s30, 1310720
    buffer_store_dwordx4 v[200:203], v31, s[4:7], s28 offen sc1
    v_mfma_f32_16x16x32_bf16 v[160:163], v[44:47], a[108:111], v[160:163]
    v_mfma_f32_16x16x32_bf16 v[164:167], v[68:71], a[108:111], v[164:167]
    v_mfma_f32_16x16x32_bf16 v[168:171], v[44:47], a[132:135], v[168:171]
    v_mfma_f32_16x16x32_bf16 v[172:175], v[68:71], a[132:135], v[172:175]
    v_mfma_f32_16x16x32_bf16 v[176:179], v[44:47], a[156:159], v[176:179]
    v_mfma_f32_16x16x32_bf16 v[180:183], v[68:71], a[156:159], v[180:183]
    v_mfma_f32_16x16x32_bf16 v[184:187], v[44:47], a[180:183], v[184:187]
    v_mfma_f32_16x16x32_bf16 v[188:191], v[68:71], a[180:183], v[188:191]
    v_cvt_pk_bf16_f32 v204, v152, v153
    v_cvt_pk_bf16_f32 v205, v154, v155
    v_cvt_pk_bf16_f32 v206, v156, v157
    v_cvt_pk_bf16_f32 v207, v158, v159
    s_add_u32 s28, s30, 1966080
    buffer_store_dwordx4 v[204:207], v31, s[4:7], s28 offen sc1
    v_mfma_f32_16x16x32_bf16 v[160:163], v[48:51], a[112:115], v[160:163]
    v_mfma_f32_16x16x32_bf16 v[164:167], v[72:75], a[112:115], v[164:167]
    v_mfma_f32_16x16x32_bf16 v[168:171], v[48:51], a[136:139], v[168:171]
    v_mfma_f32_16x16x32_bf16 v[172:175], v[72:75], a[136:139], v[172:175]
    v_mfma_f32_16x16x32_bf16 v[176:179], v[48:51], a[160:163], v[176:179]
    v_mfma_f32_16x16x32_bf16 v[180:183], v[72:75], a[160:163], v[180:183]
    v_mfma_f32_16x16x32_bf16 v[184:187], v[48:51], a[184:187], v[184:187]
    v_mfma_f32_16x16x32_bf16 v[188:191], v[72:75], a[184:187], v[188:191]
    v_mfma_f32_16x16x32_bf16 v[160:163], v[52:55], a[116:119], v[160:163]
    v_mfma_f32_16x16x32_bf16 v[164:167], v[76:79], a[116:119], v[164:167]
    v_mfma_f32_16x16x32_bf16 v[168:171], v[52:55], a[140:143], v[168:171]
    v_mfma_f32_16x16x32_bf16 v[172:175], v[76:79], a[140:143], v[172:175]
    v_mfma_f32_16x16x32_bf16 v[176:179], v[52:55], a[164:167], v[176:179]
    v_mfma_f32_16x16x32_bf16 v[180:183], v[76:79], a[164:167], v[180:183]
    v_mfma_f32_16x16x32_bf16 v[184:187], v[52:55], a[188:191], v[184:187]
    v_mfma_f32_16x16x32_bf16 v[188:191], v[76:79], a[188:191], v[188:191]
    s_mov_b32 s31, s30
    v_cvt_pk_bf16_f32 v208, v160, v161
    v_cvt_pk_bf16_f32 v209, v162, v163
    v_cvt_pk_bf16_f32 v210, v164, v165
    v_cvt_pk_bf16_f32 v211, v166, v167
    s_add_u32 s28, s31, 2621440
    buffer_store_dwordx4 v[208:211], v31, s[4:7], s28 offen sc1
    v_cvt_pk_bf16_f32 v212, v168, v169
    v_cvt_pk_bf16_f32 v213, v170, v171
    v_cvt_pk_bf16_f32 v214, v172, v173
    v_cvt_pk_bf16_f32 v215, v174, v175
    s_add_u32 s28, s31, 3276800
    buffer_store_dwordx4 v[212:215], v31, s[4:7], s28 offen sc1
    v_cvt_pk_bf16_f32 v216, v176, v177
    v_cvt_pk_bf16_f32 v217, v178, v179
    v_cvt_pk_bf16_f32 v218, v180, v181
    v_cvt_pk_bf16_f32 v219, v182, v183
    s_add_u32 s28, s31, 3932160
    buffer_store_dwordx4 v[216:219], v31, s[4:7], s28 offen sc1
    v_cvt_pk_bf16_f32 v220, v184, v185
    v_cvt_pk_bf16_f32 v221, v186, v187
    v_cvt_pk_bf16_f32 v222, v188, v189
    v_cvt_pk_bf16_f32 v223, v190, v191
    s_add_u32 s28, s31, 4587520
    buffer_store_dwordx4 v[220:223], v31, s[4:7], s28 offen sc1
    s_branch L_adone
L_repack:
    v_mov_b32 v255, 0
    s_nop 0
    v_readfirstlane_b32 s28, v255
    s_nop 0
    s_cmp_lg_u32 s28, 0
    s_cbranch_scc1 Lcfd_4
    v_mov_b32 v5, 0
Lcf_3:
    s_sleep 4
    buffer_load_dword v255, v5, s[20:23], 0 offen offset:144 sc1
    s_sub_u32 s27, s27, 1
    s_cbranch_scc1 L_exit
    s_waitcnt vmcnt(0)
    v_readfirstlane_b32 s28, v255
    s_nop 0
    s_cmp_eq_u32 s28, 0
    s_cbranch_scc1 Lcf_3
Lcfd_4:
    s_cmp_lg_u32 s28, s3
    s_cbranch_scc1 L_redo
    s_sub_u32 s74, s73, 160
    s_mov_b32 s16, s34
    s_mov_b32 s17, s35
    s_mov_b32 s18, 0x2800
    s_mov_b32 s19, 0x20000
    v_mov_b32 v208, -1
    v_mov_b32 v209, -1
    v_mov_b32 v210, -1
    v_mov_b32 v211, -1
    v_mov_b32 v212, 0
    v_mov_b32 v213, 0
    v_mov_b32 v214, 0
    v_mov_b32 v215, 0
    v_lshlrev_b32 v6, 4, v0
    s_cmp_lt_u32 s74, 3
    s_cbranch_scc1 L_probe
L_fill:
    s_add_u32 s74, s74, 24
    s_and_b32 s74, s74, 31
    s_lshl_b32 s28, s74, 13
    s_add_u32 s28, s28, 0xc000000
    buffer_store_dwordx4 v[208:211], v6, s[4:7], s28 offen sc1
    s_add_u32 s28, s28, 4096
    buffer_store_dwordx4 v[208:211], v6, s[4:7], s28 offen sc1
    s_add_u32 s28, s28, 258048
    buffer_store_dwordx4 v[208:211], v6, s[4:7], s28 offen sc1
    s_add_u32 s28, s28, 4096
    buffer_store_dwordx4 v[208:211], v6, s[4:7], s28 offen sc1
    s_add_u32 s28, s28, 258048
    buffer_store_dwordx4 v[208:211], v6, s[4:7], s28 offen sc1
    s_add_u32 s28, s28, 4096
    buffer_store_dwordx4 v[208:211], v6, s[4:7], s28 offen sc1
    s_add_u32 s28, s28, 258048
    buffer_store_dwordx4 v[208:211], v6, s[4:7], s28 offen sc1
    s_add_u32 s28, s28, 4096
    buffer_store_dwordx4 v[208:211], v6, s[4:7], s28 offen sc1
    s_add_u32 s28, s28, 258048
    buffer_store_dwordx4 v[208:211], v6, s[4:7], s28 offen sc1
    s_add_u32 s28, s28, 4096
    buffer_store_dwordx4 v[208:211], v6, s[4:7], s28 offen sc1
    s_add_u32 s28, s28, 258048
    buffer_store_dwordx4 v[208:211], v6, s[4:7], s28 offen sc1
    s_add_u32 s28, s28, 4096
    buffer_store_dwordx4 v[208:211], v6, s[4:7], s28 offen sc1
    s_add_u32 s28, s28, 258048
    buffer_store_dwordx4 v[208:211], v6, s[4:7], s28 offen sc1
    s_add_u32 s28, s28, 4096
    buffer_store_dwordx4 v[208:211], v6, s[4:7], s28 offen sc1
    s_add_u32 s28, s28, 258048
    buffer_store_dwordx4 v[208:211], v6, s[4:7], s28 offen sc1
    s_add_u32 s28, s28, 4096
    buffer_store_dwordx4 v[208:211], v6, s[4:7], s28 offen sc1
    s_add_u32 s28, s28, 258048
    buffer_store_dwordx4 v[208:211], v6, s[4:7], s28 offen sc1
    s_add_u32 s28, s28, 4096
    buffer_store_dwordx4 v[208:211], v6, s[4:7], s28 offen sc1
    s_add_u32 s28, s28, 258048
    buffer_store_dwordx4 v[208:211], v6, s[4:7], s28 offen sc1
    s_add_u32 s28, s28, 4096
    buffer_store_dwordx4 v[208:211], v6, s[4:7], s28 offen sc1
    s_add_u32 s28, s28, 258048
    buffer_store_dwordx4 v[208:211], v6, s[4:7], s28 offen sc1
    s_add_u32 s28, s28, 4096
    buffer_store_dwordx4 v[208:211], v6, s[4:7], s28 offen sc1
    s_add_u32 s28, s28, 258048
    buffer_store_dwordx4 v[208:211], v6, s[4:7], s28 offen sc1
    s_add_u32 s28, s28, 4096
    buffer_store_dwordx4 v[208:211], v6, s[4:7], s28 offen sc1
    s_add_u32 s28, s28, 258048
    buffer_store_dwordx4 v[208:211], v6, s[4:7], s28 offen sc1
    s_add_u32 s28, s28, 4096
    buffer_store_dwordx4 v[208:211], v6, s[4:7], s28 offen sc1
    s_add_u32 s28, s28, 258048
    buffer_store_dwordx4 v[208:211], v6, s[4:7], s28 offen sc1
    s_add_u32 s28, s28, 4096
    buffer_store_dwordx4 v[208:211], v6, s[4:7], s28 offen sc1
    s_add_u32 s28, s28, 258048
    buffer_store_dwordx4 v[208:211], v6, s[4:7], s28 offen sc1
    s_add_u32 s28, s28, 4096
    buffer_store_dwordx4 v[208:211], v6, s[4:7], s28 offen sc1
    s_add_u32 s28, s28, 258048
    buffer_store_dwordx4 v[208:211], v6, s[4:7], s28 offen sc1
    s_add_u32 s28, s28, 4096
    buffer_store_dwordx4 v[208:211], v6, s[4:7], s28 offen sc1
    s_add_u32 s28, s28, 258048
    buffer_store_dwordx4 v[208:211], v6, s[4:7], s28 offen sc1
    s_add_u32 s28, s28, 4096
    buffer_store_dwordx4 v[208:211], v6, s[4:7], s28 offen sc1
    s_add_u32 s28, s28, 258048
    s_sub_u32 s28, s74, 8
    s_cmp_ge_u32 s28, 9
    s_cbranch_scc1 Lf_5
    s_lshl_b32 s28, s28, 12
    s_add_u32 s28, s28, 0xba10000
    buffer_store_dwordx4 v[212:215], v6, s[4:7], s28 offen sc1
Lf_5:
    s_mul_i32 s28, s74, 196608
    s_add_u32 s28, s28, 0x422f000
    buffer_store_dwordx4 v[208:211], v6, s[4:7], s28 offen sc1
    s_cmp_ge_u32 s74, 8
    s_cbranch_scc1 L_fdone
    s_waitcnt vmcnt(0)
    s_barrier
    v_bfe_u32 v5, v0, 4, 2
    v_lshlrev_b32 v5, 1, v5
    v_bfe_u32 v6, v0, 2, 1
    v_add_u32 v5, v5, v6
    v_mul_u32_u24 v5, 320, v5
    v_bfe_u32 v6, v0, 3, 1
    v_add_u32 v5, v5, v6
    v_lshrrev_b32 v6, 6, v0
    v_lshl_add_u32 v5, v6, 3, v5
    v_and_b32 v6, 3, v0
    v_lshl_add_u32 v5, v6, 1, v5
    v_lshlrev_b32 v5, 2, v5
    v_lshlrev_b32 v6, 2, v0
    s_lshl_b32 s29, s74, 13
    s_add_u32 s29, s29, 0xc001400
    s_lshr_b32 s74, s74, 1
    s_lshl_b32 s28, s74, 8
    buffer_load_dword v7, v5, s[16:19], s28 offen offset:0
    s_waitcnt vmcnt(0)
    v_min_u32 v7, -2, v7
    buffer_store_dword v7, v6, s[4:7], s29 offen offset:0 sc1
    s_lshl_b32 s28, s74, 8
    buffer_load_dword v7, v5, s[16:19], s28 offen offset:128
    s_waitcnt vmcnt(0)
    v_min_u32 v7, -2, v7
    buffer_store_dword v7, v6, s[4:7], s29 offen offset:1024 sc1
    s_lshl_b32 s28, s74, 6
    buffer_load_dword v7, v5, s[16:19], s28 offen offset:1024
    s_waitcnt vmcnt(0)
    v_min_u32 v7, -2, v7
    buffer_store_dword v7, v6, s[4:7], s29 offen offset:2048 sc1
    s_branch L_fdone
L_probe:
    s_cmp_lg_u32 s24, 0
    s_cbranch_scc1 L_probe_e
    s_lshl_b32 s29, s74, 21
    s_mov_b32 exec_hi, 0
    s_add_u32 s28, s29, 0xc021e00
    buffer_store_dwordx4 v[208:211], v4, s[4:7], s28 offen sc1
    s_add_u32 s28, s29, 0xc025e00
    buffer_store_dwordx4 v[208:211], v4, s[4:7], s28 offen sc1
    s_add_u32 s28, s29, 0xc029e00
    buffer_store_dwordx4 v[208:211], v4, s[4:7], s28 offen sc1
    s_add_u32 s28, s29, 0xc023e00
    buffer_store_dwordx4 v[208:211], v4, s[4:7], s28 offen sc1
    s_add_u32 s28, s29, 0xc027e00
    buffer_store_dwordx4 v[208:211], v4, s[4:7], s28 offen sc1
    s_add_u32 s28, s29, 0xc02be00
    buffer_store_dwordx4 v[208:211], v4, s[4:7], s28 offen sc1
    s_mov_b64 exec, 1
    v_mov_b32 v5, 0
    s_mov_b32 s76, -1
    s_mov_b32 s77, -1
    s_waitcnt vmcnt(0)
    s_add_u32 s30, s29, 512
L_probe_l:
    s_add_u32 s28, s29, 0xc021e00
    s_memtime s[90:91]
    s_waitcnt lgkmcnt(0)
    buffer_load_dword v7, v5, s[4:7], s28 offen sc1
    s_waitcnt vmcnt(0)
    s_memtime s[88:89]
    s_waitcnt lgkmcnt(0)
    s_sub_u32 s90, s88, s90
    s_min_u32 s76, s76, s90
    s_add_u32 s28, s29, 0xc023e00
    s_memtime s[90:91]
    s_waitcnt lgkmcnt(0)
    buffer_load_dword v7, v5, s[4:7], s28 offen sc1
    s_waitcnt vmcnt(0)
    s_memtime s[88:89]
    s_waitcnt lgkmcnt(0)
    s_sub_u32 s90, s88, s90
    s_min_u32 s77, s77, s90
    s_add_u32 s28, s29, 0xc025e00
    s_memtime s[90:91]
    s_waitcnt lgkmcnt(0)
    buffer_load_dword v7, v5, s[4:7], s28 offen sc1
    s_waitcnt vmcnt(0)
    s_memtime s[88:89]
    s_waitcnt lgkmcnt(0)
    s_sub_u32 s90, s88, s90
    s_min_u32 s76, s76, s90
    s_add_u32 s28, s29, 0xc027e00
    s_memtime s[90:91]
    s_waitcnt lgkmcnt(0)
    buffer_load_dword v7, v5, s[4:7], s28 offen sc1
    s_waitcnt vmcnt(0)
    s_memtime s[88:89]
    s_waitcnt lgkmcnt(0)
    s_sub_u32 s90, s88, s90
    s_min_u32 s77, s77, s90
    s_add_u32 s28, s29, 0xc029e00
    s_memtime s[90:91]
    s_waitcnt lgkmcnt(0)
    buffer_load_dword v7, v5, s[4:7], s28 offen sc1
    s_waitcnt vmcnt(0)
    s_memtime s[88:89]
    s_waitcnt lgkmcnt(0)
    s_sub_u32 s90, s88, s90
    s_min_u32 s76, s76, s90
    s_add_u32 s28, s29, 0xc02be00
    s_memtime s[90:91]
    s_waitcnt lgkmcnt(0)
    buffer_load_dword v7, v5, s[4:7], s28 offen sc1
    s_waitcnt vmcnt(0)
    s_memtime s[88:89]
    s_waitcnt lgkmcnt(0)
    s_sub_u32 s90, s88, s90
    s_min_u32 s77, s77, s90
    s_add_u32 s29, s29, 128
    s_min_u32 s28, s76, s77
    s_cmp_lt_u32 s28, 460
    s_cbranch_scc1 L_probe_d
    s_cmp_lt_u32 s29, s30
    s_cbranch_scc1 L_probe_l
L_probe_d:
    s_cmp_lt_u32 s77, s76
    s_cselect_b32 s28, 1, 0
    v_mov_b32 v7, s28
    buffer_store_byte v7, v5, s[20:23], s74 offen offset:136 sc1
    s_mov_b64 exec, -1
L_probe_e:
    s_barrier
    s_branch L_fill
L_fdone:
    s_waitcnt vmcnt(0)
    s_barrier
    s_cmp_lg_u32 s24, 0
    s_cbranch_scc1 L_dispatch
    v_mov_b32 v5, 0
    v_mov_b32 v6, 1
    s_mov_b64 exec, 1
    buffer_atomic_add v6, v5, s[20:23], 0 offen offset:4 sc0 sc1
    s_waitcnt vmcnt(0)
    v_cmp_eq_u32 vcc, 31, v6
    s_cbranch_vccz Lar_6
    buffer_store_dword v6, v5, s[20:23], 0 offen offset:132 sc1
Lar_6:
    s_mov_b64 exec, -1
    s_branch L_dispatch
L_adone:
    s_waitcnt vmcnt(0)
    s_barrier
    s_cmp_lg_u32 s24, 0
    s_cbranch_scc1 L_dispatch
    v_mov_b32 v5, 0
    v_mov_b32 v6, 1
    s_mov_b64 exec, 1
    buffer_atomic_add v6, v5, s[20:23], 0 offen offset:0 sc0 sc1
    s_waitcnt vmcnt(0)
    v_cmp_eq_u32 vcc, 159, v6
    s_cbranch_vccz Lar_7
    buffer_store_dword v6, v5, s[20:23], 0 offen offset:128 sc1
Lar_7:
    s_mov_b64 exec, -1
L_dispatch:
    s_mov_b32 s26, 0
    s_cmp_eq_u32 s72, 0
    s_cbranch_scc1 L_r1
    s_cmp_eq_u32 s72, 1
    s_cbranch_scc1 L_r2
    s_cmp_eq_u32 s72, 2
    s_cbranch_scc1 L_k
    s_cmp_eq_u32 s72, 3
    s_cbranch_scc1 L_q
    s_cmp_eq_u32 s72, 4
    s_cbranch_scc1 L_s5
    s_cmp_eq_u32 s72, 6
    s_cbranch_scc1 L_up
    s_cmp_eq_u32 s72, 7
    s_cbranch_scc1 L_k
    s_branch L_out
L_r1:
    s_mov_b32 s12, s36
    s_mov_b32 s13, s37
    s_mov_b32 s14, 0x780000
    s_mov_b32 s15, 0x20000
    s_mov_b32 s16, s38
    s_mov_b32 s17, s39
    s_mov_b32 s18, 0x780000
    s_mov_b32 s19, 0x20000
    s_and_b32 s28, s24, 1
    s_lshl_b32 s28, s28, 2
    v_and_b32 v5, 1, v3
    v_lshlrev_b32 v5, 1, v5
    v_add_u32 v5, s28, v5
    v_and_b32 v6, 7, v1
    v_xor_b32 v5, v5, v6
    v_lshrrev_b32 v6, 3, v1
    v_mul_u32_u24 v6, 12288, v6
    v_lshl_add_u32 v16, v5, 4, v6
    s_mul_i32 s90, s24, 98304
    s_mul_i32 s28, s25, 384
    s_add_u32 s90, s90, s28
    s_mul_i32 s95, s24, 3072
    s_add_u32 s29, s90, 0
    s_add_u32 m0, s95, 0
    s_nop 0
    buffer_load_dwordx4 v16, s[12:15], s29 offen offset:0 nt lds
    s_add_u32 m0, s95, 896
    s_nop 0
    buffer_load_dwordx4 v16, s[12:15], s29 offen offset:128 nt lds
    s_add_u32 m0, s95, 1792
    s_nop 0
    buffer_load_dwordx4 v16, s[12:15], s29 offen offset:256 nt lds
    s_add_u32 s29, s90, 393216
    s_add_u32 m0, s95, 12288
    s_nop 0
    buffer_load_dwordx4 v16, s[12:15], s29 offen offset:0 nt lds
    s_add_u32 m0, s95, 13184
    s_nop 0
    buffer_load_dwordx4 v16, s[12:15], s29 offen offset:128 nt lds
    s_add_u32 m0, s95, 14080
    s_nop 0
    buffer_load_dwordx4 v16, s[12:15], s29 offen offset:256 nt lds
    s_add_u32 s29, s90, 786432
    s_add_u32 m0, s95, 24576
    s_nop 0
    buffer_load_dwordx4 v16, s[12:15], s29 offen offset:0 nt lds
    s_add_u32 m0, s95, 25472
    s_nop 0
    buffer_load_dwordx4 v16, s[12:15], s29 offen offset:128 nt lds
    s_add_u32 m0, s95, 26368
    s_nop 0
    buffer_load_dwordx4 v16, s[12:15], s29 offen offset:256 nt lds
    v_mov_b32 v5, 0
    buffer_load_dword v255, v5, s[20:23], 0 offen offset:144 sc1
    s_add_u32 s29, s90, 1179648
    s_add_u32 m0, s95, 36864
    s_nop 0
    buffer_load_dwordx4 v16, s[12:15], s29 offen offset:0 nt lds
    s_add_u32 m0, s95, 37760
    s_nop 0
    buffer_load_dwordx4 v16, s[12:15], s29 offen offset:128 nt lds
    s_add_u32 m0, s95, 38656
    s_nop 0
    buffer_load_dwordx4 v16, s[12:15], s29 offen offset:256 nt lds
    s_add_u32 s29, s90, 1572864
    s_add_u32 m0, s95, 49152
    s_nop 0
    buffer_load_dwordx4 v16, s[12:15], s29 offen offset:0 nt lds
    s_add_u32 m0, s95, 50048
    s_nop 0
    buffer_load_dwordx4 v16, s[12:15], s29 offen offset:128 nt lds
    s_add_u32 m0, s95, 50944
    s_nop 0
    buffer_load_dwordx4 v16, s[12:15], s29 offen offset:256 nt lds
    s_add_u32 s29, s90, 1966080
    s_add_u32 m0, s95, 61440
    s_nop 0
    buffer_load_dwordx4 v16, s[12:15], s29 offen offset:0 nt lds
    s_add_u32 m0, s95, 62336
    s_nop 0
    buffer_load_dwordx4 v16, s[12:15], s29 offen offset:128 nt lds
    s_add_u32 m0, s95, 63232
    s_nop 0
    buffer_load_dwordx4 v16, s[12:15], s29 offen offset:256 nt lds
    s_add_u32 s29, s90, 2359296
    s_add_u32 m0, s95, 73728
    s_nop 0
    buffer_load_dwordx4 v16, s[12:15], s29 offen offset:0 nt lds
    s_add_u32 m0, s95, 74624
    s_nop 0
    buffer_load_dwordx4 v16, s[12:15], s29 offen offset:128 nt lds
    s_add_u32 m0, s95, 75520
    s_nop 0
    buffer_load_dwordx4 v16, s[12:15], s29 offen offset:256 nt lds
    s_add_u32 s29, s90, 2752512
    s_add_u32 m0, s95, 86016
    s_nop 0
    buffer_load_dwordx4 v16, s[12:15], s29 offen offset:0 nt lds
    s_add_u32 m0, s95, 86912
    s_nop 0
    buffer_load_dwordx4 v16, s[12:15], s29 offen offset:128 nt lds
    s_add_u32 m0, s95, 87808
    s_nop 0
    buffer_load_dwordx4 v16, s[12:15], s29 offen offset:256 nt lds
    s_add_u32 s29, s90, 3145728
    s_add_u32 m0, s95, 98304
    s_nop 0
    buffer_load_dwordx4 v16, s[12:15], s29 offen offset:0 nt lds
    s_add_u32 m0, s95, 99200
    s_nop 0
    buffer_load_dwordx4 v16, s[12:15], s29 offen offset:128 nt lds
    s_add_u32 m0, s95, 100096
    s_nop 0
    buffer_load_dwordx4 v16, s[12:15], s29 offen offset:256 nt lds
    s_add_u32 s29, s90, 3538944
    s_add_u32 m0, s95, 110592
    s_nop 0
    buffer_load_dwordx4 v16, s[12:15], s29 offen offset:0 nt lds
    s_add_u32 m0, s95, 111488
    s_nop 0
    buffer_load_dwordx4 v16, s[12:15], s29 offen offset:128 nt lds
    s_add_u32 m0, s95, 112384
    s_nop 0
    buffer_load_dwordx4 v16, s[12:15], s29 offen offset:256 nt lds
    s_add_u32 s29, s90, 3932160
    s_add_u32 m0, s95, 122880
    s_nop 0
    buffer_load_dwordx4 v16, s[12:15], s29 offen offset:0 nt lds
    s_add_u32 m0, s95, 123776
    s_nop 0
    buffer_load_dwordx4 v16, s[12:15], s29 offen offset:128 nt lds
    s_add_u32 m0, s95, 124672
    s_nop 0
    buffer_load_dwordx4 v16, s[12:15], s29 offen offset:256 nt lds
    s_add_u32 s29, s90, 4325376
    s_add_u32 m0, s95, 135168
    s_nop 0
    buffer_load_dwordx4 v16, s[12:15], s29 offen offset:0 nt lds
    s_add_u32 m0, s95, 136064
    s_nop 0
    buffer_load_dwordx4 v16, s[12:15], s29 offen offset:128 nt lds
    s_add_u32 m0, s95, 136960
    s_nop 0
    buffer_load_dwordx4 v16, s[12:15], s29 offen offset:256 nt lds
    v_and_b32 v5, 1, v3
    v_lshlrev_b32 v5, 1, v5
    v_lshrrev_b32 v6, 3, v2
    v_add_u32 v5, v5, v6
    v_mul_u32_u24 v6, 3072, v3
    v_lshrrev_b32 v7, 2, v2
    v_lshl_add_u32 v6, v7, 7, v6
    v_and_b32 v7, 3, v2
    v_lshl_add_u32 v6, v7, 3, v6
    s_mul_i32 s28, s24, 3
    s_add_u32 s28, s28, 0
    s_and_b32 s29, s28, 3
    s_lshr_b32 s28, s28, 2
    s_lshl_b32 s28, s28, 10
    s_add_u32 s28, s28, 0
    v_xor_b32 v7, s29, v5
    v_lshl_add_u32 v7, v7, 5, v6
    v_add_u32 v17, s28, v7
    v_add_u32 v18, 49152, v17
    v_add_u32 v19, 49152, v18
    s_mul_i32 s28, s24, 3
    s_add_u32 s28, s28, 1
    s_and_b32 s29, s28, 3
    s_lshr_b32 s28, s28, 2
    s_lshl_b32 s28, s28, 10
    s_add_u32 s28, s28, 0
    v_xor_b32 v7, s29, v5
    v_lshl_add_u32 v7, v7, 5, v6
    v_add_u32 v20, s28, v7
    v_add_u32 v21, 49152, v20
    v_add_u32 v22, 49152, v21
    s_mul_i32 s28, s24, 3
    s_add_u32 s28, s28, 2
    s_and_b32 s29, s28, 3
    s_lshr_b32 s28, s28, 2
    s_lshl_b32 s28, s28, 10
    s_add_u32 s28, s28, 0
    v_xor_b32 v7, s29, v5
    v_lshl_add_u32 v7, v7, 5, v6
    v_add_u32 v23, s28, v7
    v_add_u32 v24, 49152, v23
    v_add_u32 v25, 49152, v24
    s_waitcnt vmcnt(24)
    v_readfirstlane_b32 s28, v255
    s_nop 0
    s_cmp_lg_u32 s28, 0
    s_cbranch_scc1 Lcfd_9
    v_mov_b32 v5, 0
Lcf_8:
    s_sleep 4
    buffer_load_dword v255, v5, s[20:23], 0 offen offset:144 sc1
    s_sub_u32 s27, s27, 1
    s_cbranch_scc1 L_exit
    s_waitcnt vmcnt(0)
    v_readfirstlane_b32 s28, v255
    s_nop 0
    s_cmp_eq_u32 s28, 0
    s_cbranch_scc1 Lcf_8
Lcfd_9:
    s_cmp_lg_u32 s28, s3
    s_cbranch_scc1 L_redo
    s_barrier
    s_cmp_eq_u32 s24, 1
    s_cbranch_scc1 Lwv_12
    s_cmp_eq_u32 s24, 2
    s_cbranch_scc1 Lwv_13
    s_cmp_eq_u32 s24, 3
    s_cbranch_scc1 Lwv_14
    ds_read_b64_tr_b16 a[0:1], v17 offset:0
    ds_read_b64_tr_b16 a[2:3], v17 offset:512
    ds_read_b64_tr_b16 a[80:81], v20 offset:0
    ds_read_b64_tr_b16 a[82:83], v20 offset:512
    ds_read_b64_tr_b16 a[152:153], v23 offset:0
    ds_read_b64_tr_b16 a[154:155], v23 offset:512
    ds_read_b64_tr_b16 a[4:5], v17 offset:12288
    ds_read_b64_tr_b16 a[6:7], v17 offset:12800
    ds_read_b64_tr_b16 a[84:85], v20 offset:12288
    ds_read_b64_tr_b16 a[86:87], v20 offset:12800
    ds_read_b64_tr_b16 a[156:157], v23 offset:12288
    ds_read_b64_tr_b16 a[158:159], v23 offset:12800
    s_waitcnt lgkmcnt(2)
    ds_read_b64_tr_b16 a[8:9], v17 offset:24576
    ds_read_b64_tr_b16 a[10:11], v17 offset:25088
    ds_read_b64_tr_b16 a[88:89], v20 offset:24576
    ds_read_b64_tr_b16 a[90:91], v20 offset:25088
    ds_read_b64_tr_b16 a[160:161], v23 offset:24576
    ds_read_b64_tr_b16 a[162:163], v23 offset:25088
    ds_read_b64_tr_b16 a[12:13], v17 offset:36864
    ds_read_b64_tr_b16 a[14:15], v17 offset:37376
    ds_read_b64_tr_b16 a[92:93], v20 offset:36864
    ds_read_b64_tr_b16 a[94:95], v20 offset:37376
    s_waitcnt lgkmcnt(2)
    ds_read_b64_tr_b16 a[164:165], v23 offset:36864
    ds_read_b64_tr_b16 a[166:167], v23 offset:37376
    s_branch Lwl_10
Lwv_12:
    ds_read_b64_tr_b16 a[48:49], v17 offset:0
    ds_read_b64_tr_b16 a[50:51], v17 offset:512
    ds_read_b64_tr_b16 a[128:129], v20 offset:0
    ds_read_b64_tr_b16 a[130:131], v20 offset:512
    ds_read_b64_tr_b16 a[200:201], v23 offset:0
    ds_read_b64_tr_b16 a[202:203], v23 offset:512
    ds_read_b64_tr_b16 a[52:53], v17 offset:12288
    ds_read_b64_tr_b16 a[54:55], v17 offset:12800
    ds_read_b64_tr_b16 a[132:133], v20 offset:12288
    ds_read_b64_tr_b16 a[134:135], v20 offset:12800
    ds_read_b64_tr_b16 a[204:205], v23 offset:12288
    ds_read_b64_tr_b16 a[206:207], v23 offset:12800
    s_waitcnt lgkmcnt(2)
    ds_read_b64_tr_b16 a[56:57], v17 offset:24576
    ds_read_b64_tr_b16 a[58:59], v17 offset:25088
    ds_read_b64_tr_b16 a[136:137], v20 offset:24576
    ds_read_b64_tr_b16 a[138:139], v20 offset:25088
    ds_read_b64_tr_b16 a[208:209], v23 offset:24576
    ds_read_b64_tr_b16 a[210:211], v23 offset:25088
    ds_read_b64_tr_b16 a[60:61], v17 offset:36864
    ds_read_b64_tr_b16 a[62:63], v17 offset:37376
    ds_read_b64_tr_b16 a[140:141], v20 offset:36864
    ds_read_b64_tr_b16 a[142:143], v20 offset:37376
    s_waitcnt lgkmcnt(2)
    ds_read_b64_tr_b16 a[212:213], v23 offset:36864
    ds_read_b64_tr_b16 a[214:215], v23 offset:37376
    s_branch Lwl_10
Lwv_13:
    ds_read_b64_tr_b16 a[32:33], v17 offset:0
    ds_read_b64_tr_b16 a[34:35], v17 offset:512
    ds_read_b64_tr_b16 a[112:113], v20 offset:0
    ds_read_b64_tr_b16 a[114:115], v20 offset:512
    ds_read_b64_tr_b16 a[184:185], v23 offset:0
    ds_read_b64_tr_b16 a[186:187], v23 offset:512
    ds_read_b64_tr_b16 a[36:37], v17 offset:12288
    ds_read_b64_tr_b16 a[38:39], v17 offset:12800
    ds_read_b64_tr_b16 a[116:117], v20 offset:12288
    ds_read_b64_tr_b16 a[118:119], v20 offset:12800
    ds_read_b64_tr_b16 a[188:189], v23 offset:12288
    ds_read_b64_tr_b16 a[190:191], v23 offset:12800
    s_waitcnt lgkmcnt(2)
    ds_read_b64_tr_b16 a[40:41], v17 offset:24576
    ds_read_b64_tr_b16 a[42:43], v17 offset:25088
    ds_read_b64_tr_b16 a[120:121], v20 offset:24576
    ds_read_b64_tr_b16 a[122:123], v20 offset:25088
    ds_read_b64_tr_b16 a[192:193], v23 offset:24576
    ds_read_b64_tr_b16 a[194:195], v23 offset:25088
    ds_read_b64_tr_b16 a[44:45], v17 offset:36864
    ds_read_b64_tr_b16 a[46:47], v17 offset:37376
    ds_read_b64_tr_b16 a[124:125], v20 offset:36864
    ds_read_b64_tr_b16 a[126:127], v20 offset:37376
    s_waitcnt lgkmcnt(2)
    ds_read_b64_tr_b16 a[196:197], v23 offset:36864
    ds_read_b64_tr_b16 a[198:199], v23 offset:37376
    s_branch Lwl_10
Lwv_14:
    ds_read_b64_tr_b16 a[16:17], v17 offset:0
    ds_read_b64_tr_b16 a[18:19], v17 offset:512
    ds_read_b64_tr_b16 a[96:97], v20 offset:0
    ds_read_b64_tr_b16 a[98:99], v20 offset:512
    ds_read_b64_tr_b16 a[168:169], v23 offset:0
    ds_read_b64_tr_b16 a[170:171], v23 offset:512
    ds_read_b64_tr_b16 a[20:21], v17 offset:12288
    ds_read_b64_tr_b16 a[22:23], v17 offset:12800
    ds_read_b64_tr_b16 a[100:101], v20 offset:12288
    ds_read_b64_tr_b16 a[102:103], v20 offset:12800
    ds_read_b64_tr_b16 a[172:173], v23 offset:12288
    ds_read_b64_tr_b16 a[174:175], v23 offset:12800
    s_waitcnt lgkmcnt(2)
    ds_read_b64_tr_b16 a[24:25], v17 offset:24576
    ds_read_b64_tr_b16 a[26:27], v17 offset:25088
    ds_read_b64_tr_b16 a[104:105], v20 offset:24576
    ds_read_b64_tr_b16 a[106:107], v20 offset:25088
    ds_read_b64_tr_b16 a[176:177], v23 offset:24576
    ds_read_b64_tr_b16 a[178:179], v23 offset:25088
    ds_read_b64_tr_b16 a[28:29], v17 offset:36864
    ds_read_b64_tr_b16 a[30:31], v17 offset:37376
    ds_read_b64_tr_b16 a[108:109], v20 offset:36864
    ds_read_b64_tr_b16 a[110:111], v20 offset:37376
    s_waitcnt lgkmcnt(2)
    ds_read_b64_tr_b16 a[180:181], v23 offset:36864
    ds_read_b64_tr_b16 a[182:183], v23 offset:37376
Lwl_10:
    s_waitcnt lgkmcnt(0)
    s_barrier
    s_add_u32 s29, s90, 4718592
    s_add_u32 m0, s95, 0
    s_nop 0
    buffer_load_dwordx4 v16, s[12:15], s29 offen offset:0 nt lds
    s_add_u32 m0, s95, 896
    s_nop 0
    buffer_load_dwordx4 v16, s[12:15], s29 offen offset:128 nt lds
    s_add_u32 m0, s95, 1792
    s_nop 0
    buffer_load_dwordx4 v16, s[12:15], s29 offen offset:256 nt lds
    s_add_u32 s29, s90, 5111808
    s_add_u32 m0, s95, 12288
    s_nop 0
    buffer_load_dwordx4 v16, s[12:15], s29 offen offset:0 nt lds
    s_add_u32 m0, s95, 13184
    s_nop 0
    buffer_load_dwordx4 v16, s[12:15], s29 offen offset:128 nt lds
    s_add_u32 m0, s95, 14080
    s_nop 0
    buffer_load_dwordx4 v16, s[12:15], s29 offen offset:256 nt lds
    s_add_u32 s29, s90, 5505024
    s_add_u32 m0, s95, 24576
    s_nop 0
    buffer_load_dwordx4 v16, s[12:15], s29 offen offset:0 nt lds
    s_add_u32 m0, s95, 25472
    s_nop 0
    buffer_load_dwordx4 v16, s[12:15], s29 offen offset:128 nt lds
    s_add_u32 m0, s95, 26368
    s_nop 0
    buffer_load_dwordx4 v16, s[12:15], s29 offen offset:256 nt lds
    s_add_u32 s29, s90, 5898240
    s_add_u32 m0, s95, 36864
    s_nop 0
    buffer_load_dwordx4 v16, s[12:15], s29 offen offset:0 nt lds
    s_add_u32 m0, s95, 37760
    s_nop 0
    buffer_load_dwordx4 v16, s[12:15], s29 offen offset:128 nt lds
    s_add_u32 m0, s95, 38656
    s_nop 0
    buffer_load_dwordx4 v16, s[12:15], s29 offen offset:256 nt lds
    s_waitcnt vmcnt(24)
    s_barrier
    s_cmp_eq_u32 s24, 1
    s_cbranch_scc1 Lwv_17
    s_cmp_eq_u32 s24, 2
    s_cbranch_scc1 Lwv_18
    s_cmp_eq_u32 s24, 3
    s_cbranch_scc1 Lwv_19
    ds_read_b64_tr_b16 a[16:17], v18 offset:0
    ds_read_b64_tr_b16 a[18:19], v18 offset:512
    ds_read_b64_tr_b16 a[96:97], v21 offset:0
    ds_read_b64_tr_b16 a[98:99], v21 offset:512
    ds_read_b64_tr_b16 a[168:169], v24 offset:0
    ds_read_b64_tr_b16 a[170:171], v24 offset:512
    ds_read_b64_tr_b16 a[20:21], v18 offset:12288
    ds_read_b64_tr_b16 a[22:23], v18 offset:12800
    ds_read_b64_tr_b16 a[100:101], v21 offset:12288
    ds_read_b64_tr_b16 a[102:103], v21 offset:12800
    ds_read_b64_tr_b16 a[172:173], v24 offset:12288
    ds_read_b64_tr_b16 a[174:175], v24 offset:12800
    s_waitcnt lgkmcnt(2)
    ds_read_b64_tr_b16 a[24:25], v18 offset:24576
    ds_read_b64_tr_b16 a[26:27], v18 offset:25088
    ds_read_b64_tr_b16 a[104:105], v21 offset:24576
    ds_read_b64_tr_b16 a[106:107], v21 offset:25088
    ds_read_b64_tr_b16 a[176:177], v24 offset:24576
    ds_read_b64_tr_b16 a[178:179], v24 offset:25088
    ds_read_b64_tr_b16 a[28:29], v18 offset:36864
    ds_read_b64_tr_b16 a[30:31], v18 offset:37376
    ds_read_b64_tr_b16 a[108:109], v21 offset:36864
    ds_read_b64_tr_b16 a[110:111], v21 offset:37376
    s_waitcnt lgkmcnt(2)
    ds_read_b64_tr_b16 a[180:181], v24 offset:36864
    ds_read_b64_tr_b16 a[182:183], v24 offset:37376
    s_branch Lwl_15
Lwv_17:
    ds_read_b64_tr_b16 a[0:1], v18 offset:0
    ds_read_b64_tr_b16 a[2:3], v18 offset:512
    ds_read_b64_tr_b16 a[80:81], v21 offset:0
    ds_read_b64_tr_b16 a[82:83], v21 offset:512
    ds_read_b64_tr_b16 a[152:153], v24 offset:0
    ds_read_b64_tr_b16 a[154:155], v24 offset:512
    ds_read_b64_tr_b16 a[4:5], v18 offset:12288
    ds_read_b64_tr_b16 a[6:7], v18 offset:12800
    ds_read_b64_tr_b16 a[84:85], v21 offset:12288
    ds_read_b64_tr_b16 a[86:87], v21 offset:12800
    ds_read_b64_tr_b16 a[156:157], v24 offset:12288
    ds_read_b64_tr_b16 a[158:159], v24 offset:12800
    s_waitcnt lgkmcnt(2)
    ds_read_b64_tr_b16 a[8:9], v18 offset:24576
    ds_read_b64_tr_b16 a[10:11], v18 offset:25088
    ds_read_b64_tr_b16 a[88:89], v21 offset:24576
    ds_read_b64_tr_b16 a[90:91], v21 offset:25088
    ds_read_b64_tr_b16 a[160:161], v24 offset:24576
    ds_read_b64_tr_b16 a[162:163], v24 offset:25088
    ds_read_b64_tr_b16 a[12:13], v18 offset:36864
    ds_read_b64_tr_b16 a[14:15], v18 offset:37376
    ds_read_b64_tr_b16 a[92:93], v21 offset:36864
    ds_read_b64_tr_b16 a[94:95], v21 offset:37376
    s_waitcnt lgkmcnt(2)
    ds_read_b64_tr_b16 a[164:165], v24 offset:36864
    ds_read_b64_tr_b16 a[166:167], v24 offset:37376
    s_branch Lwl_15
Lwv_18:
    ds_read_b64_tr_b16 a[48:49], v18 offset:0
    ds_read_b64_tr_b16 a[50:51], v18 offset:512
    ds_read_b64_tr_b16 a[128:129], v21 offset:0
    ds_read_b64_tr_b16 a[130:131], v21 offset:512
    ds_read_b64_tr_b16 a[200:201], v24 offset:0
    ds_read_b64_tr_b16 a[202:203], v24 offset:512
    ds_read_b64_tr_b16 a[52:53], v18 offset:12288
    ds_read_b64_tr_b16 a[54:55], v18 offset:12800
    ds_read_b64_tr_b16 a[132:133], v21 offset:12288
    ds_read_b64_tr_b16 a[134:135], v21 offset:12800
    ds_read_b64_tr_b16 a[204:205], v24 offset:12288
    ds_read_b64_tr_b16 a[206:207], v24 offset:12800
    s_waitcnt lgkmcnt(2)
    ds_read_b64_tr_b16 a[56:57], v18 offset:24576
    ds_read_b64_tr_b16 a[58:59], v18 offset:25088
    ds_read_b64_tr_b16 a[136:137], v21 offset:24576
    ds_read_b64_tr_b16 a[138:139], v21 offset:25088
    ds_read_b64_tr_b16 a[208:209], v24 offset:24576
    ds_read_b64_tr_b16 a[210:211], v24 offset:25088
    ds_read_b64_tr_b16 a[60:61], v18 offset:36864
    ds_read_b64_tr_b16 a[62:63], v18 offset:37376
    ds_read_b64_tr_b16 a[140:141], v21 offset:36864
    ds_read_b64_tr_b16 a[142:143], v21 offset:37376
    s_waitcnt lgkmcnt(2)
    ds_read_b64_tr_b16 a[212:213], v24 offset:36864
    ds_read_b64_tr_b16 a[214:215], v24 offset:37376
    s_branch Lwl_15
Lwv_19:
    ds_read_b64_tr_b16 a[32:33], v18 offset:0
    ds_read_b64_tr_b16 a[34:35], v18 offset:512
    ds_read_b64_tr_b16 a[112:113], v21 offset:0
    ds_read_b64_tr_b16 a[114:115], v21 offset:512
    ds_read_b64_tr_b16 a[184:185], v24 offset:0
    ds_read_b64_tr_b16 a[186:187], v24 offset:512
    ds_read_b64_tr_b16 a[36:37], v18 offset:12288
    ds_read_b64_tr_b16 a[38:39], v18 offset:12800
    ds_read_b64_tr_b16 a[116:117], v21 offset:12288
    ds_read_b64_tr_b16 a[118:119], v21 offset:12800
    ds_read_b64_tr_b16 a[188:189], v24 offset:12288
    ds_read_b64_tr_b16 a[190:191], v24 offset:12800
    s_waitcnt lgkmcnt(2)
    ds_read_b64_tr_b16 a[40:41], v18 offset:24576
    ds_read_b64_tr_b16 a[42:43], v18 offset:25088
    ds_read_b64_tr_b16 a[120:121], v21 offset:24576
    ds_read_b64_tr_b16 a[122:123], v21 offset:25088
    ds_read_b64_tr_b16 a[192:193], v24 offset:24576
    ds_read_b64_tr_b16 a[194:195], v24 offset:25088
    ds_read_b64_tr_b16 a[44:45], v18 offset:36864
    ds_read_b64_tr_b16 a[46:47], v18 offset:37376
    ds_read_b64_tr_b16 a[124:125], v21 offset:36864
    ds_read_b64_tr_b16 a[126:127], v21 offset:37376
    s_waitcnt lgkmcnt(2)
    ds_read_b64_tr_b16 a[196:197], v24 offset:36864
    ds_read_b64_tr_b16 a[198:199], v24 offset:37376
Lwl_15:
    s_waitcnt lgkmcnt(0)
    s_barrier
    s_add_u32 s29, s90, 6291456
    s_add_u32 m0, s95, 49152
    s_nop 0
    buffer_load_dwordx4 v16, s[12:15], s29 offen offset:0 nt lds
    s_add_u32 m0, s95, 50048
    s_nop 0
    buffer_load_dwordx4 v16, s[12:15], s29 offen offset:128 nt lds
    s_add_u32 m0, s95, 50944
    s_nop 0
    buffer_load_dwordx4 v16, s[12:15], s29 offen offset:256 nt lds
    s_add_u32 s29, s90, 6684672
    s_add_u32 m0, s95, 61440
    s_nop 0
    buffer_load_dwordx4 v16, s[12:15], s29 offen offset:0 nt lds
    s_add_u32 m0, s95, 62336
    s_nop 0
    buffer_load_dwordx4 v16, s[12:15], s29 offen offset:128 nt lds
    s_add_u32 m0, s95, 63232
    s_nop 0
    buffer_load_dwordx4 v16, s[12:15], s29 offen offset:256 nt lds
    s_add_u32 s29, s90, 7077888
    s_add_u32 m0, s95, 73728
    s_nop 0
    buffer_load_dwordx4 v16, s[12:15], s29 offen offset:0 nt lds
    s_add_u32 m0, s95, 74624
    s_nop 0
    buffer_load_dwordx4 v16, s[12:15], s29 offen offset:128 nt lds
    s_add_u32 m0, s95, 75520
    s_nop 0
    buffer_load_dwordx4 v16, s[12:15], s29 offen offset:256 nt lds
    s_add_u32 s29, s90, 7471104
    s_add_u32 m0, s95, 86016
    s_nop 0
    buffer_load_dwordx4 v16, s[12:15], s29 offen offset:0 nt lds
    s_add_u32 m0, s95, 86912
    s_nop 0
    buffer_load_dwordx4 v16, s[12:15], s29 offen offset:128 nt lds
    s_add_u32 m0, s95, 87808
    s_nop 0
    buffer_load_dwordx4 v16, s[12:15], s29 offen offset:256 nt lds
    s_waitcnt vmcnt(24)
    s_barrier
    s_cmp_eq_u32 s24, 1
    s_cbranch_scc1 Lwv_22
    s_cmp_eq_u32 s24, 2
    s_cbranch_scc1 Lwv_23
    s_cmp_eq_u32 s24, 3
    s_cbranch_scc1 Lwv_24
    ds_read_b64_tr_b16 a[32:33], v19 offset:0
    ds_read_b64_tr_b16 a[34:35], v19 offset:512
    ds_read_b64_tr_b16 a[112:113], v22 offset:0
    ds_read_b64_tr_b16 a[114:115], v22 offset:512
    ds_read_b64_tr_b16 a[184:185], v25 offset:0
    ds_read_b64_tr_b16 a[186:187], v25 offset:512
    ds_read_b64_tr_b16 a[36:37], v19 offset:12288
    ds_read_b64_tr_b16 a[38:39], v19 offset:12800
    ds_read_b64_tr_b16 a[116:117], v22 offset:12288
    ds_read_b64_tr_b16 a[118:119], v22 offset:12800
    ds_read_b64_tr_b16 a[188:189], v25 offset:12288
    ds_read_b64_tr_b16 a[190:191], v25 offset:12800
    s_waitcnt lgkmcnt(2)
    ds_read_b64_tr_b16 a[40:41], v19 offset:24576
    ds_read_b64_tr_b16 a[42:43], v19 offset:25088
    ds_read_b64_tr_b16 a[120:121], v22 offset:24576
    ds_read_b64_tr_b16 a[122:123], v22 offset:25088
    ds_read_b64_tr_b16 a[192:193], v25 offset:24576
    ds_read_b64_tr_b16 a[194:195], v25 offset:25088
    ds_read_b64_tr_b16 a[44:45], v19 offset:36864
    ds_read_b64_tr_b16 a[46:47], v19 offset:37376
    ds_read_b64_tr_b16 a[124:125], v22 offset:36864
    ds_read_b64_tr_b16 a[126:127], v22 offset:37376
    s_waitcnt lgkmcnt(2)
    ds_read_b64_tr_b16 a[196:197], v25 offset:36864
    ds_read_b64_tr_b16 a[198:199], v25 offset:37376
    s_branch Lwl_20
Lwv_22:
    ds_read_b64_tr_b16 a[16:17], v19 offset:0
    ds_read_b64_tr_b16 a[18:19], v19 offset:512
    ds_read_b64_tr_b16 a[96:97], v22 offset:0
    ds_read_b64_tr_b16 a[98:99], v22 offset:512
    ds_read_b64_tr_b16 a[168:169], v25 offset:0
    ds_read_b64_tr_b16 a[170:171], v25 offset:512
    ds_read_b64_tr_b16 a[20:21], v19 offset:12288
    ds_read_b64_tr_b16 a[22:23], v19 offset:12800
    ds_read_b64_tr_b16 a[100:101], v22 offset:12288
    ds_read_b64_tr_b16 a[102:103], v22 offset:12800
    ds_read_b64_tr_b16 a[172:173], v25 offset:12288
    ds_read_b64_tr_b16 a[174:175], v25 offset:12800
    s_waitcnt lgkmcnt(2)
    ds_read_b64_tr_b16 a[24:25], v19 offset:24576
    ds_read_b64_tr_b16 a[26:27], v19 offset:25088
    ds_read_b64_tr_b16 a[104:105], v22 offset:24576
    ds_read_b64_tr_b16 a[106:107], v22 offset:25088
    ds_read_b64_tr_b16 a[176:177], v25 offset:24576
    ds_read_b64_tr_b16 a[178:179], v25 offset:25088
    ds_read_b64_tr_b16 a[28:29], v19 offset:36864
    ds_read_b64_tr_b16 a[30:31], v19 offset:37376
    ds_read_b64_tr_b16 a[108:109], v22 offset:36864
    ds_read_b64_tr_b16 a[110:111], v22 offset:37376
    s_waitcnt lgkmcnt(2)
    ds_read_b64_tr_b16 a[180:181], v25 offset:36864
    ds_read_b64_tr_b16 a[182:183], v25 offset:37376
    s_branch Lwl_20
Lwv_23:
    ds_read_b64_tr_b16 a[0:1], v19 offset:0
    ds_read_b64_tr_b16 a[2:3], v19 offset:512
    ds_read_b64_tr_b16 a[80:81], v22 offset:0
    ds_read_b64_tr_b16 a[82:83], v22 offset:512
    ds_read_b64_tr_b16 a[152:153], v25 offset:0
    ds_read_b64_tr_b16 a[154:155], v25 offset:512
    ds_read_b64_tr_b16 a[4:5], v19 offset:12288
    ds_read_b64_tr_b16 a[6:7], v19 offset:12800
    ds_read_b64_tr_b16 a[84:85], v22 offset:12288
    ds_read_b64_tr_b16 a[86:87], v22 offset:12800
    ds_read_b64_tr_b16 a[156:157], v25 offset:12288
    ds_read_b64_tr_b16 a[158:159], v25 offset:12800
    s_waitcnt lgkmcnt(2)
    ds_read_b64_tr_b16 a[8:9], v19 offset:24576
    ds_read_b64_tr_b16 a[10:11], v19 offset:25088
    ds_read_b64_tr_b16 a[88:89], v22 offset:24576
    ds_read_b64_tr_b16 a[90:91], v22 offset:25088
    ds_read_b64_tr_b16 a[160:161], v25 offset:24576
    ds_read_b64_tr_b16 a[162:163], v25 offset:25088
    ds_read_b64_tr_b16 a[12:13], v19 offset:36864
    ds_read_b64_tr_b16 a[14:15], v19 offset:37376
    ds_read_b64_tr_b16 a[92:93], v22 offset:36864
    ds_read_b64_tr_b16 a[94:95], v22 offset:37376
    s_waitcnt lgkmcnt(2)
    ds_read_b64_tr_b16 a[164:165], v25 offset:36864
    ds_read_b64_tr_b16 a[166:167], v25 offset:37376
    s_branch Lwl_20
Lwv_24:
    ds_read_b64_tr_b16 a[48:49], v19 offset:0
    ds_read_b64_tr_b16 a[50:51], v19 offset:512
    ds_read_b64_tr_b16 a[128:129], v22 offset:0
    ds_read_b64_tr_b16 a[130:131], v22 offset:512
    ds_read_b64_tr_b16 a[200:201], v25 offset:0
    ds_read_b64_tr_b16 a[202:203], v25 offset:512
    ds_read_b64_tr_b16 a[52:53], v19 offset:12288
    ds_read_b64_tr_b16 a[54:55], v19 offset:12800
    ds_read_b64_tr_b16 a[132:133], v22 offset:12288
    ds_read_b64_tr_b16 a[134:135], v22 offset:12800
    ds_read_b64_tr_b16 a[204:205], v25 offset:12288
    ds_read_b64_tr_b16 a[206:207], v25 offset:12800
    s_waitcnt lgkmcnt(2)
    ds_read_b64_tr_b16 a[56:57], v19 offset:24576
    ds_read_b64_tr_b16 a[58:59], v19 offset:25088
    ds_read_b64_tr_b16 a[136:137], v22 offset:24576
    ds_read_b64_tr_b16 a[138:139], v22 offset:25088
    ds_read_b64_tr_b16 a[208:209], v25 offset:24576
    ds_read_b64_tr_b16 a[210:211], v25 offset:25088
    ds_read_b64_tr_b16 a[60:61], v19 offset:36864
    ds_read_b64_tr_b16 a[62:63], v19 offset:37376
    ds_read_b64_tr_b16 a[140:141], v22 offset:36864
    ds_read_b64_tr_b16 a[142:143], v22 offset:37376
    s_waitcnt lgkmcnt(2)
    ds_read_b64_tr_b16 a[212:213], v25 offset:36864
    ds_read_b64_tr_b16 a[214:215], v25 offset:37376
Lwl_20:
    s_waitcnt lgkmcnt(0)
    s_barrier
    s_add_u32 s29, s90, 0
    s_add_u32 m0, s95, 98304
    s_nop 0
    buffer_load_dwordx4 v16, s[16:19], s29 offen offset:0 nt lds
    s_add_u32 m0, s95, 99200
    s_nop 0
    buffer_load_dwordx4 v16, s[16:19], s29 offen offset:128 nt lds
    s_add_u32 m0, s95, 100096
    s_nop 0
    buffer_load_dwordx4 v16, s[16:19], s29 offen offset:256 nt lds
    s_add_u32 s29, s90, 393216
    s_add_u32 m0, s95, 110592
    s_nop 0
    buffer_load_dwordx4 v16, s[16:19], s29 offen offset:0 nt lds
    s_add_u32 m0, s95, 111488
    s_nop 0
    buffer_load_dwordx4 v16, s[16:19], s29 offen offset:128 nt lds
    s_add_u32 m0, s95, 112384
    s_nop 0
    buffer_load_dwordx4 v16, s[16:19], s29 offen offset:256 nt lds
    s_add_u32 s29, s90, 786432
    s_add_u32 m0, s95, 122880
    s_nop 0
    buffer_load_dwordx4 v16, s[16:19], s29 offen offset:0 nt lds
    s_add_u32 m0, s95, 123776
    s_nop 0
    buffer_load_dwordx4 v16, s[16:19], s29 offen offset:128 nt lds
    s_add_u32 m0, s95, 124672
    s_nop 0
    buffer_load_dwordx4 v16, s[16:19], s29 offen offset:256 nt lds
    s_add_u32 s29, s90, 1179648
    s_add_u32 m0, s95, 135168
    s_nop 0
    buffer_load_dwordx4 v16, s[16:19], s29 offen offset:0 nt lds
    s_add_u32 m0, s95, 136064
    s_nop 0
    buffer_load_dwordx4 v16, s[16:19], s29 offen offset:128 nt lds
    s_add_u32 m0, s95, 136960
    s_nop 0
    buffer_load_dwordx4 v16, s[16:19], s29 offen offset:256 nt lds
    s_waitcnt vmcnt(24)
    s_barrier
    s_cmp_eq_u32 s24, 1
    s_cbranch_scc1 Lwv_27
    s_cmp_eq_u32 s24, 2
    s_cbranch_scc1 Lwv_28
    s_cmp_eq_u32 s24, 3
    s_cbranch_scc1 Lwv_29
    ds_read_b64_tr_b16 a[48:49], v17 offset:0
    ds_read_b64_tr_b16 a[50:51], v17 offset:512
    ds_read_b64_tr_b16 a[128:129], v20 offset:0
    ds_read_b64_tr_b16 a[130:131], v20 offset:512
    ds_read_b64_tr_b16 a[200:201], v23 offset:0
    ds_read_b64_tr_b16 a[202:203], v23 offset:512
    ds_read_b64_tr_b16 a[52:53], v17 offset:12288
    ds_read_b64_tr_b16 a[54:55], v17 offset:12800
    ds_read_b64_tr_b16 a[132:133], v20 offset:12288
    ds_read_b64_tr_b16 a[134:135], v20 offset:12800
    ds_read_b64_tr_b16 a[204:205], v23 offset:12288
    ds_read_b64_tr_b16 a[206:207], v23 offset:12800
    s_waitcnt lgkmcnt(2)
    ds_read_b64_tr_b16 a[56:57], v17 offset:24576
    ds_read_b64_tr_b16 a[58:59], v17 offset:25088
    ds_read_b64_tr_b16 a[136:137], v20 offset:24576
    ds_read_b64_tr_b16 a[138:139], v20 offset:25088
    ds_read_b64_tr_b16 a[208:209], v23 offset:24576
    ds_read_b64_tr_b16 a[210:211], v23 offset:25088
    ds_read_b64_tr_b16 a[60:61], v17 offset:36864
    ds_read_b64_tr_b16 a[62:63], v17 offset:37376
    ds_read_b64_tr_b16 a[140:141], v20 offset:36864
    ds_read_b64_tr_b16 a[142:143], v20 offset:37376
    s_waitcnt lgkmcnt(2)
    ds_read_b64_tr_b16 a[212:213], v23 offset:36864
    ds_read_b64_tr_b16 a[214:215], v23 offset:37376
    s_branch Lwl_25
Lwv_27:
    ds_read_b64_tr_b16 a[32:33], v17 offset:0
    ds_read_b64_tr_b16 a[34:35], v17 offset:512
    ds_read_b64_tr_b16 a[112:113], v20 offset:0
    ds_read_b64_tr_b16 a[114:115], v20 offset:512
    ds_read_b64_tr_b16 a[184:185], v23 offset:0
    ds_read_b64_tr_b16 a[186:187], v23 offset:512
    ds_read_b64_tr_b16 a[36:37], v17 offset:12288
    ds_read_b64_tr_b16 a[38:39], v17 offset:12800
    ds_read_b64_tr_b16 a[116:117], v20 offset:12288
    ds_read_b64_tr_b16 a[118:119], v20 offset:12800
    ds_read_b64_tr_b16 a[188:189], v23 offset:12288
    ds_read_b64_tr_b16 a[190:191], v23 offset:12800
    s_waitcnt lgkmcnt(2)
    ds_read_b64_tr_b16 a[40:41], v17 offset:24576
    ds_read_b64_tr_b16 a[42:43], v17 offset:25088
    ds_read_b64_tr_b16 a[120:121], v20 offset:24576
    ds_read_b64_tr_b16 a[122:123], v20 offset:25088
    ds_read_b64_tr_b16 a[192:193], v23 offset:24576
    ds_read_b64_tr_b16 a[194:195], v23 offset:25088
    ds_read_b64_tr_b16 a[44:45], v17 offset:36864
    ds_read_b64_tr_b16 a[46:47], v17 offset:37376
    ds_read_b64_tr_b16 a[124:125], v20 offset:36864
    ds_read_b64_tr_b16 a[126:127], v20 offset:37376
    s_waitcnt lgkmcnt(2)
    ds_read_b64_tr_b16 a[196:197], v23 offset:36864
    ds_read_b64_tr_b16 a[198:199], v23 offset:37376
    s_branch Lwl_25
Lwv_28:
    ds_read_b64_tr_b16 a[16:17], v17 offset:0
    ds_read_b64_tr_b16 a[18:19], v17 offset:512
    ds_read_b64_tr_b16 a[96:97], v20 offset:0
    ds_read_b64_tr_b16 a[98:99], v20 offset:512
    ds_read_b64_tr_b16 a[168:169], v23 offset:0
    ds_read_b64_tr_b16 a[170:171], v23 offset:512
    ds_read_b64_tr_b16 a[20:21], v17 offset:12288
    ds_read_b64_tr_b16 a[22:23], v17 offset:12800
    ds_read_b64_tr_b16 a[100:101], v20 offset:12288
    ds_read_b64_tr_b16 a[102:103], v20 offset:12800
    ds_read_b64_tr_b16 a[172:173], v23 offset:12288
    ds_read_b64_tr_b16 a[174:175], v23 offset:12800
    s_waitcnt lgkmcnt(2)
    ds_read_b64_tr_b16 a[24:25], v17 offset:24576
    ds_read_b64_tr_b16 a[26:27], v17 offset:25088
    ds_read_b64_tr_b16 a[104:105], v20 offset:24576
    ds_read_b64_tr_b16 a[106:107], v20 offset:25088
    ds_read_b64_tr_b16 a[176:177], v23 offset:24576
    ds_read_b64_tr_b16 a[178:179], v23 offset:25088
    ds_read_b64_tr_b16 a[28:29], v17 offset:36864
    ds_read_b64_tr_b16 a[30:31], v17 offset:37376
    ds_read_b64_tr_b16 a[108:109], v20 offset:36864
    ds_read_b64_tr_b16 a[110:111], v20 offset:37376
    s_waitcnt lgkmcnt(2)
    ds_read_b64_tr_b16 a[180:181], v23 offset:36864
    ds_read_b64_tr_b16 a[182:183], v23 offset:37376
    s_branch Lwl_25
Lwv_29:
    ds_read_b64_tr_b16 a[0:1], v17 offset:0
    ds_read_b64_tr_b16 a[2:3], v17 offset:512
    ds_read_b64_tr_b16 a[80:81], v20 offset:0
    ds_read_b64_tr_b16 a[82:83], v20 offset:512
    ds_read_b64_tr_b16 a[152:153], v23 offset:0
    ds_read_b64_tr_b16 a[154:155], v23 offset:512
    ds_read_b64_tr_b16 a[4:5], v17 offset:12288
    ds_read_b64_tr_b16 a[6:7], v17 offset:12800
    ds_read_b64_tr_b16 a[84:85], v20 offset:12288
    ds_read_b64_tr_b16 a[86:87], v20 offset:12800
    ds_read_b64_tr_b16 a[156:157], v23 offset:12288
    ds_read_b64_tr_b16 a[158:159], v23 offset:12800
    s_waitcnt lgkmcnt(2)
    ds_read_b64_tr_b16 a[8:9], v17 offset:24576
    ds_read_b64_tr_b16 a[10:11], v17 offset:25088
    ds_read_b64_tr_b16 a[88:89], v20 offset:24576
    ds_read_b64_tr_b16 a[90:91], v20 offset:25088
    ds_read_b64_tr_b16 a[160:161], v23 offset:24576
    ds_read_b64_tr_b16 a[162:163], v23 offset:25088
    ds_read_b64_tr_b16 a[12:13], v17 offset:36864
    ds_read_b64_tr_b16 a[14:15], v17 offset:37376
    ds_read_b64_tr_b16 a[92:93], v20 offset:36864
    ds_read_b64_tr_b16 a[94:95], v20 offset:37376
    s_waitcnt lgkmcnt(2)
    ds_read_b64_tr_b16 a[164:165], v23 offset:36864
    ds_read_b64_tr_b16 a[166:167], v23 offset:37376
Lwl_25:
    s_waitcnt lgkmcnt(0)
    s_barrier
    s_add_u32 s29, s90, 1572864
    s_add_u32 m0, s95, 0
    s_nop 0
    buffer_load_dwordx4 v16, s[16:19], s29 offen offset:0 nt lds
    s_add_u32 m0, s95, 896
    s_nop 0
    buffer_load_dwordx4 v16, s[16:19], s29 offen offset:128 nt lds
    s_add_u32 m0, s95, 1792
    s_nop 0
    buffer_load_dwordx4 v16, s[16:19], s29 offen offset:256 nt lds
    s_add_u32 s29, s90, 1966080
    s_add_u32 m0, s95, 12288
    s_nop 0
    buffer_load_dwordx4 v16, s[16:19], s29 offen offset:0 nt lds
    s_add_u32 m0, s95, 13184
    s_nop 0
    buffer_load_dwordx4 v16, s[16:19], s29 offen offset:128 nt lds
    s_add_u32 m0, s95, 14080
    s_nop 0
    buffer_load_dwordx4 v16, s[16:19], s29 offen offset:256 nt lds
    s_add_u32 s29, s90, 2359296
    s_add_u32 m0, s95, 24576
    s_nop 0
    buffer_load_dwordx4 v16, s[16:19], s29 offen offset:0 nt lds
    s_add_u32 m0, s95, 25472
    s_nop 0
    buffer_load_dwordx4 v16, s[16:19], s29 offen offset:128 nt lds
    s_add_u32 m0, s95, 26368
    s_nop 0
    buffer_load_dwordx4 v16, s[16:19], s29 offen offset:256 nt lds
    s_add_u32 s29, s90, 2752512
    s_add_u32 m0, s95, 36864
    s_nop 0
    buffer_load_dwordx4 v16, s[16:19], s29 offen offset:0 nt lds
    s_add_u32 m0, s95, 37760
    s_nop 0
    buffer_load_dwordx4 v16, s[16:19], s29 offen offset:128 nt lds
    s_add_u32 m0, s95, 38656
    s_nop 0
    buffer_load_dwordx4 v16, s[16:19], s29 offen offset:256 nt lds
    s_waitcnt vmcnt(24)
    s_barrier
    ds_read_b64_tr_b16 a[64:65], v18 offset:0
    ds_read_b64_tr_b16 a[66:67], v18 offset:512
    ds_read_b64_tr_b16 v[96:97], v21 offset:0
    ds_read_b64_tr_b16 v[98:99], v21 offset:512
    ds_read_b64_tr_b16 a[216:217], v24 offset:0
    ds_read_b64_tr_b16 a[218:219], v24 offset:512
    ds_read_b64_tr_b16 a[68:69], v18 offset:12288
    ds_read_b64_tr_b16 a[70:71], v18 offset:12800
    ds_read_b64_tr_b16 v[100:101], v21 offset:12288
    ds_read_b64_tr_b16 v[102:103], v21 offset:12800
    ds_read_b64_tr_b16 a[220:221], v24 offset:12288
    ds_read_b64_tr_b16 a[222:223], v24 offset:12800
    s_waitcnt lgkmcnt(2)
    ds_read_b64_tr_b16 a[72:73], v18 offset:24576
    ds_read_b64_tr_b16 a[74:75], v18 offset:25088
    ds_read_b64_tr_b16 a[144:145], v21 offset:24576
    ds_read_b64_tr_b16 a[146:147], v21 offset:25088
    ds_read_b64_tr_b16 a[224:225], v24 offset:24576
    ds_read_b64_tr_b16 a[226:227], v24 offset:25088
    ds_read_b64_tr_b16 a[76:77], v18 offset:36864
    ds_read_b64_tr_b16 a[78:79], v18 offset:37376
    ds_read_b64_tr_b16 a[148:149], v21 offset:36864
    ds_read_b64_tr_b16 a[150:151], v21 offset:37376
    s_waitcnt lgkmcnt(2)
    ds_read_b64_tr_b16 a[228:229], v24 offset:36864
    ds_read_b64_tr_b16 a[230:231], v24 offset:37376
Lwl_30:
    s_waitcnt lgkmcnt(0)
    s_barrier
    s_add_u32 s29, s90, 3145728
    s_add_u32 m0, s95, 49152
    s_nop 0
    buffer_load_dwordx4 v16, s[16:19], s29 offen offset:0 nt lds
    s_add_u32 m0, s95, 50048
    s_nop 0
    buffer_load_dwordx4 v16, s[16:19], s29 offen offset:128 nt lds
    s_add_u32 m0, s95, 50944
    s_nop 0
    buffer_load_dwordx4 v16, s[16:19], s29 offen offset:256 nt lds
    s_add_u32 s29, s90, 3538944
    s_add_u32 m0, s95, 61440
    s_nop 0
    buffer_load_dwordx4 v16, s[16:19], s29 offen offset:0 nt lds
    s_add_u32 m0, s95, 62336
    s_nop 0
    buffer_load_dwordx4 v16, s[16:19], s29 offen offset:128 nt lds
    s_add_u32 m0, s95, 63232
    s_nop 0
    buffer_load_dwordx4 v16, s[16:19], s29 offen offset:256 nt lds
    s_add_u32 s29, s90, 3932160
    s_add_u32 m0, s95, 73728
    s_nop 0
    buffer_load_dwordx4 v16, s[16:19], s29 offen offset:0 nt lds
    s_add_u32 m0, s95, 74624
    s_nop 0
    buffer_load_dwordx4 v16, s[16:19], s29 offen offset:128 nt lds
    s_add_u32 m0, s95, 75520
    s_nop 0
    buffer_load_dwordx4 v16, s[16:19], s29 offen offset:256 nt lds
    s_add_u32 s29, s90, 4325376
    s_add_u32 m0, s95, 86016
    s_nop 0
    buffer_load_dwordx4 v16, s[16:19], s29 offen offset:0 nt lds
    s_add_u32 m0, s95, 86912
    s_nop 0
    buffer_load_dwordx4 v16, s[16:19], s29 offen offset:128 nt lds
    s_add_u32 m0, s95, 87808
    s_nop 0
    buffer_load_dwordx4 v16, s[16:19], s29 offen offset:256 nt lds
    s_waitcnt vmcnt(24)
    s_barrier
    s_cmp_eq_u32 s24, 1
    s_cbranch_scc1 Lwv_34
    s_cmp_eq_u32 s24, 2
    s_cbranch_scc1 Lwv_35
    s_cmp_eq_u32 s24, 3
    s_cbranch_scc1 Lwv_36
    ds_read_b64_tr_b16 a[232:233], v19 offset:0
    ds_read_b64_tr_b16 a[234:235], v19 offset:512
    ds_read_b64_tr_b16 v[184:185], v22 offset:0
    ds_read_b64_tr_b16 v[186:187], v22 offset:512
    ds_read_b64_tr_b16 v[32:33], v25 offset:0
    ds_read_b64_tr_b16 v[34:35], v25 offset:512
    ds_read_b64_tr_b16 a[236:237], v19 offset:12288
    ds_read_b64_tr_b16 a[238:239], v19 offset:12800
    ds_read_b64_tr_b16 v[188:189], v22 offset:12288
    ds_read_b64_tr_b16 v[190:191], v22 offset:12800
    ds_read_b64_tr_b16 v[36:37], v25 offset:12288
    ds_read_b64_tr_b16 v[38:39], v25 offset:12800
    s_waitcnt lgkmcnt(2)
    ds_read_b64_tr_b16 a[240:241], v19 offset:24576
    ds_read_b64_tr_b16 a[242:243], v19 offset:25088
    ds_read_b64_tr_b16 v[192:193], v22 offset:24576
    ds_read_b64_tr_b16 v[194:195], v22 offset:25088
    ds_read_b64_tr_b16 v[40:41], v25 offset:24576
    ds_read_b64_tr_b16 v[42:43], v25 offset:25088
    ds_read_b64_tr_b16 a[244:245], v19 offset:36864
    ds_read_b64_tr_b16 a[246:247], v19 offset:37376
    ds_read_b64_tr_b16 v[196:197], v22 offset:36864
    ds_read_b64_tr_b16 v[198:199], v22 offset:37376
    s_waitcnt lgkmcnt(2)
    ds_read_b64_tr_b16 v[44:45], v25 offset:36864
    ds_read_b64_tr_b16 v[46:47], v25 offset:37376
    s_branch Lwl_32
Lwv_34:
    ds_read_b64_tr_b16 v[152:153], v19 offset:0
    ds_read_b64_tr_b16 v[154:155], v19 offset:512
    ds_read_b64_tr_b16 v[224:225], v22 offset:0
    ds_read_b64_tr_b16 v[226:227], v22 offset:512
    ds_read_b64_tr_b16 v[88:89], v25 offset:0
    ds_read_b64_tr_b16 v[90:91], v25 offset:512
    ds_read_b64_tr_b16 v[156:157], v19 offset:12288
    ds_read_b64_tr_b16 v[158:159], v19 offset:12800
    ds_read_b64_tr_b16 v[228:229], v22 offset:12288
    ds_read_b64_tr_b16 v[230:231], v22 offset:12800
    ds_read_b64_tr_b16 v[92:93], v25 offset:12288
    ds_read_b64_tr_b16 v[94:95], v25 offset:12800
    s_waitcnt lgkmcnt(2)
    ds_read_b64_tr_b16 v[160:161], v19 offset:24576
    ds_read_b64_tr_b16 v[162:163], v19 offset:25088
    ds_read_b64_tr_b16 v[232:233], v22 offset:24576
    ds_read_b64_tr_b16 v[234:235], v22 offset:25088
    ds_read_b64_tr_b16 v[104:105], v25 offset:24576
    ds_read_b64_tr_b16 v[106:107], v25 offset:25088
    ds_read_b64_tr_b16 v[164:165], v19 offset:36864
    ds_read_b64_tr_b16 v[166:167], v19 offset:37376
    ds_read_b64_tr_b16 v[236:237], v22 offset:36864
    ds_read_b64_tr_b16 v[238:239], v22 offset:37376
    s_waitcnt lgkmcnt(2)
    ds_read_b64_tr_b16 v[108:109], v25 offset:36864
    ds_read_b64_tr_b16 v[110:111], v25 offset:37376
    s_branch Lwl_32
Lwv_35:
    ds_read_b64_tr_b16 v[136:137], v19 offset:0
    ds_read_b64_tr_b16 v[138:139], v19 offset:512
    ds_read_b64_tr_b16 v[216:217], v22 offset:0
    ds_read_b64_tr_b16 v[218:219], v22 offset:512
    ds_read_b64_tr_b16 v[64:65], v25 offset:0
    ds_read_b64_tr_b16 v[66:67], v25 offset:512
    ds_read_b64_tr_b16 v[140:141], v19 offset:12288
    ds_read_b64_tr_b16 v[142:143], v19 offset:12800
    ds_read_b64_tr_b16 v[220:221], v22 offset:12288
    ds_read_b64_tr_b16 v[222:223], v22 offset:12800
    ds_read_b64_tr_b16 v[68:69], v25 offset:12288
    ds_read_b64_tr_b16 v[70:71], v25 offset:12800
    s_waitcnt lgkmcnt(2)
    ds_read_b64_tr_b16 v[144:145], v19 offset:24576
    ds_read_b64_tr_b16 v[146:147], v19 offset:25088
    ds_read_b64_tr_b16 v[72:73], v22 offset:24576
    ds_read_b64_tr_b16 v[74:75], v22 offset:25088
    ds_read_b64_tr_b16 v[80:81], v25 offset:24576
    ds_read_b64_tr_b16 v[82:83], v25 offset:25088
    ds_read_b64_tr_b16 v[148:149], v19 offset:36864
    ds_read_b64_tr_b16 v[150:151], v19 offset:37376
    ds_read_b64_tr_b16 v[76:77], v22 offset:36864
    ds_read_b64_tr_b16 v[78:79], v22 offset:37376
    s_waitcnt lgkmcnt(2)
    ds_read_b64_tr_b16 v[84:85], v25 offset:36864
    ds_read_b64_tr_b16 v[86:87], v25 offset:37376
    s_branch Lwl_32
Lwv_36:
    ds_read_b64_tr_b16 a[248:249], v19 offset:0
    ds_read_b64_tr_b16 a[250:251], v19 offset:512
    ds_read_b64_tr_b16 v[200:201], v22 offset:0
    ds_read_b64_tr_b16 v[202:203], v22 offset:512
    ds_read_b64_tr_b16 v[48:49], v25 offset:0
    ds_read_b64_tr_b16 v[50:51], v25 offset:512
    ds_read_b64_tr_b16 a[252:253], v19 offset:12288
    ds_read_b64_tr_b16 a[254:255], v19 offset:12800
    ds_read_b64_tr_b16 v[204:205], v22 offset:12288
    ds_read_b64_tr_b16 v[206:207], v22 offset:12800
    ds_read_b64_tr_b16 v[52:53], v25 offset:12288
    ds_read_b64_tr_b16 v[54:55], v25 offset:12800
    s_waitcnt lgkmcnt(2)
    ds_read_b64_tr_b16 v[128:129], v19 offset:24576
    ds_read_b64_tr_b16 v[130:131], v19 offset:25088
    ds_read_b64_tr_b16 v[208:209], v22 offset:24576
    ds_read_b64_tr_b16 v[210:211], v22 offset:25088
    ds_read_b64_tr_b16 v[56:57], v25 offset:24576
    ds_read_b64_tr_b16 v[58:59], v25 offset:25088
    ds_read_b64_tr_b16 v[132:133], v19 offset:36864
    ds_read_b64_tr_b16 v[134:135], v19 offset:37376
    ds_read_b64_tr_b16 v[212:213], v22 offset:36864
    ds_read_b64_tr_b16 v[214:215], v22 offset:37376
    s_waitcnt lgkmcnt(2)
    ds_read_b64_tr_b16 v[60:61], v25 offset:36864
    ds_read_b64_tr_b16 v[62:63], v25 offset:37376
Lwl_32:
    s_waitcnt lgkmcnt(0)
    s_barrier
    s_add_u32 s29, s90, 4718592
    s_add_u32 m0, s95, 98304
    s_nop 0
    buffer_load_dwordx4 v16, s[16:19], s29 offen offset:0 nt lds
    s_add_u32 m0, s95, 99200
    s_nop 0
    buffer_load_dwordx4 v16, s[16:19], s29 offen offset:128 nt lds
    s_add_u32 m0, s95, 100096
    s_nop 0
    buffer_load_dwordx4 v16, s[16:19], s29 offen offset:256 nt lds
    s_add_u32 s29, s90, 5111808
    s_add_u32 m0, s95, 110592
    s_nop 0
    buffer_load_dwordx4 v16, s[16:19], s29 offen offset:0 nt lds
    s_add_u32 m0, s95, 111488
    s_nop 0
    buffer_load_dwordx4 v16, s[16:19], s29 offen offset:128 nt lds
    s_add_u32 m0, s95, 112384
    s_nop 0
    buffer_load_dwordx4 v16, s[16:19], s29 offen offset:256 nt lds
    s_add_u32 s29, s90, 5505024
    s_add_u32 m0, s95, 122880
    s_nop 0
    buffer_load_dwordx4 v16, s[16:19], s29 offen offset:0 nt lds
    s_add_u32 m0, s95, 123776
    s_nop 0
    buffer_load_dwordx4 v16, s[16:19], s29 offen offset:128 nt lds
    s_add_u32 m0, s95, 124672
    s_nop 0
    buffer_load_dwordx4 v16, s[16:19], s29 offen offset:256 nt lds
    s_add_u32 s29, s90, 5898240
    s_add_u32 m0, s95, 135168
    s_nop 0
    buffer_load_dwordx4 v16, s[16:19], s29 offen offset:0 nt lds
    s_add_u32 m0, s95, 136064
    s_nop 0
    buffer_load_dwordx4 v16, s[16:19], s29 offen offset:128 nt lds
    s_add_u32 m0, s95, 136960
    s_nop 0
    buffer_load_dwordx4 v16, s[16:19], s29 offen offset:256 nt lds
    s_waitcnt vmcnt(24)
    s_barrier
    s_cmp_eq_u32 s24, 1
    s_cbranch_scc1 Lwv_39
    s_cmp_eq_u32 s24, 2
    s_cbranch_scc1 Lwv_40
    s_cmp_eq_u32 s24, 3
    s_cbranch_scc1 Lwv_41
    ds_read_b64_tr_b16 a[248:249], v17 offset:0
    ds_read_b64_tr_b16 a[250:251], v17 offset:512
    ds_read_b64_tr_b16 v[200:201], v20 offset:0
    ds_read_b64_tr_b16 v[202:203], v20 offset:512
    ds_read_b64_tr_b16 v[48:49], v23 offset:0
    ds_read_b64_tr_b16 v[50:51], v23 offset:512
    ds_read_b64_tr_b16 a[252:253], v17 offset:12288
    ds_read_b64_tr_b16 a[254:255], v17 offset:12800
    ds_read_b64_tr_b16 v[204:205], v20 offset:12288
    ds_read_b64_tr_b16 v[206:207], v20 offset:12800
    ds_read_b64_tr_b16 v[52:53], v23 offset:12288
    ds_read_b64_tr_b16 v[54:55], v23 offset:12800
    s_waitcnt lgkmcnt(2)
    ds_read_b64_tr_b16 v[128:129], v17 offset:24576
    ds_read_b64_tr_b16 v[130:131], v17 offset:25088
    ds_read_b64_tr_b16 v[208:209], v20 offset:24576
    ds_read_b64_tr_b16 v[210:211], v20 offset:25088
    ds_read_b64_tr_b16 v[56:57], v23 offset:24576
    ds_read_b64_tr_b16 v[58:59], v23 offset:25088
    ds_read_b64_tr_b16 v[132:133], v17 offset:36864
    ds_read_b64_tr_b16 v[134:135], v17 offset:37376
    ds_read_b64_tr_b16 v[212:213], v20 offset:36864
    ds_read_b64_tr_b16 v[214:215], v20 offset:37376
    s_waitcnt lgkmcnt(2)
    ds_read_b64_tr_b16 v[60:61], v23 offset:36864
    ds_read_b64_tr_b16 v[62:63], v23 offset:37376
    s_branch Lwl_37
Lwv_39:
    ds_read_b64_tr_b16 a[232:233], v17 offset:0
    ds_read_b64_tr_b16 a[234:235], v17 offset:512
    ds_read_b64_tr_b16 v[184:185], v20 offset:0
    ds_read_b64_tr_b16 v[186:187], v20 offset:512
    ds_read_b64_tr_b16 v[32:33], v23 offset:0
    ds_read_b64_tr_b16 v[34:35], v23 offset:512
    ds_read_b64_tr_b16 a[236:237], v17 offset:12288
    ds_read_b64_tr_b16 a[238:239], v17 offset:12800
    ds_read_b64_tr_b16 v[188:189], v20 offset:12288
    ds_read_b64_tr_b16 v[190:191], v20 offset:12800
    ds_read_b64_tr_b16 v[36:37], v23 offset:12288
    ds_read_b64_tr_b16 v[38:39], v23 offset:12800
    s_waitcnt lgkmcnt(2)
    ds_read_b64_tr_b16 a[240:241], v17 offset:24576
    ds_read_b64_tr_b16 a[242:243], v17 offset:25088
    ds_read_b64_tr_b16 v[192:193], v20 offset:24576
    ds_read_b64_tr_b16 v[194:195], v20 offset:25088
    ds_read_b64_tr_b16 v[40:41], v23 offset:24576
    ds_read_b64_tr_b16 v[42:43], v23 offset:25088
    ds_read_b64_tr_b16 a[244:245], v17 offset:36864
    ds_read_b64_tr_b16 a[246:247], v17 offset:37376
    ds_read_b64_tr_b16 v[196:197], v20 offset:36864
    ds_read_b64_tr_b16 v[198:199], v20 offset:37376
    s_waitcnt lgkmcnt(2)
    ds_read_b64_tr_b16 v[44:45], v23 offset:36864
    ds_read_b64_tr_b16 v[46:47], v23 offset:37376
    s_branch Lwl_37
Lwv_40:
    ds_read_b64_tr_b16 v[152:153], v17 offset:0
    ds_read_b64_tr_b16 v[154:155], v17 offset:512
    ds_read_b64_tr_b16 v[224:225], v20 offset:0
    ds_read_b64_tr_b16 v[226:227], v20 offset:512
    ds_read_b64_tr_b16 v[88:89], v23 offset:0
    ds_read_b64_tr_b16 v[90:91], v23 offset:512
    ds_read_b64_tr_b16 v[156:157], v17 offset:12288
    ds_read_b64_tr_b16 v[158:159], v17 offset:12800
    ds_read_b64_tr_b16 v[228:229], v20 offset:12288
    ds_read_b64_tr_b16 v[230:231], v20 offset:12800
    ds_read_b64_tr_b16 v[92:93], v23 offset:12288
    ds_read_b64_tr_b16 v[94:95], v23 offset:12800
    s_waitcnt lgkmcnt(2)
    ds_read_b64_tr_b16 v[160:161], v17 offset:24576
    ds_read_b64_tr_b16 v[162:163], v17 offset:25088
    ds_read_b64_tr_b16 v[232:233], v20 offset:24576
    ds_read_b64_tr_b16 v[234:235], v20 offset:25088
    ds_read_b64_tr_b16 v[104:105], v23 offset:24576
    ds_read_b64_tr_b16 v[106:107], v23 offset:25088
    ds_read_b64_tr_b16 v[164:165], v17 offset:36864
    ds_read_b64_tr_b16 v[166:167], v17 offset:37376
    ds_read_b64_tr_b16 v[236:237], v20 offset:36864
    ds_read_b64_tr_b16 v[238:239], v20 offset:37376
    s_waitcnt lgkmcnt(2)
    ds_read_b64_tr_b16 v[108:109], v23 offset:36864
    ds_read_b64_tr_b16 v[110:111], v23 offset:37376
    s_branch Lwl_37
Lwv_41:
    ds_read_b64_tr_b16 v[136:137], v17 offset:0
    ds_read_b64_tr_b16 v[138:139], v17 offset:512
    ds_read_b64_tr_b16 v[216:217], v20 offset:0
    ds_read_b64_tr_b16 v[218:219], v20 offset:512
    ds_read_b64_tr_b16 v[64:65], v23 offset:0
    ds_read_b64_tr_b16 v[66:67], v23 offset:512
    ds_read_b64_tr_b16 v[140:141], v17 offset:12288
    ds_read_b64_tr_b16 v[142:143], v17 offset:12800
    ds_read_b64_tr_b16 v[220:221], v20 offset:12288
    ds_read_b64_tr_b16 v[222:223], v20 offset:12800
    ds_read_b64_tr_b16 v[68:69], v23 offset:12288
    ds_read_b64_tr_b16 v[70:71], v23 offset:12800
    s_waitcnt lgkmcnt(2)
    ds_read_b64_tr_b16 v[144:145], v17 offset:24576
    ds_read_b64_tr_b16 v[146:147], v17 offset:25088
    ds_read_b64_tr_b16 v[72:73], v20 offset:24576
    ds_read_b64_tr_b16 v[74:75], v20 offset:25088
    ds_read_b64_tr_b16 v[80:81], v23 offset:24576
    ds_read_b64_tr_b16 v[82:83], v23 offset:25088
    ds_read_b64_tr_b16 v[148:149], v17 offset:36864
    ds_read_b64_tr_b16 v[150:151], v17 offset:37376
    ds_read_b64_tr_b16 v[76:77], v20 offset:36864
    ds_read_b64_tr_b16 v[78:79], v20 offset:37376
    s_waitcnt lgkmcnt(2)
    ds_read_b64_tr_b16 v[84:85], v23 offset:36864
    ds_read_b64_tr_b16 v[86:87], v23 offset:37376
Lwl_37:
    s_waitcnt lgkmcnt(0)
    s_barrier
    s_add_u32 s29, s90, 6291456
    s_add_u32 m0, s95, 0
    s_nop 0
    buffer_load_dwordx4 v16, s[16:19], s29 offen offset:0 nt lds
    s_add_u32 m0, s95, 896
    s_nop 0
    buffer_load_dwordx4 v16, s[16:19], s29 offen offset:128 nt lds
    s_add_u32 m0, s95, 1792
    s_nop 0
    buffer_load_dwordx4 v16, s[16:19], s29 offen offset:256 nt lds
    s_add_u32 s29, s90, 6684672
    s_add_u32 m0, s95, 12288
    s_nop 0
    buffer_load_dwordx4 v16, s[16:19], s29 offen offset:0 nt lds
    s_add_u32 m0, s95, 13184
    s_nop 0
    buffer_load_dwordx4 v16, s[16:19], s29 offen offset:128 nt lds
    s_add_u32 m0, s95, 14080
    s_nop 0
    buffer_load_dwordx4 v16, s[16:19], s29 offen offset:256 nt lds
    s_add_u32 s29, s90, 7077888
    s_add_u32 m0, s95, 24576
    s_nop 0
    buffer_load_dwordx4 v16, s[16:19], s29 offen offset:0 nt lds
    s_add_u32 m0, s95, 25472
    s_nop 0
    buffer_load_dwordx4 v16, s[16:19], s29 offen offset:128 nt lds
    s_add_u32 m0, s95, 26368
    s_nop 0
    buffer_load_dwordx4 v16, s[16:19], s29 offen offset:256 nt lds
    s_add_u32 s29, s90, 7471104
    s_add_u32 m0, s95, 36864
    s_nop 0
    buffer_load_dwordx4 v16, s[16:19], s29 offen offset:0 nt lds
    s_add_u32 m0, s95, 37760
    s_nop 0
    buffer_load_dwordx4 v16, s[16:19], s29 offen offset:128 nt lds
    s_add_u32 m0, s95, 38656
    s_nop 0
    buffer_load_dwordx4 v16, s[16:19], s29 offen offset:256 nt lds
    s_waitcnt vmcnt(24)
    s_barrier
    s_cmp_eq_u32 s24, 1
    s_cbranch_scc1 Lwv_44
    s_cmp_eq_u32 s24, 2
    s_cbranch_scc1 Lwv_45
    s_cmp_eq_u32 s24, 3
    s_cbranch_scc1 Lwv_46
    ds_read_b64_tr_b16 v[136:137], v18 offset:0
    ds_read_b64_tr_b16 v[138:139], v18 offset:512
    ds_read_b64_tr_b16 v[216:217], v21 offset:0
    ds_read_b64_tr_b16 v[218:219], v21 offset:512
    ds_read_b64_tr_b16 v[64:65], v24 offset:0
    ds_read_b64_tr_b16 v[66:67], v24 offset:512
    ds_read_b64_tr_b16 v[140:141], v18 offset:12288
    ds_read_b64_tr_b16 v[142:143], v18 offset:12800
    ds_read_b64_tr_b16 v[220:221], v21 offset:12288
    ds_read_b64_tr_b16 v[222:223], v21 offset:12800
    ds_read_b64_tr_b16 v[68:69], v24 offset:12288
    ds_read_b64_tr_b16 v[70:71], v24 offset:12800
    s_waitcnt lgkmcnt(2)
    ds_read_b64_tr_b16 v[144:145], v18 offset:24576
    ds_read_b64_tr_b16 v[146:147], v18 offset:25088
    ds_read_b64_tr_b16 v[72:73], v21 offset:24576
    ds_read_b64_tr_b16 v[74:75], v21 offset:25088
    ds_read_b64_tr_b16 v[80:81], v24 offset:24576
    ds_read_b64_tr_b16 v[82:83], v24 offset:25088
    ds_read_b64_tr_b16 v[148:149], v18 offset:36864
    ds_read_b64_tr_b16 v[150:151], v18 offset:37376
    ds_read_b64_tr_b16 v[76:77], v21 offset:36864
    ds_read_b64_tr_b16 v[78:79], v21 offset:37376
    s_waitcnt lgkmcnt(2)
    ds_read_b64_tr_b16 v[84:85], v24 offset:36864
    ds_read_b64_tr_b16 v[86:87], v24 offset:37376
    s_branch Lwl_42
Lwv_44:
    ds_read_b64_tr_b16 a[248:249], v18 offset:0
    ds_read_b64_tr_b16 a[250:251], v18 offset:512
    ds_read_b64_tr_b16 v[200:201], v21 offset:0
    ds_read_b64_tr_b16 v[202:203], v21 offset:512
    ds_read_b64_tr_b16 v[48:49], v24 offset:0
    ds_read_b64_tr_b16 v[50:51], v24 offset:512
    ds_read_b64_tr_b16 a[252:253], v18 offset:12288
    ds_read_b64_tr_b16 a[254:255], v18 offset:12800
    ds_read_b64_tr_b16 v[204:205], v21 offset:12288
    ds_read_b64_tr_b16 v[206:207], v21 offset:12800
    ds_read_b64_tr_b16 v[52:53], v24 offset:12288
    ds_read_b64_tr_b16 v[54:55], v24 offset:12800
    s_waitcnt lgkmcnt(2)
    ds_read_b64_tr_b16 v[128:129], v18 offset:24576
    ds_read_b64_tr_b16 v[130:131], v18 offset:25088
    ds_read_b64_tr_b16 v[208:209], v21 offset:24576
    ds_read_b64_tr_b16 v[210:211], v21 offset:25088
    ds_read_b64_tr_b16 v[56:57], v24 offset:24576
    ds_read_b64_tr_b16 v[58:59], v24 offset:25088
    ds_read_b64_tr_b16 v[132:133], v18 offset:36864
    ds_read_b64_tr_b16 v[134:135], v18 offset:37376
    ds_read_b64_tr_b16 v[212:213], v21 offset:36864
    ds_read_b64_tr_b16 v[214:215], v21 offset:37376
    s_waitcnt lgkmcnt(2)
    ds_read_b64_tr_b16 v[60:61], v24 offset:36864
    ds_read_b64_tr_b16 v[62:63], v24 offset:37376
    s_branch Lwl_42
Lwv_45:
    ds_read_b64_tr_b16 a[232:233], v18 offset:0
    ds_read_b64_tr_b16 a[234:235], v18 offset:512
    ds_read_b64_tr_b16 v[184:185], v21 offset:0
    ds_read_b64_tr_b16 v[186:187], v21 offset:512
    ds_read_b64_tr_b16 v[32:33], v24 offset:0
    ds_read_b64_tr_b16 v[34:35], v24 offset:512
    ds_read_b64_tr_b16 a[236:237], v18 offset:12288
    ds_read_b64_tr_b16 a[238:239], v18 offset:12800
    ds_read_b64_tr_b16 v[188:189], v21 offset:12288
    ds_read_b64_tr_b16 v[190:191], v21 offset:12800
    ds_read_b64_tr_b16 v[36:37], v24 offset:12288
    ds_read_b64_tr_b16 v[38:39], v24 offset:12800
    s_waitcnt lgkmcnt(2)
    ds_read_b64_tr_b16 a[240:241], v18 offset:24576
    ds_read_b64_tr_b16 a[242:243], v18 offset:25088
    ds_read_b64_tr_b16 v[192:193], v21 offset:24576
    ds_read_b64_tr_b16 v[194:195], v21 offset:25088
    ds_read_b64_tr_b16 v[40:41], v24 offset:24576
    ds_read_b64_tr_b16 v[42:43], v24 offset:25088
    ds_read_b64_tr_b16 a[244:245], v18 offset:36864
    ds_read_b64_tr_b16 a[246:247], v18 offset:37376
    ds_read_b64_tr_b16 v[196:197], v21 offset:36864
    ds_read_b64_tr_b16 v[198:199], v21 offset:37376
    s_waitcnt lgkmcnt(2)
    ds_read_b64_tr_b16 v[44:45], v24 offset:36864
    ds_read_b64_tr_b16 v[46:47], v24 offset:37376
    s_branch Lwl_42
Lwv_46:
    ds_read_b64_tr_b16 v[152:153], v18 offset:0
    ds_read_b64_tr_b16 v[154:155], v18 offset:512
    ds_read_b64_tr_b16 v[224:225], v21 offset:0
    ds_read_b64_tr_b16 v[226:227], v21 offset:512
    ds_read_b64_tr_b16 v[88:89], v24 offset:0
    ds_read_b64_tr_b16 v[90:91], v24 offset:512
    ds_read_b64_tr_b16 v[156:157], v18 offset:12288
    ds_read_b64_tr_b16 v[158:159], v18 offset:12800
    ds_read_b64_tr_b16 v[228:229], v21 offset:12288
    ds_read_b64_tr_b16 v[230:231], v21 offset:12800
    ds_read_b64_tr_b16 v[92:93], v24 offset:12288
    ds_read_b64_tr_b16 v[94:95], v24 offset:12800
    s_waitcnt lgkmcnt(2)
    ds_read_b64_tr_b16 v[160:161], v18 offset:24576
    ds_read_b64_tr_b16 v[162:163], v18 offset:25088
    ds_read_b64_tr_b16 v[232:233], v21 offset:24576
    ds_read_b64_tr_b16 v[234:235], v21 offset:25088
    ds_read_b64_tr_b16 v[104:105], v24 offset:24576
    ds_read_b64_tr_b16 v[106:107], v24 offset:25088
    ds_read_b64_tr_b16 v[164:165], v18 offset:36864
    ds_read_b64_tr_b16 v[166:167], v18 offset:37376
    ds_read_b64_tr_b16 v[236:237], v21 offset:36864
    ds_read_b64_tr_b16 v[238:239], v21 offset:37376
    s_waitcnt lgkmcnt(2)
    ds_read_b64_tr_b16 v[108:109], v24 offset:36864
    ds_read_b64_tr_b16 v[110:111], v24 offset:37376
Lwl_42:
    s_waitcnt lgkmcnt(0)
    s_waitcnt vmcnt(12)
    s_barrier
    s_cmp_eq_u32 s24, 1
    s_cbranch_scc1 Lwv_49
    s_cmp_eq_u32 s24, 2
    s_cbranch_scc1 Lwv_50
    s_cmp_eq_u32 s24, 3
    s_cbranch_scc1 Lwv_51
    ds_read_b64_tr_b16 v[152:153], v19 offset:0
    ds_read_b64_tr_b16 v[154:155], v19 offset:512
    ds_read_b64_tr_b16 v[224:225], v22 offset:0
    ds_read_b64_tr_b16 v[226:227], v22 offset:512
    ds_read_b64_tr_b16 v[88:89], v25 offset:0
    ds_read_b64_tr_b16 v[90:91], v25 offset:512
    ds_read_b64_tr_b16 v[156:157], v19 offset:12288
    ds_read_b64_tr_b16 v[158:159], v19 offset:12800
    ds_read_b64_tr_b16 v[228:229], v22 offset:12288
    ds_read_b64_tr_b16 v[230:231], v22 offset:12800
    ds_read_b64_tr_b16 v[92:93], v25 offset:12288
    ds_read_b64_tr_b16 v[94:95], v25 offset:12800
    s_waitcnt lgkmcnt(2)
    ds_read_b64_tr_b16 v[160:161], v19 offset:24576
    ds_read_b64_tr_b16 v[162:163], v19 offset:25088
    ds_read_b64_tr_b16 v[232:233], v22 offset:24576
    ds_read_b64_tr_b16 v[234:235], v22 offset:25088
    ds_read_b64_tr_b16 v[104:105], v25 offset:24576
    ds_read_b64_tr_b16 v[106:107], v25 offset:25088
    ds_read_b64_tr_b16 v[164:165], v19 offset:36864
    ds_read_b64_tr_b16 v[166:167], v19 offset:37376
    ds_read_b64_tr_b16 v[236:237], v22 offset:36864
    ds_read_b64_tr_b16 v[238:239], v22 offset:37376
    s_waitcnt lgkmcnt(2)
    ds_read_b64_tr_b16 v[108:109], v25 offset:36864
    ds_read_b64_tr_b16 v[110:111], v25 offset:37376
    s_branch Lwl_47
Lwv_49:
    ds_read_b64_tr_b16 v[136:137], v19 offset:0
    ds_read_b64_tr_b16 v[138:139], v19 offset:512
    ds_read_b64_tr_b16 v[216:217], v22 offset:0
    ds_read_b64_tr_b16 v[218:219], v22 offset:512
    ds_read_b64_tr_b16 v[64:65], v25 offset:0
    ds_read_b64_tr_b16 v[66:67], v25 offset:512
    ds_read_b64_tr_b16 v[140:141], v19 offset:12288
    ds_read_b64_tr_b16 v[142:143], v19 offset:12800
    ds_read_b64_tr_b16 v[220:221], v22 offset:12288
    ds_read_b64_tr_b16 v[222:223], v22 offset:12800
    ds_read_b64_tr_b16 v[68:69], v25 offset:12288
    ds_read_b64_tr_b16 v[70:71], v25 offset:12800
    s_waitcnt lgkmcnt(2)
    ds_read_b64_tr_b16 v[144:145], v19 offset:24576
    ds_read_b64_tr_b16 v[146:147], v19 offset:25088
    ds_read_b64_tr_b16 v[72:73], v22 offset:24576
    ds_read_b64_tr_b16 v[74:75], v22 offset:25088
    ds_read_b64_tr_b16 v[80:81], v25 offset:24576
    ds_read_b64_tr_b16 v[82:83], v25 offset:25088
    ds_read_b64_tr_b16 v[148:149], v19 offset:36864
    ds_read_b64_tr_b16 v[150:151], v19 offset:37376
    ds_read_b64_tr_b16 v[76:77], v22 offset:36864
    ds_read_b64_tr_b16 v[78:79], v22 offset:37376
    s_waitcnt lgkmcnt(2)
    ds_read_b64_tr_b16 v[84:85], v25 offset:36864
    ds_read_b64_tr_b16 v[86:87], v25 offset:37376
    s_branch Lwl_47
Lwv_50:
    ds_read_b64_tr_b16 a[248:249], v19 offset:0
    ds_read_b64_tr_b16 a[250:251], v19 offset:512
    ds_read_b64_tr_b16 v[200:201], v22 offset:0
    ds_read_b64_tr_b16 v[202:203], v22 offset:512
    ds_read_b64_tr_b16 v[48:49], v25 offset:0
    ds_read_b64_tr_b16 v[50:51], v25 offset:512
    ds_read_b64_tr_b16 a[252:253], v19 offset:12288
    ds_read_b64_tr_b16 a[254:255], v19 offset:12800
    ds_read_b64_tr_b16 v[204:205], v22 offset:12288
    ds_read_b64_tr_b16 v[206:207], v22 offset:12800
    ds_read_b64_tr_b16 v[52:53], v25 offset:12288
    ds_read_b64_tr_b16 v[54:55], v25 offset:12800
    s_waitcnt lgkmcnt(2)
    ds_read_b64_tr_b16 v[128:129], v19 offset:24576
    ds_read_b64_tr_b16 v[130:131], v19 offset:25088
    ds_read_b64_tr_b16 v[208:209], v22 offset:24576
    ds_read_b64_tr_b16 v[210:211], v22 offset:25088
    ds_read_b64_tr_b16 v[56:57], v25 offset:24576
    ds_read_b64_tr_b16 v[58:59], v25 offset:25088
    ds_read_b64_tr_b16 v[132:133], v19 offset:36864
    ds_read_b64_tr_b16 v[134:135], v19 offset:37376
    ds_read_b64_tr_b16 v[212:213], v22 offset:36864
    ds_read_b64_tr_b16 v[214:215], v22 offset:37376
    s_waitcnt lgkmcnt(2)
    ds_read_b64_tr_b16 v[60:61], v25 offset:36864
    ds_read_b64_tr_b16 v[62:63], v25 offset:37376
    s_branch Lwl_47
Lwv_51:
    ds_read_b64_tr_b16 a[232:233], v19 offset:0
    ds_read_b64_tr_b16 a[234:235], v19 offset:512
    ds_read_b64_tr_b16 v[184:185], v22 offset:0
    ds_read_b64_tr_b16 v[186:187], v22 offset:512
    ds_read_b64_tr_b16 v[32:33], v25 offset:0
    ds_read_b64_tr_b16 v[34:35], v25 offset:512
    ds_read_b64_tr_b16 a[236:237], v19 offset:12288
    ds_read_b64_tr_b16 a[238:239], v19 offset:12800
    ds_read_b64_tr_b16 v[188:189], v22 offset:12288
    ds_read_b64_tr_b16 v[190:191], v22 offset:12800
    ds_read_b64_tr_b16 v[36:37], v25 offset:12288
    ds_read_b64_tr_b16 v[38:39], v25 offset:12800
    s_waitcnt lgkmcnt(2)
    ds_read_b64_tr_b16 a[240:241], v19 offset:24576
    ds_read_b64_tr_b16 a[242:243], v19 offset:25088
    ds_read_b64_tr_b16 v[192:193], v22 offset:24576
    ds_read_b64_tr_b16 v[194:195], v22 offset:25088
    ds_read_b64_tr_b16 v[40:41], v25 offset:24576
    ds_read_b64_tr_b16 v[42:43], v25 offset:25088
    ds_read_b64_tr_b16 a[244:245], v19 offset:36864
    ds_read_b64_tr_b16 a[246:247], v19 offset:37376
    ds_read_b64_tr_b16 v[196:197], v22 offset:36864
    ds_read_b64_tr_b16 v[198:199], v22 offset:37376
    s_waitcnt lgkmcnt(2)
    ds_read_b64_tr_b16 v[44:45], v25 offset:36864
    ds_read_b64_tr_b16 v[46:47], v25 offset:37376
Lwl_47:
    s_waitcnt lgkmcnt(0)
    s_waitcnt vmcnt(0)
    s_barrier
    ds_read_b64_tr_b16 v[168:169], v17 offset:0
    ds_read_b64_tr_b16 v[170:171], v17 offset:512
    ds_read_b64_tr_b16 v[240:241], v20 offset:0
    ds_read_b64_tr_b16 v[242:243], v20 offset:512
    ds_read_b64_tr_b16 v[112:113], v23 offset:0
    ds_read_b64_tr_b16 v[114:115], v23 offset:512
    ds_read_b64_tr_b16 v[172:173], v17 offset:12288
    ds_read_b64_tr_b16 v[174:175], v17 offset:12800
    ds_read_b64_tr_b16 v[244:245], v20 offset:12288
    ds_read_b64_tr_b16 v[246:247], v20 offset:12800
    ds_read_b64_tr_b16 v[116:117], v23 offset:12288
    ds_read_b64_tr_b16 v[118:119], v23 offset:12800
    s_waitcnt lgkmcnt(2)
    ds_read_b64_tr_b16 v[176:177], v17 offset:24576
    ds_read_b64_tr_b16 v[178:179], v17 offset:25088
    ds_read_b64_tr_b16 v[248:249], v20 offset:24576
    ds_read_b64_tr_b16 v[250:251], v20 offset:25088
    ds_read_b64_tr_b16 v[120:121], v23 offset:24576
    ds_read_b64_tr_b16 v[122:123], v23 offset:25088
    ds_read_b64_tr_b16 v[180:181], v17 offset:36864
    ds_read_b64_tr_b16 v[182:183], v17 offset:37376
    ds_read_b64_tr_b16 v[252:253], v20 offset:36864
    ds_read_b64_tr_b16 v[254:255], v20 offset:37376
    s_waitcnt lgkmcnt(2)
    ds_read_b64_tr_b16 v[124:125], v23 offset:36864
    ds_read_b64_tr_b16 v[126:127], v23 offset:37376
Lwl_52:
    s_waitcnt lgkmcnt(0)
    s_barrier
    s_mul_i32 s30, s24, 24576
    v_add_u32 v20, s30, v4
    ds_write_b128 v20, v[32:35] offset:0
    ds_write_b128 v20, v[36:39] offset:1024
    ds_write_b128 v20, v[40:43] offset:2048
    ds_write_b128 v20, v[44:47] offset:3072
    ds_write_b128 v20, v[48:51] offset:4096
    ds_write_b128 v20, v[52:55] offset:5120
    ds_write_b128 v20, v[56:59] offset:6144
    ds_write_b128 v20, v[60:63] offset:7168
    s_waitcnt lgkmcnt(0)
    ds_write_b128 v20, v[64:67] offset:8192
    ds_write_b128 v20, v[68:71] offset:9216
    ds_write_b128 v20, v[72:75] offset:10240
    ds_write_b128 v20, v[76:79] offset:11264
    ds_write_b128 v20, v[80:83] offset:12288
    ds_write_b128 v20, v[84:87] offset:13312
    ds_write_b128 v20, v[88:91] offset:14336
    ds_write_b128 v20, v[92:95] offset:15360
    s_waitcnt lgkmcnt(0)
    ds_write_b128 v20, v[96:99] offset:16384
    ds_write_b128 v20, v[100:103] offset:17408
    ds_write_b128 v20, v[104:107] offset:18432
    ds_write_b128 v20, v[108:111] offset:19456
    ds_write_b128 v20, v[112:115] offset:20480
    ds_write_b128 v20, v[116:119] offset:21504
    ds_write_b128 v20, v[120:123] offset:22528
    ds_write_b128 v20, v[124:127] offset:23552
    s_waitcnt lgkmcnt(0)
    s_waitcnt lgkmcnt(0)
    s_add_u32 s28, s24, 1
    s_and_b32 s28, s28, 3
    s_lshl_b32 s31, s28, 11
    s_add_u32 s31, s31, 98304
    v_add_u32 v21, s31, v4
    s_add_u32 s28, s24, 2
    s_and_b32 s28, s28, 3
    s_lshl_b32 s31, s28, 11
    s_add_u32 s31, s31, 98304
    v_add_u32 v22, s31, v4
    s_add_u32 s28, s24, 3
    s_and_b32 s28, s28, 3
    s_lshl_b32 s31, s28, 11
    s_add_u32 s31, s31, 98304
    v_add_u32 v23, s31, v4
    s_cmp_lg_u32 s24, 0
    s_cbranch_scc1 Lgod_55
    v_mov_b32 v5, 132
Lgo_54:
    buffer_load_dword v6, v5, s[20:23], 0 offen sc1
    s_waitcnt vmcnt(0)
    v_cmp_eq_u32 vcc, 0, v6
    s_cbranch_vccz Lgod_55
    s_sleep 2
    s_sub_u32 s27, s27, 1
    s_cbranch_scc1 L_exit
    s_branch Lgo_54
Lgod_55:
    s_barrier
    v_mov_b32 v5, 0
    buffer_load_dword v6, v5, s[20:23], 0 offen offset:136 sc1
    s_waitcnt vmcnt(0)
    v_readfirstlane_b32 s28, v6
    s_nop 0
    s_and_b32 s100, s28, 1
    s_lshl_b32 s100, s100, 13
    s_and_b32 s101, s28, 0x100
    s_lshl_b32 s101, s101, 5
    s_and_b32 s73, s28, 0x10000
    s_lshr_b32 s73, s73, 3
    s_sub_u32 s101, s101, s100
    s_add_u32 s101, s101, 65536
    v_lshlrev_b32 v17, 2, v1
    s_lshl_b32 s28, s24, 11
    s_add_u32 s28, s28, 98304
    v_add_u32 v18, s28, v4
    s_lshl_b32 s28, s24, 9
    s_add_u32 s28, s28, 106496
    v_add_u32 v19, s28, v17
    s_mul_i32 s74, s24, 16384
    s_add_u32 s74, s74, 0xc001400
    v_mov_b32 v16, 0x4444
    v_mov_b32 v6, 0xeeee
    v_and_b32 v7, 2, v2
    v_cmp_lt_u32 vcc, 0, v7
    s_nop 1
    v_cndmask_b32 v16, v16, v6, vcc
    v_mov_b32 v5, 0
    v_add_u32 v24, 106496, v4
    s_mul_i32 s28, s24, 1536
    s_add_u32 s28, s28, 108544
    v_lshrrev_b32 v6, 1, v3
    v_lshrrev_b32 v7, 2, v2
    v_xor_b32 v6, v6, v7
    v_lshlrev_b32 v25, 5, v2
    v_lshl_add_u32 v25, v6, 3, v25
    v_and_b32 v6, 1, v3
    v_lshl_add_u32 v25, v6, 2, v25
    v_add_u32 v25, s28, v25
    v_lshlrev_b32 v31, 3, v1
    v_and_b32 v7, 0x1ef, v31
    v_lshlrev_b32 v6, 3, v3
    v_xor_b32 v27, v6, v7
    v_add_u32 v27, 108544, v27
    v_xor_b32 v0, v6, v31
    v_add_u32 v0, 120832, v0
    v_lshrrev_b32 v7, 2, v2
    v_xor_b32 v6, v3, v7
    v_lshlrev_b32 v14, 5, v2
    v_lshl_add_u32 v14, v6, 3, v14
    v_add_u32 v14, s28, v14
    v_add_u32 v14, 12288, v14
    s_and_b32 s28, s24, 1
    s_mul_i32 s28, s28, 6144
    s_add_u32 s28, s28, 131072
    v_add_u32 v31, s28, v31
    s_cmp_eq_u32 s24, 3
    s_cbranch_scc1 L_r1_s3
    s_lshl_b32 s28, s24, 6
    s_add_u32 s28, s28, 114688
    v_mul_u32_u24 v28, 208, v2
    v_lshl_add_u32 v28, v3, 4, v28
    v_add_u32 v28, s28, v28
    v_and_b32 v6, 1, v2
    v_lshrrev_b32 v7, 2, v2
    v_lshl_add_u32 v6, v7, 1, v6
    v_lshlrev_b32 v29, 4, v6
    v_lshl_add_u32 v29, v3, 7, v29
    v_mov_b32 v30, 0
    s_branch L_r1_s4
L_r1_s3:
    v_and_b32 v6, 1, v3
    v_lshlrev_b32 v6, 2, v6
    v_and_b32 v7, 2, v3
    v_add_u32 v6, v6, v7
    v_bfe_u32 v7, v2, 1, 1
    v_add_u32 v6, v6, v7
    v_bfe_u32 v7, v1, 2, 2
    v_and_b32 v56, 1, v1
    v_mul_u32_u24 v28, 208, v6
    v_add_u32 v28, 114688, v28
    v_lshl_add_u32 v28, v56, 6, v28
    v_lshl_add_u32 v28, v7, 4, v28
    v_lshlrev_b32 v29, 7, v7
    v_lshl_add_u32 v29, v6, 4, v29
    v_lshl_add_u32 v29, v56, 3, v29
    v_lshlrev_b32 v3, 2, v7
    v_lshl_add_u32 v3, v6, 4, v3
    v_mov_b32 v30, 0
L_r1_s4:
    s_mov_b32 s80, 0x3dd53b95
    s_mov_b32 s32, 0x55555555
    s_mov_b32 s33, 0x55555555
    s_mov_b32 s34, 0xcccccccc
    s_mov_b32 s35, 0xcccccccc
    s_mov_b32 s36, 0
    s_mov_b32 s37, -1
    s_lshr_b32 s75, s25, 3
    s_mul_i32 s75, s75, 16384
    s_and_b32 s28, s25, 7
    s_mul_i32 s28, s28, 640
    s_add_u32 s75, s75, s28
    s_add_u32 s75, s75, 0xc000000
    s_mul_i32 s76, s25, 196608
    s_add_u32 s76, s76, 0x4200000
    s_mul_i32 s77, s25, 786432
    s_add_u32 s77, s77, 0x2a00000
    s_lshl_b32 s78, s25, 7
    s_add_u32 s79, s78, 0xba11000
    s_add_u32 s78, s78, 0xba10000
    s_mov_b32 s82, 0
    s_lshl_b32 s83, s25, 7
    s_add_u32 s83, s83, 0xc400000
    s_add_u32 s74, s74, s100
    s_add_u32 s75, s75, s100
    s_add_u32 s83, s83, s73
    s_mov_b32 s26, 0
    s_lshl_b32 s28, s24, 4
    v_add_u32 v6, s28, v1
    s_lshl_b32 s28, s24, 2
    s_add_u32 s28, s28, 48
    v_add_u32 v7, s28, v1
    v_cmp_lt_u32 vcc, 15, v1
    s_nop 1
    v_cndmask_b32 v6, v6, v7, vcc
    v_cmp_lt_u32 vcc, 39, v6
    v_mov_b32 v7, 11264
    s_nop 0
    v_cndmask_b32 v7, v5, v7, vcc
    v_lshl_add_u32 v26, v6, 7, v7
    s_add_u32 s85, s73, 0xc40c000
    v_lshlrev_b32 v15, 14, v1
    v_mov_b32 v6, 0x10000000
    v_cmp_lt_u32 vcc, 2, v1
    s_nop 1
    v_cndmask_b32 v15, v15, v6, vcc
    s_cmp_eq_u32 s24, 2
    s_cselect_b32 s83, s83, 0x10000000
    s_mul_i32 s84, s24, 3072
    s_add_u32 s77, s77, s84
    s_add_u32 s84, s84, 131072
    s_mov_b32 s81, 1
Lwf_56:
    buffer_load_dword v1, v5, s[4:7], s78 offen sc1
    s_waitcnt vmcnt(0)
    v_cmp_gt_u32 vcc, s81, v1
    s_cbranch_vccz Lwfd_57
    s_sleep 1
    s_sub_u32 s27, s27, 1
    s_cbranch_scc1 L_exit
    s_branch Lwf_56
Lwfd_57:
    s_mov_b32 m0, s84
    s_nop 0
    buffer_load_dwordx4 v4, s[4:7], s77 offen offset:0 sc1 lds
    buffer_load_dwordx4 v4, s[4:7], s77 offen offset:1024 sc1 lds
    buffer_load_dwordx4 v4, s[4:7], s77 offen offset:2048 sc1 lds
L_r1_top:
    ds_read_b128 v[96:99], v20 offset:0
    ds_read_b128 v[100:103], v20 offset:1024
    ds_read_b128 v[104:107], v20 offset:2048
    ds_read_b128 v[108:111], v20 offset:3072
    ds_read_b128 v[112:115], v20 offset:4096
    ds_read_b128 v[116:119], v20 offset:5120
    ds_read_b128 v[120:123], v20 offset:6144
    ds_read_b128 v[124:127], v20 offset:7168
    v_mov_b32 v72, 0
    v_mov_b32 v73, 0
    v_mov_b32 v74, 0
    v_mov_b32 v75, 0
    v_mov_b32 v76, 0
    v_mov_b32 v77, 0
    v_mov_b32 v78, 0
    v_mov_b32 v79, 0
    v_mov_b32 v80, 0
    v_mov_b32 v81, 0
    v_mov_b32 v82, 0
    v_mov_b32 v83, 0
    v_mov_b32 v84, 0
    v_mov_b32 v85, 0
    v_mov_b32 v86, 0
    v_mov_b32 v87, 0
    v_mov_b32 v88, 0
    v_mov_b32 v89, 0
    v_mov_b32 v90, 0
    v_mov_b32 v91, 0
    v_mov_b32 v92, 0
    v_mov_b32 v93, 0
    v_mov_b32 v94, 0
    v_mov_b32 v95, 0
    v_mov_b32 v30, s26
    s_add_u32 s81, s26, 2
    s_min_u32 s81, s81, 64
    s_add_u32 s77, s77, 12288
    s_xor_b32 s84, s84, 16384
    s_cmp_ge_u32 s82, s81
    s_cbranch_scc1 L_r1_kk
Lwf_58:
    buffer_load_dword v1, v5, s[4:7], s78 offen sc1
    s_waitcnt vmcnt(0)
    v_cmp_gt_u32 vcc, s81, v1
    s_cbranch_vccz Lwfd_59
    s_sleep 1
    s_sub_u32 s27, s27, 1
    s_cbranch_scc1 L_exit
    s_branch Lwf_58
Lwfd_59:
    v_readfirstlane_b32 s82, v1
L_r1_kk:
    s_sub_u32 s29, s26, 1
    v_mov_b32 v6, -2
    s_mov_b64 exec, 0xfffff
L_r1_hu:
    buffer_load_dword v6, v26, s[4:7], s85 offen sc1
    s_sub_u32 s27, s27, 1
    s_cbranch_scc1 L_exit
    s_waitcnt vmcnt(1)
    v_cmp_gt_i32 vcc, s29, v6
    s_cbranch_vccnz L_r1_hu
    s_mov_b64 exec, -1
    buffer_load_dwordx4 v[32:35], v4, s[4:7], s74 offen offset:0 sc1
    buffer_load_dwordx4 v[36:39], v4, s[4:7], s74 offen offset:1024 sc1
    buffer_load_dword v40, v17, s[4:7], s74 offen offset:2048 sc1
    buffer_load_dword v41, v17, s[4:7], s74 offen offset:2304 sc1
    s_waitcnt lgkmcnt(0)
L_r1_h0:
    s_waitcnt vmcnt(3)
    v_smfmac_f32_16x16x64_bf16 v[72:75], v[32:35], a[0:7], v16
    ds_write_b128 v18, v[32:35]
    v_max3_u32 v2, v32, v33, v34
    v_smfmac_f32_16x16x64_bf16 v[84:87], v[32:35], a[232:239], v16
    s_waitcnt vmcnt(0)
    ds_write_b128 v18, v[36:39] offset:1024
    ds_write2_b32 v19, v40, v41 offset0:0 offset1:64
    v_smfmac_f32_16x16x64_bf16 v[76:79], v[32:35], a[80:87], v16
    v_max3_u32 v2, v2, v35, v36
    v_max3_u32 v2, v2, v37, v38
    v_max3_u32 v2, v2, v39, v40
    v_smfmac_f32_16x16x64_bf16 v[88:91], v[32:35], v[184:191], v16
    v_max_u32 v2, v2, v41
    v_cmp_eq_u32 vcc, -1, v2
    v_smfmac_f32_16x16x64_bf16 v[80:83], v[32:35], a[152:159], v16
    v_smfmac_f32_16x16x64_bf16 v[72:75], v[36:39], a[8:15], v16
    v_smfmac_f32_16x16x64_bf16 v[84:87], v[36:39], a[240:247], v16
    s_cbranch_vccnz L_r1_f0
    s_waitcnt lgkmcnt(0)
    s_barrier
    ds_read_b128 v[64:67], v21 offset:0
    ds_read_b128 v[68:71], v21 offset:1024
    v_smfmac_f32_16x16x64_bf16 v[92:95], v[32:35], v[96:103], v16
    ds_read_b128 v[56:59], v22 offset:0
    v_smfmac_f32_16x16x64_bf16 v[76:79], v[36:39], a[88:95], v16
    ds_read_b128 v[60:63], v22 offset:1024
    v_smfmac_f32_16x16x64_bf16 v[88:91], v[36:39], v[192:199], v16
    ds_read_b128 v[96:99], v20 offset:8192
    v_smfmac_f32_16x16x64_bf16 v[80:83], v[36:39], a[160:167], v16
    ds_read_b128 v[100:103], v20 offset:9216
    v_smfmac_f32_16x16x64_bf16 v[92:95], v[36:39], v[104:111], v16
    ds_read_b128 v[104:107], v20 offset:10240
    ds_read_b128 v[108:111], v20 offset:11264
    s_waitcnt lgkmcnt(7)
    v_smfmac_f32_16x16x64_bf16 v[72:75], v[64:67], a[16:23], v16
    s_mov_b32 m0, s84
    v_smfmac_f32_16x16x64_bf16 v[84:87], v[64:67], a[248:255], v16
    buffer_load_dwordx4 v4, s[4:7], s77 offen offset:0 sc1 lds
    v_smfmac_f32_16x16x64_bf16 v[76:79], v[64:67], a[96:103], v16
    v_smfmac_f32_16x16x64_bf16 v[88:91], v[64:67], v[200:207], v16
    v_smfmac_f32_16x16x64_bf16 v[80:83], v[64:67], a[168:175], v16
    v_smfmac_f32_16x16x64_bf16 v[92:95], v[64:67], v[112:119], v16
    ds_read_b128 v[112:115], v20 offset:12288
    s_waitcnt lgkmcnt(7)
    v_smfmac_f32_16x16x64_bf16 v[72:75], v[68:71], a[24:31], v16
    ds_read_b128 v[116:119], v20 offset:13312
    v_smfmac_f32_16x16x64_bf16 v[84:87], v[68:71], v[128:135], v16
    ds_read_b128 v[64:67], v23 offset:0
    v_smfmac_f32_16x16x64_bf16 v[76:79], v[68:71], a[104:111], v16
    buffer_load_dwordx4 v4, s[4:7], s77 offen offset:1024 sc1 lds
    v_smfmac_f32_16x16x64_bf16 v[88:91], v[68:71], v[208:215], v16
    v_smfmac_f32_16x16x64_bf16 v[80:83], v[68:71], a[176:183], v16
    v_smfmac_f32_16x16x64_bf16 v[92:95], v[68:71], v[120:127], v16
    ds_read_b128 v[120:123], v20 offset:14336
    s_waitcnt lgkmcnt(9)
    v_smfmac_f32_16x16x64_bf16 v[72:75], v[56:59], a[32:39], v16
    ds_read_b128 v[124:127], v20 offset:15360
    v_smfmac_f32_16x16x64_bf16 v[84:87], v[56:59], v[136:143], v16
    ds_read_b128 v[68:71], v23 offset:1024
    v_smfmac_f32_16x16x64_bf16 v[76:79], v[56:59], a[112:119], v16
    buffer_load_dwordx4 v4, s[4:7], s77 offen offset:2048 sc1 lds
    v_smfmac_f32_16x16x64_bf16 v[88:91], v[56:59], v[216:223], v16
    v_smfmac_f32_16x16x64_bf16 v[80:83], v[56:59], a[184:191], v16
    s_waitcnt lgkmcnt(8)
    v_smfmac_f32_16x16x64_bf16 v[92:95], v[56:59], v[96:103], v16
    ds_read_b128 v[96:99], v20 offset:16384
    v_smfmac_f32_16x16x64_bf16 v[72:75], v[60:63], a[40:47], v16
    ds_read_b128 v[100:103], v20 offset:17408
    v_smfmac_f32_16x16x64_bf16 v[84:87], v[60:63], v[144:151], v16
    ds_read_b128 v[56:59], v24 offset:0
    v_smfmac_f32_16x16x64_bf16 v[76:79], v[60:63], a[120:127], v16
    s_waitcnt lgkmcnt(9)
    v_smfmac_f32_16x16x64_bf16 v[88:91], v[60:63], v[104:111], v16
    ds_read_b128 v[104:107], v20 offset:18432
    v_smfmac_f32_16x16x64_bf16 v[80:83], v[60:63], a[192:199], v16
    ds_read_b128 v[108:111], v20 offset:19456
    s_waitcnt lgkmcnt(9)
    v_smfmac_f32_16x16x64_bf16 v[92:95], v[60:63], v[112:119], v16
    ds_read_b128 v[112:115], v20 offset:20480
    s_waitcnt lgkmcnt(9)
    v_smfmac_f32_16x16x64_bf16 v[72:75], v[64:67], a[48:55], v16
    ds_read_b128 v[116:119], v20 offset:21504
    v_smfmac_f32_16x16x64_bf16 v[84:87], v[64:67], v[152:159], v16
    ds_read_b128 v[60:63], v24 offset:1024
    v_smfmac_f32_16x16x64_bf16 v[76:79], v[64:67], a[128:135], v16
    v_smfmac_f32_16x16x64_bf16 v[88:91], v[64:67], v[224:231], v16
    v_smfmac_f32_16x16x64_bf16 v[80:83], v[64:67], a[200:207], v16
    s_waitcnt lgkmcnt(9)
    v_smfmac_f32_16x16x64_bf16 v[92:95], v[64:67], v[120:127], v16
    ds_read_b128 v[120:123], v20 offset:22528
    s_waitcnt lgkmcnt(9)
    v_smfmac_f32_16x16x64_bf16 v[72:75], v[68:71], a[56:63], v16
    ds_read_b128 v[124:127], v20 offset:23552
    v_smfmac_f32_16x16x64_bf16 v[76:79], v[68:71], a[136:143], v16
    ds_read2st64_b64 v[32:35], v31 offset0:0 offset1:1
    v_smfmac_f32_16x16x64_bf16 v[80:83], v[68:71], a[208:215], v16
    ds_read2st64_b64 v[36:39], v31 offset0:2 offset1:3
    s_waitcnt lgkmcnt(9)
    v_smfmac_f32_16x16x64_bf16 v[72:75], v[56:59], a[64:71], v16
    ds_read2st64_b64 v[40:43], v31 offset0:4 offset1:5
    v_smfmac_f32_16x16x64_bf16 v[76:79], v[56:59], v[96:103], v16
    ds_read2st64_b64 v[44:47], v31 offset0:6 offset1:7
    v_smfmac_f32_16x16x64_bf16 v[80:83], v[56:59], a[216:223], v16
    ds_read2st64_b64 v[48:51], v31 offset0:8 offset1:9
    s_waitcnt lgkmcnt(7)
    v_smfmac_f32_16x16x64_bf16 v[72:75], v[60:63], a[72:79], v16
    ds_read2st64_b64 v[52:55], v31 offset0:10 offset1:11
    v_smfmac_f32_16x16x64_bf16 v[76:79], v[60:63], a[144:151], v16
    v_smfmac_f32_16x16x64_bf16 v[80:83], v[60:63], a[224:231], v16
    v_smfmac_f32_16x16x64_bf16 v[84:87], v[68:71], v[160:167], v16
    v_add_f32 v72, v72, v74
    v_add_f32 v73, v73, v75
    v_smfmac_f32_16x16x64_bf16 v[88:91], v[68:71], v[232:239], v16
    v_cvt_pk_bf16_f32 v74, v72, v73
    ds_write_b32 v25, v74 offset:0
    v_smfmac_f32_16x16x64_bf16 v[92:95], v[68:71], v[104:111], v16
    v_add_f32 v76, v76, v78
    v_add_f32 v77, v77, v79
    v_smfmac_f32_16x16x64_bf16 v[84:87], v[56:59], v[168:175], v16
    v_cvt_pk_bf16_f32 v78, v76, v77
    ds_write_b32 v25, v78 offset:512
    v_smfmac_f32_16x16x64_bf16 v[88:91], v[56:59], v[240:247], v16
    v_add_f32 v80, v80, v82
    v_add_f32 v81, v81, v83
    v_smfmac_f32_16x16x64_bf16 v[92:95], v[56:59], v[112:119], v16
    v_cvt_pk_bf16_f32 v82, v80, v81
    ds_write_b32 v25, v82 offset:1024
    v_smfmac_f32_16x16x64_bf16 v[84:87], v[60:63], v[176:183], v16
    v_smfmac_f32_16x16x64_bf16 v[88:91], v[60:63], v[248:255], v16
    s_waitcnt lgkmcnt(9)
    v_smfmac_f32_16x16x64_bf16 v[92:95], v[60:63], v[120:127], v16
    s_waitcnt lgkmcnt(0)
    s_barrier
    v_add_f32 v84, v84, v86
    v_add_f32 v85, v85, v87
    v_cvt_pk_bf16_f32 v86, v84, v85
    v_cvt_pk_bf16_f32 v87, v84, v85
    ds_write_b64 v14, v[86:87] offset:0
    v_add_f32 v88, v88, v90
    v_add_f32 v89, v89, v91
    v_cvt_pk_bf16_f32 v90, v88, v89
    v_cvt_pk_bf16_f32 v91, v88, v89
    ds_write_b64 v14, v[90:91] offset:512
    v_add_f32 v92, v92, v94
    v_add_f32 v93, v93, v95
    v_cvt_pk_bf16_f32 v94, v92, v93
    v_cvt_pk_bf16_f32 v95, v92, v93
    ds_write_b64 v14, v[94:95] offset:1024
    s_cmp_eq_u32 s24, 2
    s_cbranch_scc1 L_r1_w2
    ds_read_b64_tr_b16 v[96:97], v27 offset:0
    ds_read_b64_tr_b16 v[98:99], v27 offset:512
    ds_read_b64_tr_b16 v[100:101], v27 offset:1024
    ds_read_b64_tr_b16 v[102:103], v27 offset:1536
    ds_read_b64_tr_b16 v[104:105], v27 offset:2048
    ds_read_b64_tr_b16 v[106:107], v27 offset:2560
    ds_read_b64_tr_b16 v[108:109], v27 offset:3072
    ds_read_b64_tr_b16 v[110:111], v27 offset:3584
    ds_read_b64_tr_b16 v[112:113], v27 offset:4096
    ds_read_b64_tr_b16 v[114:115], v27 offset:4608
    ds_read_b64_tr_b16 v[116:117], v27 offset:5120
    ds_read_b64_tr_b16 v[118:119], v27 offset:5632
    s_cmp_eq_u32 s24, 3
    s_cbranch_scc1 L_r1_w3
    s_waitcnt lgkmcnt(12)
    s_barrier
    s_waitcnt lgkmcnt(0)
    v_mfma_f32_16x16x32_bf16 v[56:59], v[32:35], v[96:99], 0
    v_mfma_f32_16x16x32_bf16 v[56:59], v[36:39], v[100:103], v[56:59]
    v_mfma_f32_16x16x32_bf16 v[56:59], v[40:43], v[104:107], v[56:59]
    v_mfma_f32_16x16x32_bf16 v[56:59], v[44:47], v[108:111], v[56:59]
    v_mfma_f32_16x16x32_bf16 v[56:59], v[48:51], v[112:115], v[56:59]
    v_mfma_f32_16x16x32_bf16 v[56:59], v[52:55], v[116:119], v[56:59]
    s_nop 7
    ds_write_b128 v28, v[56:59]
    s_waitcnt lgkmcnt(0)
    s_barrier
    s_barrier
    s_branch L_r1_next
L_r1_f0:
    buffer_load_dwordx4 v[32:35], v4, s[4:7], s74 offen offset:0 sc1
    buffer_load_dwordx4 v[36:39], v4, s[4:7], s74 offen offset:1024 sc1
    buffer_load_dword v40, v17, s[4:7], s74 offen offset:2048 sc1
    buffer_load_dword v41, v17, s[4:7], s74 offen offset:2304 sc1
    s_sub_u32 s27, s27, 1
    s_cbranch_scc1 L_exit
    v_mov_b32 v72, 0
    v_mov_b32 v73, 0
    v_mov_b32 v74, 0
    v_mov_b32 v75, 0
    v_mov_b32 v84, 0
    v_mov_b32 v85, 0
    v_mov_b32 v86, 0
    v_mov_b32 v87, 0
    v_mov_b32 v76, 0
    v_mov_b32 v77, 0
    v_mov_b32 v78, 0
    v_mov_b32 v79, 0
    v_mov_b32 v88, 0
    v_mov_b32 v89, 0
    v_mov_b32 v90, 0
    v_mov_b32 v91, 0
    v_mov_b32 v80, 0
    v_mov_b32 v81, 0
    v_mov_b32 v82, 0
    v_mov_b32 v83, 0
    s_branch L_r1_h0
L_r1_w2:
    s_waitcnt lgkmcnt(0)
    buffer_store_dword v30, v15, s[4:7], s83 offen sc1
    s_barrier
    s_mov_b64 exec, 1
    buffer_store_dword v30, v5, s[4:7], s79 offen sc1
    s_mov_b64 exec, -1
    s_cmp_eq_u32 s26, 63
    s_cbranch_scc1 L_r1_w2l
    s_barrier
    s_barrier
L_r1_w2l:
    ds_read_b64_tr_b16 v[32:33], v0 offset:0
    ds_read_b64_tr_b16 v[34:35], v0 offset:512
    ds_read_b64_tr_b16 v[36:37], v0 offset:1024
    ds_read_b64_tr_b16 v[38:39], v0 offset:1536
    ds_read_b64_tr_b16 v[40:41], v0 offset:2048
    ds_read_b64_tr_b16 v[42:43], v0 offset:2560
    ds_read_b64_tr_b16 v[44:45], v0 offset:3072
    ds_read_b64_tr_b16 v[46:47], v0 offset:3584
    ds_read_b64_tr_b16 v[48:49], v0 offset:4096
    ds_read_b64_tr_b16 v[50:51], v0 offset:4608
    ds_read_b64_tr_b16 v[52:53], v0 offset:5120
    ds_read_b64_tr_b16 v[54:55], v0 offset:5632
    s_waitcnt lgkmcnt(0)
    s_not_b64 exec, s[34:35]
    buffer_store_dwordx4 v[32:35], v29, s[4:7], s76 offen offset:0 sc1
    buffer_store_dwordx4 v[36:39], v29, s[4:7], s76 offen offset:512 sc1
    buffer_store_dwordx4 v[40:43], v29, s[4:7], s76 offen offset:1024 sc1
    buffer_store_dwordx4 v[44:47], v29, s[4:7], s76 offen offset:1536 sc1
    buffer_store_dwordx4 v[48:51], v29, s[4:7], s76 offen offset:2048 sc1
    buffer_store_dwordx4 v[52:55], v29, s[4:7], s76 offen offset:2560 sc1
    s_mov_b64 exec, -1
    s_cmp_lg_u32 s26, 61
    s_cbranch_scc1 L_r1_next
    s_mov_b32 s28, 62
    s_waitcnt vmcnt(0)
    v_mov_b32 v6, s28
    s_mov_b64 exec, 1
    buffer_store_dword v6, v5, s[4:7], s79 offen sc1
    s_mov_b64 exec, -1
    s_branch L_r1_next
L_r1_w3:
    s_cmp_eq_u32 s26, 63
    s_waitcnt lgkmcnt(12)
    s_barrier
    s_waitcnt lgkmcnt(3)
    ds_read_b64_tr_b16 v[32:33], v0 offset:0
    ds_read_b64_tr_b16 v[34:35], v0 offset:512
    ds_read_b64_tr_b16 v[36:37], v0 offset:1024
    ds_read_b64_tr_b16 v[38:39], v0 offset:1536
    ds_read_b64_tr_b16 v[40:41], v0 offset:2048
    ds_read_b64_tr_b16 v[42:43], v0 offset:2560
    ds_read_b64_tr_b16 v[44:45], v0 offset:3072
    ds_read_b64_tr_b16 v[46:47], v0 offset:3584
    ds_read_b64_tr_b16 v[48:49], v0 offset:4096
    ds_read_b64_tr_b16 v[50:51], v0 offset:4608
    ds_read_b64_tr_b16 v[52:53], v0 offset:5120
    ds_read_b64_tr_b16 v[54:55], v0 offset:5632
    s_cbranch_scc1 L_r1_last
    s_waitcnt lgkmcnt(10)
    v_mfma_f32_16x16x32_bf16 v[68:71], v[96:99], v[32:35], 0
    s_waitcnt lgkmcnt(8)
    v_mfma_f32_16x16x32_bf16 v[68:71], v[100:103], v[36:39], v[68:71]
    s_waitcnt lgkmcnt(6)
    v_mfma_f32_16x16x32_bf16 v[68:71], v[104:107], v[40:43], v[68:71]
    s_waitcnt lgkmcnt(4)
    v_mfma_f32_16x16x32_bf16 v[68:71], v[108:111], v[44:47], v[68:71]
    s_waitcnt lgkmcnt(2)
    v_mfma_f32_16x16x32_bf16 v[68:71], v[112:115], v[48:51], v[68:71]
    s_waitcnt lgkmcnt(0)
    v_mfma_f32_16x16x32_bf16 v[68:71], v[116:119], v[52:55], v[68:71]
    s_barrier
    ds_read_b128 v[56:59], v28
    s_nop 5
    v_cndmask_b32 v6, v68, v69, s[34:35]
    v_cndmask_b32 v7, v70, v71, s[34:35]
    v_cndmask_b32 v60, v6, v7, s[36:37]
    s_waitcnt lgkmcnt(0)
    v_max3_f32 v6, v56, v57, v58
    v_max3_f32 v6, v6, v59, v60
    s_nop 1
    v_max_f32_dpp v6, v6, v6 quad_perm:[1,0,3,2] row_mask:0xf bank_mask:0xf
    s_nop 1
    v_max_f32_dpp v6, v6, v6 row_ror:4 row_mask:0xf bank_mask:0xf
    s_nop 1
    v_max_f32_dpp v6, v6, v6 row_ror:8 row_mask:0xf bank_mask:0xf
    v_mul_f32 v6, s80, v6
    v_fma_f32 v60, v60, s80, -v6
    v_fma_f32 v56, v56, s80, -v6
    v_fma_f32 v57, v57, s80, -v6
    v_fma_f32 v58, v58, s80, -v6
    v_fma_f32 v59, v59, s80, -v6
    v_exp_f32 v60, v60
    v_exp_f32 v56, v56
    v_exp_f32 v57, v57
    v_exp_f32 v58, v58
    v_exp_f32 v59, v59
    v_add_f32 v6, v60, v56
    v_mov_b32_dpp v61, v60 quad_perm:[1,0,3,2] row_mask:0xf bank_mask:0xf
    v_add_f32 v7, v57, v58
    v_add_f32 v6, v6, v59
    v_add_f32 v6, v6, v7
    s_nop 1
    v_add_f32_dpp v6, v6, v6 quad_perm:[1,0,3,2] row_mask:0xf bank_mask:0xf
    s_nop 1
    v_add_f32_dpp v6, v6, v6 row_ror:4 row_mask:0xf bank_mask:0xf
    s_nop 1
    v_add_f32_dpp v6, v6, v6 row_ror:8 row_mask:0xf bank_mask:0xf
    v_rcp_f32 v6, v6
    s_nop 0
    v_mul_f32 v56, v56, v6
    v_mul_f32 v57, v57, v6
    v_mul_f32 v58, v58, v6
    v_mul_f32 v59, v59, v6
    v_cvt_pk_bf16_f32 v62, v56, v57
    v_cvt_pk_bf16_f32 v63, v58, v59
    buffer_store_dwordx2 v[62:63], v29, s[4:7], s75 offen sc1
    v_mul_f32 v60, v60, v6
    v_mul_f32 v61, v61, v6
    s_mov_b64 exec, s[32:33]
    v_cvt_pk_bf16_f32 v64, v60, v61
    buffer_store_dword v64, v3, s[4:7], s75 offen offset:512 sc1
    s_mov_b64 exec, -1
    s_barrier
L_r1_next:
    s_cmp_eq_u32 s26, 31
    s_cselect_b32 s28, s101, 65536
    s_add_u32 s74, s74, s28
    s_add_u32 s75, s75, s28
    v_xor_b32 v31, 16384, v31
    s_add_u32 s76, s76, 3072
    s_add_u32 s26, s26, 1
    s_cmp_lt_u32 s26, 64
    s_cbranch_scc1 L_r1_top
L_r1_last:
    s_endpgm
L_r2:
    s_cmp_lg_u32 s24, 0
    s_cbranch_scc1 Lgod_61
    v_mov_b32 v5, 132
    s_mov_b32 exec_lo, 0
    v_mov_b32 v5, 128
    s_mov_b64 exec, -1
Lgo_60:
    buffer_load_dword v6, v5, s[20:23], 0 offen sc1
    s_waitcnt vmcnt(0)
    v_cmp_eq_u32 vcc, 0, v6
    s_cbranch_vccz Lgod_61
    s_sleep 2
    s_sub_u32 s27, s27, 1
    s_cbranch_scc1 L_exit
    s_branch Lgo_60
Lgod_61:
    s_barrier
    v_mov_b32 v5, 0
    buffer_load_dword v6, v5, s[20:23], 0 offen offset:136 sc1
    s_waitcnt vmcnt(0)
    v_readfirstlane_b32 s28, v6
    s_nop 0
    s_and_b32 s100, s28, 1
    s_lshl_b32 s100, s100, 13
    s_and_b32 s101, s28, 0x100
    s_lshl_b32 s101, s101, 5
    s_and_b32 s73, s28, 0x10000
    s_lshr_b32 s73, s73, 3
    s_sub_u32 s101, s101, s100
    s_add_u32 s101, s101, 65536
    s_lshl_b32 s29, s25, 4
    s_lshl_b32 s28, s24, 2
    s_add_u32 s29, s29, s28
    s_mul_i32 s29, s29, 20480
    s_add_u32 s82, s29, 0x1000000
    buffer_load_dwordx4 a[0:3], v4, s[4:7], s82 offen offset:0 sc1
    buffer_load_dwordx4 a[4:7], v4, s[4:7], s82 offen offset:1024 sc1
    buffer_load_dwordx4 a[8:11], v4, s[4:7], s82 offen offset:2048 sc1
    buffer_load_dwordx4 a[12:15], v4, s[4:7], s82 offen offset:3072 sc1
    s_add_u32 s82, s82, 4096
    buffer_load_dwordx4 a[16:19], v4, s[4:7], s82 offen offset:0 sc1
    buffer_load_dwordx4 a[20:23], v4, s[4:7], s82 offen offset:1024 sc1
    buffer_load_dwordx4 a[24:27], v4, s[4:7], s82 offen offset:2048 sc1
    buffer_load_dwordx4 a[28:31], v4, s[4:7], s82 offen offset:3072 sc1
    s_add_u32 s82, s82, 4096
    buffer_load_dwordx4 a[32:35], v4, s[4:7], s82 offen offset:0 sc1
    buffer_load_dwordx4 a[36:39], v4, s[4:7], s82 offen offset:1024 sc1
    buffer_load_dwordx4 a[40:43], v4, s[4:7], s82 offen offset:2048 sc1
    buffer_load_dwordx4 a[44:47], v4, s[4:7], s82 offen offset:3072 sc1
    s_add_u32 s82, s82, 4096
    buffer_load_dwordx4 a[48:51], v4, s[4:7], s82 offen offset:0 sc1
    buffer_load_dwordx4 a[52:55], v4, s[4:7], s82 offen offset:1024 sc1
    buffer_load_dwordx4 a[56:59], v4, s[4:7], s82 offen offset:2048 sc1
    buffer_load_dwordx4 a[60:63], v4, s[4:7], s82 offen offset:3072 sc1
    s_add_u32 s82, s82, 4096
    buffer_load_dwordx4 a[64:67], v4, s[4:7], s82 offen offset:0 sc1
    buffer_load_dwordx4 a[68:71], v4, s[4:7], s82 offen offset:1024 sc1
    buffer_load_dwordx4 a[72:75], v4, s[4:7], s82 offen offset:2048 sc1
    buffer_load_dwordx4 a[76:79], v4, s[4:7], s82 offen offset:3072 sc1
    s_add_u32 s82, s82, 4096
    buffer_load_dwordx4 a[80:83], v4, s[4:7], s82 offen offset:0 sc1
    buffer_load_dwordx4 a[84:87], v4, s[4:7], s82 offen offset:1024 sc1
    buffer_load_dwordx4 a[88:91], v4, s[4:7], s82 offen offset:2048 sc1
    buffer_load_dwordx4 a[92:95], v4, s[4:7], s82 offen offset:3072 sc1
    s_add_u32 s82, s82, 4096
    buffer_load_dwordx4 a[96:99], v4, s[4:7], s82 offen offset:0 sc1
    buffer_load_dwordx4 a[100:103], v4, s[4:7], s82 offen offset:1024 sc1
    buffer_load_dwordx4 a[104:107], v4, s[4:7], s82 offen offset:2048 sc1
    buffer_load_dwordx4 a[108:111], v4, s[4:7], s82 offen offset:3072 sc1
    s_add_u32 s82, s82, 4096
    buffer_load_dwordx4 a[112:115], v4, s[4:7], s82 offen offset:0 sc1
    buffer_load_dwordx4 a[116:119], v4, s[4:7], s82 offen offset:1024 sc1
    buffer_load_dwordx4 a[120:123], v4, s[4:7], s82 offen offset:2048 sc1
    buffer_load_dwordx4 a[124:127], v4, s[4:7], s82 offen offset:3072 sc1
    s_add_u32 s82, s82, 4096
    buffer_load_dwordx4 a[128:131], v4, s[4:7], s82 offen offset:0 sc1
    buffer_load_dwordx4 a[132:135], v4, s[4:7], s82 offen offset:1024 sc1
    buffer_load_dwordx4 a[136:139], v4, s[4:7], s82 offen offset:2048 sc1
    buffer_load_dwordx4 a[140:143], v4, s[4:7], s82 offen offset:3072 sc1
    s_add_u32 s82, s82, 4096
    buffer_load_dwordx4 a[144:147], v4, s[4:7], s82 offen offset:0 sc1
    buffer_load_dwordx4 a[148:151], v4, s[4:7], s82 offen offset:1024 sc1
    buffer_load_dwordx4 a[152:155], v4, s[4:7], s82 offen offset:2048 sc1
    buffer_load_dwordx4 a[156:159], v4, s[4:7], s82 offen offset:3072 sc1
    s_add_u32 s82, s82, 4096
    buffer_load_dwordx4 a[160:163], v4, s[4:7], s82 offen offset:0 sc1
    buffer_load_dwordx4 a[164:167], v4, s[4:7], s82 offen offset:1024 sc1
    buffer_load_dwordx4 a[168:171], v4, s[4:7], s82 offen offset:2048 sc1
    buffer_load_dwordx4 a[172:175], v4, s[4:7], s82 offen offset:3072 sc1
    s_add_u32 s82, s82, 4096
    buffer_load_dwordx4 a[176:179], v4, s[4:7], s82 offen offset:0 sc1
    buffer_load_dwordx4 a[180:183], v4, s[4:7], s82 offen offset:1024 sc1
    buffer_load_dwordx4 a[184:187], v4, s[4:7], s82 offen offset:2048 sc1
    buffer_load_dwordx4 a[188:191], v4, s[4:7], s82 offen offset:3072 sc1
    s_add_u32 s82, s82, 4096
    buffer_load_dwordx4 a[192:195], v4, s[4:7], s82 offen offset:0 sc1
    buffer_load_dwordx4 a[196:199], v4, s[4:7], s82 offen offset:1024 sc1
    buffer_load_dwordx4 a[200:203], v4, s[4:7], s82 offen offset:2048 sc1
    buffer_load_dwordx4 a[204:207], v4, s[4:7], s82 offen offset:3072 sc1
    s_add_u32 s82, s82, 4096
    buffer_load_dwordx4 a[208:211], v4, s[4:7], s82 offen offset:0 sc1
    buffer_load_dwordx4 a[212:215], v4, s[4:7], s82 offen offset:1024 sc1
    buffer_load_dwordx4 a[216:219], v4, s[4:7], s82 offen offset:2048 sc1
    buffer_load_dwordx4 a[220:223], v4, s[4:7], s82 offen offset:3072 sc1
    s_add_u32 s82, s82, 4096
    buffer_load_dwordx4 a[224:227], v4, s[4:7], s82 offen offset:0 sc1
    buffer_load_dwordx4 a[228:231], v4, s[4:7], s82 offen offset:1024 sc1
    buffer_load_dwordx4 a[232:235], v4, s[4:7], s82 offen offset:2048 sc1
    buffer_load_dwordx4 a[236:239], v4, s[4:7], s82 offen offset:3072 sc1
    s_add_u32 s82, s82, 4096
    buffer_load_dwordx4 a[240:243], v4, s[4:7], s82 offen offset:0 sc1
    buffer_load_dwordx4 a[244:247], v4, s[4:7], s82 offen offset:1024 sc1
    s_waitcnt vmcnt(51)
    buffer_load_dwordx4 a[248:251], v4, s[4:7], s82 offen offset:2048 sc1
    buffer_load_dwordx4 a[252:255], v4, s[4:7], s82 offen offset:3072 sc1
    s_add_u32 s82, s82, 4096
    buffer_load_dwordx4 v[192:195], v4, s[4:7], s82 offen offset:0 sc1
    buffer_load_dwordx4 v[196:199], v4, s[4:7], s82 offen offset:1024 sc1
    buffer_load_dwordx4 v[200:203], v4, s[4:7], s82 offen offset:2048 sc1
    buffer_load_dwordx4 v[204:207], v4, s[4:7], s82 offen offset:3072 sc1
    s_add_u32 s82, s82, 4096
    buffer_load_dwordx4 v[208:211], v4, s[4:7], s82 offen offset:0 sc1
    buffer_load_dwordx4 v[212:215], v4, s[4:7], s82 offen offset:1024 sc1
    buffer_load_dwordx4 v[216:219], v4, s[4:7], s82 offen offset:2048 sc1
    buffer_load_dwordx4 v[220:223], v4, s[4:7], s82 offen offset:3072 sc1
    s_add_u32 s82, s82, 4096
    buffer_load_dwordx4 v[224:227], v4, s[4:7], s82 offen offset:0 sc1
    s_waitcnt vmcnt(51)
    buffer_load_dwordx4 v[228:231], v4, s[4:7], s82 offen offset:1024 sc1
    buffer_load_dwordx4 v[232:235], v4, s[4:7], s82 offen offset:2048 sc1
    buffer_load_dwordx4 v[236:239], v4, s[4:7], s82 offen offset:3072 sc1
    s_add_u32 s82, s82, 4096
    buffer_load_dwordx4 v[240:243], v4, s[4:7], s82 offen offset:0 sc1
    buffer_load_dwordx4 v[244:247], v4, s[4:7], s82 offen offset:1024 sc1
    buffer_load_dwordx4 v[248:251], v4, s[4:7], s82 offen offset:2048 sc1
    buffer_load_dwordx4 v[252:255], v4, s[4:7], s82 offen offset:3072 sc1
    s_add_u32 s82, s82, 4096
    v_lshlrev_b32 v17, 2, v1
    s_lshl_b32 s28, s24, 11
    s_add_u32 s28, s28, 90112
    v_add_u32 v18, s28, v4
    s_lshl_b32 s28, s24, 9
    s_add_u32 s28, s28, 98304
    v_add_u32 v19, s28, v17
    s_mul_i32 s74, s24, 16384
    s_add_u32 s74, s74, 0xc001400
    v_mov_b32 v16, 0x4444
    v_mov_b32 v6, 0xeeee
    v_and_b32 v7, 2, v2
    v_cmp_lt_u32 vcc, 0, v7
    s_nop 1
    v_cndmask_b32 v16, v16, v6, vcc
    v_mov_b32 v5, 0
    v_add_u32 v20, 90112, v4
    v_lshrrev_b32 v31, 3, v2
    v_and_b32 v7, 7, v2
    v_mul_u32_u24 v6, 640, v31
    v_lshl_add_u32 v24, v7, 4, v6
    v_lshl_add_u32 v24, v3, 7, v24
    v_lshl_add_u32 v25, v7, 4, v6
    v_mul_u32_u24 v6, 1280, v3
    v_add_u32 v25, v25, v6
    v_and_b32 v6, 1, v3
    v_lshlrev_b32 v26, 5, v7
    v_lshl_add_u32 v26, v6, 4, v26
    v_lshl_add_u32 v26, v31, 8, v26
    s_lshl_b32 s28, s24, 9
    s_add_u32 s28, s28, 40960
    v_add_u32 v26, s28, v26
    v_lshrrev_b32 v6, 1, v3
    v_xor_b32 v6, v6, v31
    v_lshl_add_u32 v26, v6, 11, v26
    v_and_b32 v6, 1, v1
    v_lshlrev_b32 v27, 7, v6
    v_lshlrev_b32 v28, 2, v6
    v_and_b32 v6, 4, v1
    v_lshl_add_u32 v27, v6, 4, v27
    v_and_b32 v6, 56, v1
    v_add_u32 v27, v27, v6
    v_and_b32 v6, 2, v1
    v_lshl_add_u32 v27, v6, 1, v27
    v_add_u32 v27, 40960, v27
    v_and_b32 v6, 30, v1
    v_lshl_add_u32 v28, v6, 3, v28
    s_mul_i32 s75, s24, 16384
    s_add_u32 s75, s75, 0xc000000
    s_lshr_b32 s28, s25, 4
    s_and_b32 s29, s25, 15
    s_lshl_b32 s29, s29, 7
    s_bfe_u32 s30, s25, 0x20002
    s_and_b32 s31, s25, 3
    s_lshl_b32 s31, s31, 7
    s_add_u32 s31, s31, 2048
    s_cmp_ge_u32 s25, 64
    s_cselect_b32 s28, s30, s28
    s_cselect_b32 s29, s31, s29
    s_mul_i32 s76, s28, 16384
    s_add_u32 s76, s76, s29
    s_add_u32 s76, s76, 0xc011400
    s_and_b32 s28, s25, 1
    s_mul_i32 s28, s28, 120
    s_sub_u32 s76, s76, s28
    v_lshlrev_b32 v6, 4, v7
    v_lshl_add_u32 v21, v31, 10, v6
    v_lshl_add_u32 v21, v3, 8, v21
    v_lshl_add_u32 v22, v31, 8, v6
    v_lshl_add_u32 v22, v3, 9, v22
    s_lshr_b32 s29, s25, 1
    s_and_b32 s30, s25, 1
    s_lshl_b32 s30, s30, 7
    s_mul_i32 s79, s29, 2117632
    s_lshl_b32 s28, s24, 13
    s_add_u32 s79, s79, s30
    s_add_u32 s79, s79, s28
    s_add_u32 s79, s79, 0x5200000
    s_mul_i32 s80, s29, 528384
    s_lshl_b32 s28, s24, 11
    s_add_u32 s80, s80, s30
    s_add_u32 s80, s80, s28
    s_add_u32 s80, s80, 0xa400000
    s_lshl_b32 s81, s25, 7
    s_add_u32 s81, s81, 0xba13000
    s_cmp_eq_u32 s24, 1
    s_cselect_b32 s81, s81, 0x10000000
    s_mov_b32 s83, s79
    s_mov_b32 s84, s80
    v_and_b32 v31, 7, v1
    v_lshlrev_b32 v31, 7, v31
    s_lshl_b32 s88, s24, 10
    s_add_u32 s88, s88, 0xc400000
    s_add_u32 s74, s74, s100
    s_add_u32 s75, s75, s100
    s_add_u32 s76, s76, s100
    s_add_u32 s88, s88, s73
    s_lshr_b32 s29, s25, 1
    s_mul_i32 s28, s29, 171
    s_lshr_b32 s28, s28, 9
    s_mul_i32 s28, s28, 3
    s_sub_u32 s28, s29, s28
    s_lshl_b32 s28, s28, 14
    s_add_u32 s88, s88, s28
    s_lshl_b32 s89, s25, 7
    s_cmp_ge_u32 s25, 40
    s_cselect_b32 s28, 11264, 0
    s_add_u32 s89, s89, s28
    s_add_u32 s89, s89, s73
    s_add_u32 s89, s89, 0xc40c000
    s_cmp_eq_u32 s24, 3
    s_cselect_b32 s89, s89, 0x10000000
    s_lshl_b32 s85, s24, 10
    s_add_u32 s85, s85, 0xba16000
    v_mov_b32 v23, v31
    s_waitcnt vmcnt(0)
    s_barrier
    s_mov_b32 s26, 0
    v_cmp_eq_u32 vcc, 0, v1
    v_mov_b32 v29, 0x10000000
    s_nop 0
    v_cndmask_b32 v29, v29, v5, vcc
    v_mov_b32 v30, -1
    s_mov_b64 exec, 0xff
    v_mov_b32 v30, 0
    s_mov_b64 exec, -1
    v_mov_b32 v128, 0
    v_mov_b32 v129, 0
    v_mov_b32 v130, 0
    v_mov_b32 v131, 0
    v_mov_b32 v132, 0
    v_mov_b32 v133, 0
    v_mov_b32 v134, 0
    v_mov_b32 v135, 0
    v_mov_b32 v136, 0
    v_mov_b32 v137, 0
    v_mov_b32 v138, 0
    v_mov_b32 v139, 0
    v_mov_b32 v140, 0
    v_mov_b32 v141, 0
    v_mov_b32 v142, 0
    v_mov_b32 v143, 0
L_r2_top:
    s_max_u32 s29, s26, 1
    s_sub_u32 s29, s29, 1
    v_mov_b32 v112, s29
    buffer_store_dwordx4 v[124:127], v22, s[4:7], s84 offen sc1
    s_add_u32 s87, s74, 65536
    s_mov_b64 exec, 1
    buffer_store_dword v112, v5, s[4:7], s81 offen sc1
    buffer_load_dword v7, v5, s[4:7], s87 offen offset:2944 sc1
    s_mov_b64 exec, 0xff
    buffer_load_dword v30, v23, s[4:7], s85 offen sc1
    s_mov_b64 exec, -1
    s_waitcnt vmcnt(0)
    buffer_load_dwordx4 v[56:59], v4, s[4:7], s74 offen offset:0 sc1
    buffer_load_dwordx4 v[60:63], v4, s[4:7], s74 offen offset:1024 sc1
    buffer_load_dword v64, v17, s[4:7], s74 offen offset:2048 sc1
    buffer_load_dword v65, v17, s[4:7], s74 offen offset:2304 sc1
    v_cmp_ge_u32 vcc, s26, v30
    s_nop 0
    s_cmp_eq_u64 vcc, 0
    s_cselect_b32 s86, 1, 0
    s_cselect_b32 s29, s79, 0x10000000
    s_add_u32 s30, s29, 4096
    buffer_load_dwordx4 v[144:147], v21, s[4:7], s29 offen offset:0 sc1
    buffer_load_dwordx4 v[148:151], v21, s[4:7], s29 offen offset:2048 sc1
    buffer_load_dwordx4 v[152:155], v21, s[4:7], s30 offen offset:0 sc1
    buffer_load_dwordx4 v[156:159], v21, s[4:7], s30 offen offset:2048 sc1
    s_waitcnt vmcnt(4)
L_r2_mc:
    v_max3_u32 v6, v56, v57, v58
    v_max3_u32 v6, v6, v59, v60
    v_max3_u32 v6, v6, v61, v62
    v_max3_u32 v6, v6, v63, v64
    v_max_u32 v6, v6, v65
    v_cmp_eq_u32 vcc, -1, v6
    ds_write_b128 v18, v[56:59]
    ds_write_b128 v18, v[60:63] offset:1024
    ds_write2_b32 v19, v64, v65 offset0:0 offset1:64
    s_cbranch_vccnz L_r2_mp
    s_waitcnt lgkmcnt(0)
    s_barrier
    ds_read_b128 v[72:75], v20 offset:0
    ds_read_b128 v[76:79], v20 offset:1024
    ds_read_b128 v[80:83], v20 offset:2048
    ds_read_b128 v[84:87], v20 offset:3072
    ds_read_b128 v[88:91], v20 offset:4096
    ds_read_b128 v[92:95], v20 offset:5120
    ds_read_b128 v[96:99], v20 offset:6144
    ds_read_b128 v[100:103], v20 offset:7168
    ds_read_b128 v[104:107], v20 offset:8192
    ds_read_b128 v[108:111], v20 offset:9216
    v_mov_b32 v6, -2
    s_waitcnt lgkmcnt(9)
    v_smfmac_f32_16x16x64_bf16 v[128:131], v[72:75], a[0:7], v16
    v_smfmac_f32_16x16x64_bf16 v[132:135], v[72:75], a[80:87], v16
    v_smfmac_f32_16x16x64_bf16 v[136:139], v[72:75], a[160:167], v16
    v_smfmac_f32_16x16x64_bf16 v[140:143], v[72:75], a[240:247], v16
    s_waitcnt lgkmcnt(8)
    v_smfmac_f32_16x16x64_bf16 v[128:131], v[76:79], a[8:15], v16
    v_smfmac_f32_16x16x64_bf16 v[132:135], v[76:79], a[88:95], v16
    v_smfmac_f32_16x16x64_bf16 v[136:139], v[76:79], a[168:175], v16
    v_smfmac_f32_16x16x64_bf16 v[140:143], v[76:79], a[248:255], v16
    s_waitcnt lgkmcnt(7)
    v_smfmac_f32_16x16x64_bf16 v[128:131], v[80:83], a[16:23], v16
    v_smfmac_f32_16x16x64_bf16 v[132:135], v[80:83], a[96:103], v16
    v_smfmac_f32_16x16x64_bf16 v[136:139], v[80:83], a[176:183], v16
    v_smfmac_f32_16x16x64_bf16 v[140:143], v[80:83], v[192:199], v16
    s_waitcnt lgkmcnt(6)
    v_smfmac_f32_16x16x64_bf16 v[128:131], v[84:87], a[24:31], v16
    v_smfmac_f32_16x16x64_bf16 v[132:135], v[84:87], a[104:111], v16
    v_smfmac_f32_16x16x64_bf16 v[136:139], v[84:87], a[184:191], v16
    v_smfmac_f32_16x16x64_bf16 v[140:143], v[84:87], v[200:207], v16
    s_waitcnt lgkmcnt(5)
    v_smfmac_f32_16x16x64_bf16 v[128:131], v[88:91], a[32:39], v16
    v_smfmac_f32_16x16x64_bf16 v[132:135], v[88:91], a[112:119], v16
    v_smfmac_f32_16x16x64_bf16 v[136:139], v[88:91], a[192:199], v16
    v_smfmac_f32_16x16x64_bf16 v[140:143], v[88:91], v[208:215], v16
    s_waitcnt lgkmcnt(4)
    v_smfmac_f32_16x16x64_bf16 v[128:131], v[92:95], a[40:47], v16
    v_smfmac_f32_16x16x64_bf16 v[132:135], v[92:95], a[120:127], v16
    v_smfmac_f32_16x16x64_bf16 v[136:139], v[92:95], a[200:207], v16
    v_smfmac_f32_16x16x64_bf16 v[140:143], v[92:95], v[216:223], v16
    s_waitcnt lgkmcnt(3)
    v_smfmac_f32_16x16x64_bf16 v[128:131], v[96:99], a[48:55], v16
    v_smfmac_f32_16x16x64_bf16 v[132:135], v[96:99], a[128:135], v16
    v_smfmac_f32_16x16x64_bf16 v[136:139], v[96:99], a[208:215], v16
    v_smfmac_f32_16x16x64_bf16 v[140:143], v[96:99], v[224:231], v16
    s_waitcnt lgkmcnt(2)
    v_smfmac_f32_16x16x64_bf16 v[128:131], v[100:103], a[56:63], v16
    s_mov_b64 exec, 0xff
    buffer_load_dword v6, v31, s[4:7], s88 offen sc1
    s_mov_b64 exec, -1
    v_smfmac_f32_16x16x64_bf16 v[132:135], v[100:103], a[136:143], v16
    v_smfmac_f32_16x16x64_bf16 v[136:139], v[100:103], a[216:223], v16
    v_smfmac_f32_16x16x64_bf16 v[140:143], v[100:103], v[232:239], v16
    s_waitcnt lgkmcnt(1)
    v_smfmac_f32_16x16x64_bf16 v[128:131], v[104:107], a[64:71], v16
    v_smfmac_f32_16x16x64_bf16 v[132:135], v[104:107], a[144:151], v16
    v_smfmac_f32_16x16x64_bf16 v[136:139], v[104:107], a[224:231], v16
    v_smfmac_f32_16x16x64_bf16 v[140:143], v[104:107], v[240:247], v16
    s_waitcnt lgkmcnt(0)
    v_smfmac_f32_16x16x64_bf16 v[128:131], v[108:111], a[72:79], v16
    v_smfmac_f32_16x16x64_bf16 v[132:135], v[108:111], a[152:159], v16
    v_smfmac_f32_16x16x64_bf16 v[136:139], v[108:111], a[232:239], v16
    v_smfmac_f32_16x16x64_bf16 v[140:143], v[108:111], v[248:255], v16
    s_cmp_eq_u32 s26, 63
    s_cbranch_scc1 L_r2_end
    v_mov_b32 v112, s26
    s_cmp_eq_u32 s86, 0
    s_cbranch_scc1 L_r2_uw
L_r2_uk:
    s_mov_b64 exec, 0xff
L_r2_hu:
    buffer_load_dword v6, v31, s[4:7], s88 offen sc1
    s_sub_u32 s27, s27, 1
    s_cbranch_scc1 L_exit
    s_waitcnt vmcnt(2)
    v_cmp_gt_i32 vcc, s26, v6
    s_cbranch_vccnz L_r2_hu
    s_mov_b64 exec, -1
    buffer_load_dwordx4 v[36:39], v24, s[4:7], s75 offen offset:0 sc1
    buffer_load_dwordx4 v[40:43], v24, s[4:7], s75 offen offset:1280 sc1
    buffer_load_dwordx4 v[44:47], v24, s[4:7], s75 offen offset:2560 sc1
    buffer_load_dwordx4 v[48:51], v24, s[4:7], s75 offen offset:3840 sc1
    buffer_load_dwordx4 v[52:55], v25, s[4:7], s75 offen offset:512 sc1
    s_barrier
    v_pk_add_f32 v[128:129], v[128:129], v[130:131]
    v_cvt_pk_bf16_f32 v124, v128, v129
    v_pk_add_f32 v[132:133], v[132:133], v[134:135]
    v_cvt_pk_bf16_f32 v125, v132, v133
    v_pk_add_f32 v[136:137], v[136:137], v[138:139]
    v_cvt_pk_bf16_f32 v126, v136, v137
    v_pk_add_f32 v[140:141], v[140:141], v[142:143]
    v_cvt_pk_bf16_f32 v127, v140, v141
    v_permlane16_swap_b32 v124, v125
    s_nop 0
    v_permlane16_swap_b32 v126, v127
    s_nop 1
    v_permlane32_swap_b32 v124, v126
    v_permlane32_swap_b32 v125, v127
    s_mov_b32 s84, s80
    s_add_u32 s79, s79, 32768
    s_add_u32 s80, s80, 8192
    s_cmp_eq_u32 s26, 31
    s_cselect_b32 s28, s101, 65536
    s_add_u32 s74, s74, s28
    v_mov_b32 v128, 0
    v_mov_b32 v129, 0
    v_mov_b32 v130, 0
    v_mov_b32 v131, 0
    v_mov_b32 v132, 0
    v_mov_b32 v133, 0
    v_mov_b32 v134, 0
    v_mov_b32 v135, 0
    v_mov_b32 v136, 0
    v_mov_b32 v137, 0
    v_mov_b32 v138, 0
    v_mov_b32 v139, 0
    v_mov_b32 v140, 0
    v_mov_b32 v141, 0
    v_mov_b32 v142, 0
    v_mov_b32 v143, 0
    buffer_store_dword v112, v29, s[4:7], s89 offen sc1
    s_waitcnt vmcnt(5)
    v_mfma_f32_16x16x32_bf16 v[32:35], v[36:39], v[144:147], 0
    v_max_u32 v6, v36, v37
    s_waitcnt vmcnt(4)
    v_mfma_f32_16x16x32_bf16 v[32:35], v[40:43], v[148:151], v[32:35]
    s_waitcnt vmcnt(3)
    v_mfma_f32_16x16x32_bf16 v[32:35], v[44:47], v[152:155], v[32:35]
    s_waitcnt vmcnt(2)
    v_mfma_f32_16x16x32_bf16 v[32:35], v[48:51], v[156:159], v[32:35]
    s_waitcnt vmcnt(1)
    v_mfma_f32_16x16x32_bf16 v[32:35], v[52:55], v[124:127], v[32:35]
    v_max3_u32 v6, v6, v38, v39
    v_max3_u32 v6, v6, v40, v41
    v_max3_u32 v6, v6, v42, v43
    v_max3_u32 v6, v6, v44, v45
    v_max3_u32 v6, v6, v46, v47
    v_max3_u32 v6, v6, v48, v49
    v_max3_u32 v6, v6, v50, v51
    v_max3_u32 v6, v6, v52, v53
    v_max3_u32 v6, v6, v54, v55
    v_cmp_eq_u32 vcc, -1, v6
    ds_write_b128 v26, v[32:35]
    s_cbranch_vccnz L_r2_pp
L_r2_pd:
    s_cmp_lg_u32 s24, 0
    s_waitcnt lgkmcnt(0)
    s_barrier
    s_cbranch_scc1 L_r2_nom
    ds_read2st64_b32 v[116:117], v27 offset0:0 offset1:1
    ds_read2st64_b32 v[118:119], v27 offset0:2 offset1:3
    ds_read2st64_b32 v[120:121], v27 offset0:4 offset1:5
    ds_read2st64_b32 v[122:123], v27 offset0:6 offset1:7
    s_waitcnt lgkmcnt(2)
    v_pk_add_f32 v[116:117], v[116:117], v[118:119]
    s_waitcnt lgkmcnt(0)
    v_pk_add_f32 v[120:121], v[120:121], v[122:123]
    v_add_f32 v116, v116, v117
    v_add_f32 v120, v120, v121
    v_add_f32 v117, v116, v120
    v_add_f32 v116, v116, v120
    s_nop 1
    v_permlane32_swap_b32 v116, v117
    v_cvt_pk_bf16_f32 v116, v116, v117
    s_mov_b32 exec_hi, 0
    buffer_store_dword v116, v28, s[4:7], s76 offen sc1
    s_mov_b64 exec, -1
L_r2_nom:
    s_barrier
    s_cmp_eq_u32 s26, 31
    s_cselect_b32 s28, s101, 65536
    s_add_u32 s75, s75, s28
    s_cmp_eq_u32 s26, 30
    s_cselect_b32 s28, s101, 65536
    s_add_u32 s76, s76, s28
    s_add_u32 s26, s26, 1
    s_branch L_r2_top
L_r2_pp:
    buffer_load_dwordx4 v[36:39], v24, s[4:7], s75 offen offset:0 sc1
    buffer_load_dwordx4 v[40:43], v24, s[4:7], s75 offen offset:1280 sc1
    buffer_load_dwordx4 v[44:47], v24, s[4:7], s75 offen offset:2560 sc1
    buffer_load_dwordx4 v[48:51], v24, s[4:7], s75 offen offset:3840 sc1
    buffer_load_dwordx4 v[52:55], v25, s[4:7], s75 offen offset:512 sc1
    s_sub_u32 s27, s27, 1
    s_cbranch_scc1 L_exit
    s_waitcnt vmcnt(4)
    v_mfma_f32_16x16x32_bf16 v[32:35], v[36:39], v[144:147], 0
    v_max_u32 v6, v36, v37
    s_waitcnt vmcnt(3)
    v_mfma_f32_16x16x32_bf16 v[32:35], v[40:43], v[148:151], v[32:35]
    s_waitcnt vmcnt(2)
    v_mfma_f32_16x16x32_bf16 v[32:35], v[44:47], v[152:155], v[32:35]
    s_waitcnt vmcnt(1)
    v_mfma_f32_16x16x32_bf16 v[32:35], v[48:51], v[156:159], v[32:35]
    s_waitcnt vmcnt(0)
    v_mfma_f32_16x16x32_bf16 v[32:35], v[52:55], v[124:127], v[32:35]
    v_max3_u32 v6, v6, v38, v39
    v_max3_u32 v6, v6, v40, v41
    v_max3_u32 v6, v6, v42, v43
    v_max3_u32 v6, v6, v44, v45
    v_max3_u32 v6, v6, v46, v47
    v_max3_u32 v6, v6, v48, v49
    v_max3_u32 v6, v6, v50, v51
    v_max3_u32 v6, v6, v52, v53
    v_max3_u32 v6, v6, v54, v55
    v_cmp_eq_u32 vcc, -1, v6
    ds_write_b128 v26, v[32:35]
    s_cbranch_vccnz L_r2_pp
    s_branch L_r2_pd
L_r2_uw:
Lwv_62:
    buffer_load_dword v7, v23, s[4:7], s85 offen sc1
    s_waitcnt vmcnt(0)
    v_cmp_ge_u32 vcc, s26, v7
    s_cbranch_vccz Lwvd_63
    s_sleep 1
    s_sub_u32 s27, s27, 1
    s_cbranch_scc1 L_exit
    s_branch Lwv_62
Lwvd_63:
    s_add_u32 s30, s79, 4096
    buffer_load_dwordx4 v[144:147], v21, s[4:7], s79 offen offset:0 sc1
    buffer_load_dwordx4 v[148:151], v21, s[4:7], s79 offen offset:2048 sc1
    buffer_load_dwordx4 v[152:155], v21, s[4:7], s30 offen offset:0 sc1
    buffer_load_dwordx4 v[156:159], v21, s[4:7], s30 offen offset:2048 sc1
    s_branch L_r2_uk
L_r2_mp:
    buffer_load_dwordx4 v[56:59], v4, s[4:7], s74 offen offset:0 sc1
    buffer_load_dwordx4 v[60:63], v4, s[4:7], s74 offen offset:1024 sc1
    buffer_load_dword v64, v17, s[4:7], s74 offen offset:2048 sc1
    buffer_load_dword v65, v17, s[4:7], s74 offen offset:2304 sc1
    s_sub_u32 s27, s27, 1
    s_cbranch_scc1 L_exit
    s_waitcnt vmcnt(0)
    s_branch L_r2_mc
L_r2_end:
    s_nop 7
    v_pk_add_f32 v[128:129], v[128:129], v[130:131]
    v_cvt_pk_bf16_f32 v124, v128, v129
    v_pk_add_f32 v[132:133], v[132:133], v[134:135]
    v_cvt_pk_bf16_f32 v125, v132, v133
    v_pk_add_f32 v[136:137], v[136:137], v[138:139]
    v_cvt_pk_bf16_f32 v126, v136, v137
    v_pk_add_f32 v[140:141], v[140:141], v[142:143]
    v_cvt_pk_bf16_f32 v127, v140, v141
    v_permlane16_swap_b32 v124, v125
    s_nop 0
    v_permlane16_swap_b32 v126, v127
    s_nop 1
    v_permlane32_swap_b32 v124, v126
    v_permlane32_swap_b32 v125, v127
    buffer_store_dwordx4 v[124:127], v22, s[4:7], s80 offen sc1
    s_waitcnt vmcnt(0)
    s_barrier
    s_cmp_lg_u32 s24, 1
    s_cbranch_scc1 L_r2_fin
    s_mov_b32 s28, 64
    v_mov_b32 v6, s28
    s_mov_b64 exec, 1
    buffer_store_dword v6, v5, s[4:7], s81 offen sc1
    s_mov_b64 exec, -1
L_r2_fin:
    s_endpgm
L_up:
    s_mov_b32 s16, s42
    s_mov_b32 s17, s43
    s_mov_b32 s18, 0x780000
    s_mov_b32 s19, 0x20000
    s_and_b32 s28, s24, 1
    s_lshl_b32 s28, s28, 2
    v_and_b32 v5, 1, v3
    v_lshlrev_b32 v5, 1, v5
    v_add_u32 v5, s28, v5
    v_and_b32 v6, 7, v1
    v_xor_b32 v5, v5, v6
    v_lshrrev_b32 v6, 3, v1
    v_mul_u32_u24 v6, 1280, v6
    v_lshl_add_u32 v26, v5, 4, v6
    s_mul_i32 s91, s25, 245760
    s_mul_i32 s28, s24, 10240
    s_add_u32 s91, s91, s28
    s_mul_i32 s95, s24, 3072
    s_add_u32 s29, s91, 0
    s_add_u32 m0, s95, 0
    s_nop 0
    buffer_load_dwordx4 v26, s[16:19], s29 offen offset:0 lds
    s_add_u32 m0, s95, 896
    s_nop 0
    buffer_load_dwordx4 v26, s[16:19], s29 offen offset:128 lds
    s_add_u32 s29, s91, 256
    s_add_u32 m0, s95, 12288
    s_nop 0
    buffer_load_dwordx4 v26, s[16:19], s29 offen offset:0 lds
    s_add_u32 m0, s95, 13184
    s_nop 0
    buffer_load_dwordx4 v26, s[16:19], s29 offen offset:128 lds
    s_add_u32 s29, s91, 512
    s_add_u32 m0, s95, 24576
    s_nop 0
    buffer_load_dwordx4 v26, s[16:19], s29 offen offset:0 lds
    s_add_u32 m0, s95, 25472
    s_nop 0
    buffer_load_dwordx4 v26, s[16:19], s29 offen offset:128 lds
    s_add_u32 s29, s91, 768
    s_add_u32 m0, s95, 36864
    s_nop 0
    buffer_load_dwordx4 v26, s[16:19], s29 offen offset:0 lds
    s_add_u32 m0, s95, 37760
    s_nop 0
    buffer_load_dwordx4 v26, s[16:19], s29 offen offset:128 lds
    s_add_u32 s29, s91, 1024
    s_add_u32 m0, s95, 49152
    s_nop 0
    buffer_load_dwordx4 v26, s[16:19], s29 offen offset:0 lds
    s_add_u32 m0, s95, 50048
    s_nop 0
    buffer_load_dwordx4 v26, s[16:19], s29 offen offset:128 lds
    s_add_u32 s29, s91, 40960
    s_add_u32 m0, s95, 61440
    s_nop 0
    buffer_load_dwordx4 v26, s[16:19], s29 offen offset:0 lds
    s_add_u32 m0, s95, 62336
    s_nop 0
    buffer_load_dwordx4 v26, s[16:19], s29 offen offset:128 lds
    s_add_u32 s29, s91, 41216
    s_add_u32 m0, s95, 73728
    s_nop 0
    buffer_load_dwordx4 v26, s[16:19], s29 offen offset:0 lds
    s_add_u32 m0, s95, 74624
    s_nop 0
    buffer_load_dwordx4 v26, s[16:19], s29 offen offset:128 lds
    s_add_u32 s29, s91, 41472
    s_add_u32 m0, s95, 86016
    s_nop 0
    buffer_load_dwordx4 v26, s[16:19], s29 offen offset:0 lds
    s_add_u32 m0, s95, 86912
    s_nop 0
    buffer_load_dwordx4 v26, s[16:19], s29 offen offset:128 lds
    s_add_u32 s29, s91, 41728
    s_add_u32 m0, s95, 98304
    s_nop 0
    buffer_load_dwordx4 v26, s[16:19], s29 offen offset:0 lds
    s_add_u32 m0, s95, 99200
    s_nop 0
    buffer_load_dwordx4 v26, s[16:19], s29 offen offset:128 lds
    s_add_u32 s29, s91, 41984
    s_add_u32 m0, s95, 110592
    s_nop 0
    buffer_load_dwordx4 v26, s[16:19], s29 offen offset:0 lds
    s_add_u32 m0, s95, 111488
    s_nop 0
    buffer_load_dwordx4 v26, s[16:19], s29 offen offset:128 lds
    s_add_u32 s29, s91, 81920
    s_add_u32 m0, s95, 122880
    s_nop 0
    buffer_load_dwordx4 v26, s[16:19], s29 offen offset:0 lds
    s_add_u32 m0, s95, 123776
    s_nop 0
    buffer_load_dwordx4 v26, s[16:19], s29 offen offset:128 lds
    s_add_u32 s29, s91, 82176
    s_add_u32 m0, s95, 135168
    s_nop 0
    buffer_load_dwordx4 v26, s[16:19], s29 offen offset:0 lds
    s_add_u32 m0, s95, 136064
    s_nop 0
    buffer_load_dwordx4 v26, s[16:19], s29 offen offset:128 lds
    v_and_b32 v5, 1, v3
    v_lshlrev_b32 v5, 1, v5
    v_lshrrev_b32 v6, 3, v2
    v_add_u32 v5, v5, v6
    v_mul_u32_u24 v6, 3072, v3
    v_lshrrev_b32 v7, 2, v2
    v_lshl_add_u32 v6, v7, 7, v6
    v_and_b32 v7, 3, v2
    v_lshl_add_u32 v6, v7, 3, v6
    s_mul_i32 s28, s24, 2
    s_add_u32 s28, s28, 0
    s_and_b32 s29, s28, 3
    s_lshr_b32 s28, s28, 2
    s_lshl_b32 s28, s28, 10
    s_add_u32 s28, s28, 0
    v_xor_b32 v7, s29, v5
    v_lshl_add_u32 v7, v7, 5, v6
    v_add_u32 v17, s28, v7
    v_add_u32 v18, 49152, v17
    v_add_u32 v19, 49152, v18
    s_mul_i32 s28, s24, 2
    s_add_u32 s28, s28, 1
    s_and_b32 s29, s28, 3
    s_lshr_b32 s28, s28, 2
    s_lshl_b32 s28, s28, 10
    s_add_u32 s28, s28, 0
    v_xor_b32 v7, s29, v5
    v_lshl_add_u32 v7, v7, 5, v6
    v_add_u32 v20, s28, v7
    v_add_u32 v21, 49152, v20
    v_add_u32 v22, 49152, v21
    s_waitcnt vmcnt(12)
    s_barrier
    ds_read_b64_tr_b16 a[0:1], v17 offset:0
    ds_read_b64_tr_b16 a[2:3], v17 offset:512
    ds_read_b64_tr_b16 a[24:25], v20 offset:0
    ds_read_b64_tr_b16 a[26:27], v20 offset:512
    ds_read_b64_tr_b16 a[48:49], v17 offset:12288
    ds_read_b64_tr_b16 a[50:51], v17 offset:12800
    ds_read_b64_tr_b16 a[72:73], v20 offset:12288
    ds_read_b64_tr_b16 a[74:75], v20 offset:12800
    ds_read_b64_tr_b16 a[96:97], v17 offset:24576
    ds_read_b64_tr_b16 a[98:99], v17 offset:25088
    ds_read_b64_tr_b16 a[120:121], v20 offset:24576
    ds_read_b64_tr_b16 a[122:123], v20 offset:25088
    s_waitcnt lgkmcnt(2)
    ds_read_b64_tr_b16 a[144:145], v17 offset:36864
    ds_read_b64_tr_b16 a[146:147], v17 offset:37376
    ds_read_b64_tr_b16 a[168:169], v20 offset:36864
    ds_read_b64_tr_b16 a[170:171], v20 offset:37376
    ds_read_b64_tr_b16 a[192:193], v18 offset:0
    ds_read_b64_tr_b16 a[194:195], v18 offset:512
    ds_read_b64_tr_b16 a[216:217], v21 offset:0
    ds_read_b64_tr_b16 a[218:219], v21 offset:512
    ds_read_b64_tr_b16 a[4:5], v18 offset:12288
    ds_read_b64_tr_b16 a[6:7], v18 offset:12800
    s_waitcnt lgkmcnt(2)
    ds_read_b64_tr_b16 a[28:29], v21 offset:12288
    ds_read_b64_tr_b16 a[30:31], v21 offset:12800
Lwl_64:
    s_waitcnt lgkmcnt(0)
    s_barrier
    s_add_u32 s29, s91, 82432
    s_add_u32 m0, s95, 0
    s_nop 0
    buffer_load_dwordx4 v26, s[16:19], s29 offen offset:0 lds
    s_add_u32 m0, s95, 896
    s_nop 0
    buffer_load_dwordx4 v26, s[16:19], s29 offen offset:128 lds
    s_add_u32 s29, s91, 82688
    s_add_u32 m0, s95, 12288
    s_nop 0
    buffer_load_dwordx4 v26, s[16:19], s29 offen offset:0 lds
    s_add_u32 m0, s95, 13184
    s_nop 0
    buffer_load_dwordx4 v26, s[16:19], s29 offen offset:128 lds
    s_add_u32 s29, s91, 82944
    s_add_u32 m0, s95, 24576
    s_nop 0
    buffer_load_dwordx4 v26, s[16:19], s29 offen offset:0 lds
    s_add_u32 m0, s95, 25472
    s_nop 0
    buffer_load_dwordx4 v26, s[16:19], s29 offen offset:128 lds
    s_add_u32 s29, s91, 122880
    s_add_u32 m0, s95, 36864
    s_nop 0
    buffer_load_dwordx4 v26, s[16:19], s29 offen offset:0 lds
    s_add_u32 m0, s95, 37760
    s_nop 0
    buffer_load_dwordx4 v26, s[16:19], s29 offen offset:128 lds
    s_add_u32 s29, s91, 123136
    s_add_u32 m0, s95, 49152
    s_nop 0
    buffer_load_dwordx4 v26, s[16:19], s29 offen offset:0 lds
    s_add_u32 m0, s95, 50048
    s_nop 0
    buffer_load_dwordx4 v26, s[16:19], s29 offen offset:128 lds
    s_add_u32 s29, s91, 123392
    s_add_u32 m0, s95, 61440
    s_nop 0
    buffer_load_dwordx4 v26, s[16:19], s29 offen offset:0 lds
    s_add_u32 m0, s95, 62336
    s_nop 0
    buffer_load_dwordx4 v26, s[16:19], s29 offen offset:128 lds
    s_waitcnt vmcnt(12)
    s_barrier
    ds_read_b64_tr_b16 a[52:53], v18 offset:24576
    ds_read_b64_tr_b16 a[54:55], v18 offset:25088
    ds_read_b64_tr_b16 a[76:77], v21 offset:24576
    ds_read_b64_tr_b16 a[78:79], v21 offset:25088
    ds_read_b64_tr_b16 a[100:101], v18 offset:36864
    ds_read_b64_tr_b16 a[102:103], v18 offset:37376
    ds_read_b64_tr_b16 a[124:125], v21 offset:36864
    ds_read_b64_tr_b16 a[126:127], v21 offset:37376
    ds_read_b64_tr_b16 a[148:149], v19 offset:0
    ds_read_b64_tr_b16 a[150:151], v19 offset:512
    ds_read_b64_tr_b16 a[172:173], v22 offset:0
    ds_read_b64_tr_b16 a[174:175], v22 offset:512
    s_waitcnt lgkmcnt(2)
    ds_read_b64_tr_b16 a[196:197], v19 offset:12288
    ds_read_b64_tr_b16 a[198:199], v19 offset:12800
    ds_read_b64_tr_b16 a[220:221], v22 offset:12288
    ds_read_b64_tr_b16 a[222:223], v22 offset:12800
    ds_read_b64_tr_b16 a[8:9], v19 offset:24576
    ds_read_b64_tr_b16 a[10:11], v19 offset:25088
    ds_read_b64_tr_b16 a[32:33], v22 offset:24576
    ds_read_b64_tr_b16 a[34:35], v22 offset:25088
    ds_read_b64_tr_b16 a[56:57], v19 offset:36864
    ds_read_b64_tr_b16 a[58:59], v19 offset:37376
    s_waitcnt lgkmcnt(2)
    ds_read_b64_tr_b16 a[80:81], v22 offset:36864
    ds_read_b64_tr_b16 a[82:83], v22 offset:37376
Lwl_66:
    s_waitcnt lgkmcnt(0)
    s_barrier
    s_add_u32 s29, s91, 123648
    s_add_u32 m0, s95, 73728
    s_nop 0
    buffer_load_dwordx4 v26, s[16:19], s29 offen offset:0 lds
    s_add_u32 m0, s95, 74624
    s_nop 0
    buffer_load_dwordx4 v26, s[16:19], s29 offen offset:128 lds
    s_add_u32 s29, s91, 123904
    s_add_u32 m0, s95, 86016
    s_nop 0
    buffer_load_dwordx4 v26, s[16:19], s29 offen offset:0 lds
    s_add_u32 m0, s95, 86912
    s_nop 0
    buffer_load_dwordx4 v26, s[16:19], s29 offen offset:128 lds
    s_add_u32 s29, s91, 163840
    s_add_u32 m0, s95, 98304
    s_nop 0
    buffer_load_dwordx4 v26, s[16:19], s29 offen offset:0 lds
    s_add_u32 m0, s95, 99200
    s_nop 0
    buffer_load_dwordx4 v26, s[16:19], s29 offen offset:128 lds
    s_add_u32 s29, s91, 164096
    s_add_u32 m0, s95, 110592
    s_nop 0
    buffer_load_dwordx4 v26, s[16:19], s29 offen offset:0 lds
    s_add_u32 m0, s95, 111488
    s_nop 0
    buffer_load_dwordx4 v26, s[16:19], s29 offen offset:128 lds
    s_add_u32 s29, s91, 164352
    s_add_u32 m0, s95, 122880
    s_nop 0
    buffer_load_dwordx4 v26, s[16:19], s29 offen offset:0 lds
    s_add_u32 m0, s95, 123776
    s_nop 0
    buffer_load_dwordx4 v26, s[16:19], s29 offen offset:128 lds
    s_add_u32 s29, s91, 164608
    s_add_u32 m0, s95, 135168
    s_nop 0
    buffer_load_dwordx4 v26, s[16:19], s29 offen offset:0 lds
    s_add_u32 m0, s95, 136064
    s_nop 0
    buffer_load_dwordx4 v26, s[16:19], s29 offen offset:128 lds
    s_waitcnt vmcnt(12)
    s_barrier
    ds_read_b64_tr_b16 a[104:105], v17 offset:0
    ds_read_b64_tr_b16 a[106:107], v17 offset:512
    ds_read_b64_tr_b16 a[128:129], v20 offset:0
    ds_read_b64_tr_b16 a[130:131], v20 offset:512
    ds_read_b64_tr_b16 a[152:153], v17 offset:12288
    ds_read_b64_tr_b16 a[154:155], v17 offset:12800
    ds_read_b64_tr_b16 a[176:177], v20 offset:12288
    ds_read_b64_tr_b16 a[178:179], v20 offset:12800
    ds_read_b64_tr_b16 a[200:201], v17 offset:24576
    ds_read_b64_tr_b16 a[202:203], v17 offset:25088
    ds_read_b64_tr_b16 a[224:225], v20 offset:24576
    ds_read_b64_tr_b16 a[226:227], v20 offset:25088
    s_waitcnt lgkmcnt(2)
    ds_read_b64_tr_b16 a[12:13], v17 offset:36864
    ds_read_b64_tr_b16 a[14:15], v17 offset:37376
    ds_read_b64_tr_b16 a[36:37], v20 offset:36864
    ds_read_b64_tr_b16 a[38:39], v20 offset:37376
    ds_read_b64_tr_b16 a[60:61], v18 offset:0
    ds_read_b64_tr_b16 a[62:63], v18 offset:512
    ds_read_b64_tr_b16 a[84:85], v21 offset:0
    ds_read_b64_tr_b16 a[86:87], v21 offset:512
    ds_read_b64_tr_b16 a[108:109], v18 offset:12288
    ds_read_b64_tr_b16 a[110:111], v18 offset:12800
    s_waitcnt lgkmcnt(2)
    ds_read_b64_tr_b16 a[132:133], v21 offset:12288
    ds_read_b64_tr_b16 a[134:135], v21 offset:12800
Lwl_68:
    s_waitcnt lgkmcnt(0)
    s_barrier
    s_add_u32 s29, s91, 164864
    s_add_u32 m0, s95, 0
    s_nop 0
    buffer_load_dwordx4 v26, s[16:19], s29 offen offset:0 lds
    s_add_u32 m0, s95, 896
    s_nop 0
    buffer_load_dwordx4 v26, s[16:19], s29 offen offset:128 lds
    s_add_u32 s29, s91, 204800
    s_add_u32 m0, s95, 12288
    s_nop 0
    buffer_load_dwordx4 v26, s[16:19], s29 offen offset:0 lds
    s_add_u32 m0, s95, 13184
    s_nop 0
    buffer_load_dwordx4 v26, s[16:19], s29 offen offset:128 lds
    s_add_u32 s29, s91, 205056
    s_add_u32 m0, s95, 24576
    s_nop 0
    buffer_load_dwordx4 v26, s[16:19], s29 offen offset:0 lds
    s_add_u32 m0, s95, 25472
    s_nop 0
    buffer_load_dwordx4 v26, s[16:19], s29 offen offset:128 lds
    s_add_u32 s29, s91, 205312
    s_add_u32 m0, s95, 36864
    s_nop 0
    buffer_load_dwordx4 v26, s[16:19], s29 offen offset:0 lds
    s_add_u32 m0, s95, 37760
    s_nop 0
    buffer_load_dwordx4 v26, s[16:19], s29 offen offset:128 lds
    s_add_u32 s29, s91, 205568
    s_add_u32 m0, s95, 49152
    s_nop 0
    buffer_load_dwordx4 v26, s[16:19], s29 offen offset:0 lds
    s_add_u32 m0, s95, 50048
    s_nop 0
    buffer_load_dwordx4 v26, s[16:19], s29 offen offset:128 lds
    s_add_u32 s29, s91, 205824
    s_add_u32 m0, s95, 61440
    s_nop 0
    buffer_load_dwordx4 v26, s[16:19], s29 offen offset:0 lds
    s_add_u32 m0, s95, 62336
    s_nop 0
    buffer_load_dwordx4 v26, s[16:19], s29 offen offset:128 lds
    s_waitcnt vmcnt(12)
    s_barrier
    ds_read_b64_tr_b16 a[156:157], v18 offset:24576
    ds_read_b64_tr_b16 a[158:159], v18 offset:25088
    ds_read_b64_tr_b16 a[180:181], v21 offset:24576
    ds_read_b64_tr_b16 a[182:183], v21 offset:25088
    ds_read_b64_tr_b16 a[204:205], v18 offset:36864
    ds_read_b64_tr_b16 a[206:207], v18 offset:37376
    ds_read_b64_tr_b16 a[228:229], v21 offset:36864
    ds_read_b64_tr_b16 a[230:231], v21 offset:37376
    ds_read_b64_tr_b16 a[16:17], v19 offset:0
    ds_read_b64_tr_b16 a[18:19], v19 offset:512
    ds_read_b64_tr_b16 a[40:41], v22 offset:0
    ds_read_b64_tr_b16 a[42:43], v22 offset:512
    s_waitcnt lgkmcnt(2)
    ds_read_b64_tr_b16 a[64:65], v19 offset:12288
    ds_read_b64_tr_b16 a[66:67], v19 offset:12800
    ds_read_b64_tr_b16 a[88:89], v22 offset:12288
    ds_read_b64_tr_b16 a[90:91], v22 offset:12800
    ds_read_b64_tr_b16 a[112:113], v19 offset:24576
    ds_read_b64_tr_b16 a[114:115], v19 offset:25088
    ds_read_b64_tr_b16 a[136:137], v22 offset:24576
    ds_read_b64_tr_b16 a[138:139], v22 offset:25088
    ds_read_b64_tr_b16 a[160:161], v19 offset:36864
    ds_read_b64_tr_b16 a[162:163], v19 offset:37376
    s_waitcnt lgkmcnt(2)
    ds_read_b64_tr_b16 a[184:185], v22 offset:36864
    ds_read_b64_tr_b16 a[186:187], v22 offset:37376
Lwl_70:
    s_waitcnt lgkmcnt(0)
    s_waitcnt vmcnt(0)
    s_barrier
    ds_read_b64_tr_b16 a[208:209], v17 offset:0
    ds_read_b64_tr_b16 a[210:211], v17 offset:512
    ds_read_b64_tr_b16 a[232:233], v20 offset:0
    ds_read_b64_tr_b16 a[234:235], v20 offset:512
    ds_read_b64_tr_b16 a[20:21], v17 offset:12288
    ds_read_b64_tr_b16 a[22:23], v17 offset:12800
    ds_read_b64_tr_b16 a[44:45], v20 offset:12288
    ds_read_b64_tr_b16 a[46:47], v20 offset:12800
    ds_read_b64_tr_b16 a[68:69], v17 offset:24576
    ds_read_b64_tr_b16 a[70:71], v17 offset:25088
    ds_read_b64_tr_b16 a[92:93], v20 offset:24576
    ds_read_b64_tr_b16 a[94:95], v20 offset:25088
    s_waitcnt lgkmcnt(2)
    ds_read_b64_tr_b16 a[116:117], v17 offset:36864
    ds_read_b64_tr_b16 a[118:119], v17 offset:37376
    ds_read_b64_tr_b16 a[140:141], v20 offset:36864
    ds_read_b64_tr_b16 a[142:143], v20 offset:37376
    ds_read_b64_tr_b16 a[164:165], v18 offset:0
    ds_read_b64_tr_b16 a[166:167], v18 offset:512
    ds_read_b64_tr_b16 a[188:189], v21 offset:0
    ds_read_b64_tr_b16 a[190:191], v21 offset:512
    ds_read_b64_tr_b16 a[212:213], v18 offset:12288
    ds_read_b64_tr_b16 a[214:215], v18 offset:12800
    s_waitcnt lgkmcnt(2)
    ds_read_b64_tr_b16 a[236:237], v21 offset:12288
    ds_read_b64_tr_b16 a[238:239], v21 offset:12800
Lwl_72:
    s_waitcnt lgkmcnt(0)
    s_cmp_lg_u32 s24, 0
    s_cbranch_scc1 Lgod_75
    v_mov_b32 v5, 132
Lgo_74:
    buffer_load_dword v6, v5, s[20:23], 0 offen sc1
    s_waitcnt vmcnt(0)
    v_cmp_eq_u32 vcc, 0, v6
    s_cbranch_vccz Lgod_75
    s_sleep 2
    s_sub_u32 s27, s27, 1
    s_cbranch_scc1 L_exit
    s_branch Lgo_74
Lgod_75:
    s_barrier
    s_mov_b32 s26, 0
    v_mov_b32 v5, 0
    v_mov_b32 v16, v4
    s_mul_i32 s75, s24, 4235264
    s_lshl_b32 s28, s25, 10
    s_add_u32 s75, s75, s28
    s_add_u32 s75, s75, 0x5200000
    s_mul_i32 s76, s25, 786432
    s_mul_i32 s80, s24, 3072
    s_add_u32 s76, s76, s80
    s_add_u32 s76, s76, 0xc800000
    s_lshl_b32 s28, s25, 7
    s_add_u32 s74, s28, 0xba16000
    s_add_u32 s77, s28, 0xba17000
    s_cmp_eq_u32 s24, 0
    s_cselect_b32 s74, s74, 0x10000000
    s_mov_b32 s79, 1
Lwf_76:
    buffer_load_dword v17, v5, s[4:7], s77 offen sc1
    s_waitcnt vmcnt(0)
    v_cmp_gt_u32 vcc, s79, v17
    s_cbranch_vccz Lwfd_77
    s_sleep 1
    s_sub_u32 s27, s27, 1
    s_cbranch_scc1 L_exit
    s_branch Lwf_76
Lwfd_77:
    s_mov_b32 m0, s80
    s_add_u32 s80, s80, 16384
    s_and_b32 s80, s80, 0xffff
    buffer_load_dwordx4 v4, s[4:7], s76 offen offset:0 sc1 lds
    buffer_load_dwordx4 v4, s[4:7], s76 offen offset:1024 sc1 lds
    buffer_load_dwordx4 v4, s[4:7], s76 offen offset:2048 sc1 lds
    s_add_u32 s76, s76, 12288
    s_waitcnt vmcnt(0)
    s_barrier
    ds_read_b128 v[32:35], v16 offset:0
    ds_read_b128 v[36:39], v16 offset:1024
    ds_read_b128 v[40:43], v16 offset:2048
    ds_read_b128 v[44:47], v16 offset:3072
    ds_read_b128 v[48:51], v16 offset:4096
    ds_read_b128 v[52:55], v16 offset:5120
    ds_read_b128 v[56:59], v16 offset:6144
    ds_read_b128 v[60:63], v16 offset:7168
    ds_read_b128 v[64:67], v16 offset:8192
    ds_read_b128 v[68:71], v16 offset:9216
    ds_read_b128 v[72:75], v16 offset:10240
    ds_read_b128 v[76:79], v16 offset:11264
    v_add_u32 v16, 16384, v16
    v_and_b32 v16, 0xffff, v16
    s_branch L_up_go
L_up_vw0:
Lwf_78:
    buffer_load_dword v17, v5, s[4:7], s77 offen sc1
    s_waitcnt vmcnt(0)
    v_cmp_gt_u32 vcc, s79, v17
    s_cbranch_vccz Lwfd_79
    s_sleep 1
    s_sub_u32 s27, s27, 1
    s_cbranch_scc1 L_exit
    s_branch Lwf_78
Lwfd_79:
    s_branch L_up_vk0
L_up_vw1:
Lwf_80:
    buffer_load_dword v17, v5, s[4:7], s77 offen sc1
    s_waitcnt vmcnt(0)
    v_cmp_gt_u32 vcc, s79, v17
    s_cbranch_vccz Lwfd_81
    s_sleep 1
    s_sub_u32 s27, s27, 1
    s_cbranch_scc1 L_exit
    s_branch Lwf_80
Lwfd_81:
    s_branch L_up_vk1
L_up_now:
    s_nop 3
    v_cvt_pk_bf16_f32 v96, v96, v97
    v_cvt_pk_bf16_f32 v97, v98, v99
    v_cvt_pk_bf16_f32 v98, v100, v101
    v_cvt_pk_bf16_f32 v99, v102, v103
    s_add_u32 s29, s75, 67764224
    buffer_store_dwordx4 v[96:99], v4, s[4:7], s29 offen sc1
    v_cvt_pk_bf16_f32 v104, v104, v105
    v_cvt_pk_bf16_f32 v105, v106, v107
    v_cvt_pk_bf16_f32 v106, v108, v109
    v_cvt_pk_bf16_f32 v107, v110, v111
    s_add_u32 s29, s75, 69881856
    buffer_store_dwordx4 v[104:107], v4, s[4:7], s29 offen sc1
    s_add_u32 s75, s75, 32768
    s_waitcnt vmcnt(0)
    s_barrier
    v_mov_b32 v6, s26
    s_mov_b64 exec, 1
    buffer_store_dword v6, v5, s[4:7], s74 offen sc1
    s_mov_b64 exec, -1
    s_cmp_ge_u32 s26, 64
    s_cbranch_scc1 L_up_end
L_up_go:
    s_waitcnt lgkmcnt(0)
    v_mfma_f32_16x16x32_bf16 v[80:83], v[32:35], a[0:3], 0
    v_mfma_f32_16x16x32_bf16 v[84:87], v[56:59], a[0:3], 0
    v_mfma_f32_16x16x32_bf16 v[88:91], v[32:35], a[24:27], 0
    v_mfma_f32_16x16x32_bf16 v[92:95], v[56:59], a[24:27], 0
    v_readfirstlane_b32 s78, v17
    s_add_u32 s79, s26, 2
    s_min_u32 s79, s79, 64
    s_cmp_lt_u32 s78, s79
    s_cbranch_scc1 L_up_vw0
L_up_vk0:
    v_mfma_f32_16x16x32_bf16 v[80:83], v[36:39], a[4:7], v[80:83]
    s_mov_b32 m0, s80
    s_add_u32 s80, s80, 16384
    s_and_b32 s80, s80, 0xffff
    v_mfma_f32_16x16x32_bf16 v[84:87], v[60:63], a[4:7], v[84:87]
    buffer_load_dwordx4 v4, s[4:7], s76 offen offset:0 sc1 lds
    v_mfma_f32_16x16x32_bf16 v[88:91], v[36:39], a[28:31], v[88:91]
    buffer_load_dwordx4 v4, s[4:7], s76 offen offset:1024 sc1 lds
    v_mfma_f32_16x16x32_bf16 v[92:95], v[60:63], a[28:31], v[92:95]
    buffer_load_dwordx4 v4, s[4:7], s76 offen offset:2048 sc1 lds
    v_mfma_f32_16x16x32_bf16 v[80:83], v[40:43], a[8:11], v[80:83]
    s_add_u32 s76, s76, 12288
    v_mfma_f32_16x16x32_bf16 v[84:87], v[64:67], a[8:11], v[84:87]
    buffer_load_dword v17, v5, s[4:7], s77 offen sc1
    v_mfma_f32_16x16x32_bf16 v[88:91], v[40:43], a[32:35], v[88:91]
    v_mfma_f32_16x16x32_bf16 v[92:95], v[64:67], a[32:35], v[92:95]
    v_mfma_f32_16x16x32_bf16 v[80:83], v[44:47], a[12:15], v[80:83]
    v_mfma_f32_16x16x32_bf16 v[84:87], v[68:71], a[12:15], v[84:87]
    v_mfma_f32_16x16x32_bf16 v[88:91], v[44:47], a[36:39], v[88:91]
    v_mfma_f32_16x16x32_bf16 v[92:95], v[68:71], a[36:39], v[92:95]
    v_mfma_f32_16x16x32_bf16 v[80:83], v[48:51], a[16:19], v[80:83]
    v_mfma_f32_16x16x32_bf16 v[84:87], v[72:75], a[16:19], v[84:87]
    v_mfma_f32_16x16x32_bf16 v[88:91], v[48:51], a[40:43], v[88:91]
    v_mfma_f32_16x16x32_bf16 v[92:95], v[72:75], a[40:43], v[92:95]
    v_mfma_f32_16x16x32_bf16 v[80:83], v[52:55], a[20:23], v[80:83]
    v_mfma_f32_16x16x32_bf16 v[84:87], v[76:79], a[20:23], v[84:87]
    v_mfma_f32_16x16x32_bf16 v[88:91], v[52:55], a[44:47], v[88:91]
    v_mfma_f32_16x16x32_bf16 v[92:95], v[76:79], a[44:47], v[92:95]
    s_branch L_up_join
L_up_top:
    s_waitcnt lgkmcnt(0)
    v_mfma_f32_16x16x32_bf16 v[80:83], v[32:35], a[0:3], 0
    v_mfma_f32_16x16x32_bf16 v[84:87], v[56:59], a[0:3], 0
    v_mfma_f32_16x16x32_bf16 v[88:91], v[32:35], a[24:27], 0
    v_mfma_f32_16x16x32_bf16 v[92:95], v[56:59], a[24:27], 0
    v_readfirstlane_b32 s78, v17
    s_add_u32 s79, s26, 2
    s_min_u32 s79, s79, 64
    s_cmp_lt_u32 s78, s79
    s_cbranch_scc1 L_up_vw1
L_up_vk1:
    v_mfma_f32_16x16x32_bf16 v[80:83], v[36:39], a[4:7], v[80:83]
    s_mov_b32 m0, s80
    s_add_u32 s80, s80, 16384
    s_and_b32 s80, s80, 0xffff
    v_mfma_f32_16x16x32_bf16 v[84:87], v[60:63], a[4:7], v[84:87]
    buffer_load_dwordx4 v4, s[4:7], s76 offen offset:0 sc1 lds
    v_mfma_f32_16x16x32_bf16 v[88:91], v[36:39], a[28:31], v[88:91]
    buffer_load_dwordx4 v4, s[4:7], s76 offen offset:1024 sc1 lds
    v_mfma_f32_16x16x32_bf16 v[92:95], v[60:63], a[28:31], v[92:95]
    buffer_load_dwordx4 v4, s[4:7], s76 offen offset:2048 sc1 lds
    v_mfma_f32_16x16x32_bf16 v[80:83], v[40:43], a[8:11], v[80:83]
    s_add_u32 s76, s76, 12288
    v_mfma_f32_16x16x32_bf16 v[84:87], v[64:67], a[8:11], v[84:87]
    buffer_load_dword v17, v5, s[4:7], s77 offen sc1
    v_mfma_f32_16x16x32_bf16 v[88:91], v[40:43], a[32:35], v[88:91]
    v_cvt_pk_bf16_f32 v96, v96, v97
    v_cvt_pk_bf16_f32 v97, v98, v99
    v_mfma_f32_16x16x32_bf16 v[92:95], v[64:67], a[32:35], v[92:95]
    v_cvt_pk_bf16_f32 v98, v100, v101
    v_cvt_pk_bf16_f32 v99, v102, v103
    v_mfma_f32_16x16x32_bf16 v[80:83], v[44:47], a[12:15], v[80:83]
    s_add_u32 s29, s75, 67764224
    buffer_store_dwordx4 v[96:99], v4, s[4:7], s29 offen sc1
    v_mfma_f32_16x16x32_bf16 v[84:87], v[68:71], a[12:15], v[84:87]
    v_cvt_pk_bf16_f32 v104, v104, v105
    v_cvt_pk_bf16_f32 v105, v106, v107
    v_mfma_f32_16x16x32_bf16 v[88:91], v[44:47], a[36:39], v[88:91]
    v_cvt_pk_bf16_f32 v106, v108, v109
    v_cvt_pk_bf16_f32 v107, v110, v111
    v_mfma_f32_16x16x32_bf16 v[92:95], v[68:71], a[36:39], v[92:95]
    s_add_u32 s29, s75, 69881856
    buffer_store_dwordx4 v[104:107], v4, s[4:7], s29 offen sc1
    v_mfma_f32_16x16x32_bf16 v[80:83], v[48:51], a[16:19], v[80:83]
    s_add_u32 s75, s75, 32768
    v_mfma_f32_16x16x32_bf16 v[84:87], v[72:75], a[16:19], v[84:87]
    v_mfma_f32_16x16x32_bf16 v[88:91], v[48:51], a[40:43], v[88:91]
    v_mfma_f32_16x16x32_bf16 v[92:95], v[72:75], a[40:43], v[92:95]
    v_mfma_f32_16x16x32_bf16 v[80:83], v[52:55], a[20:23], v[80:83]
    v_mfma_f32_16x16x32_bf16 v[84:87], v[76:79], a[20:23], v[84:87]
    v_mfma_f32_16x16x32_bf16 v[88:91], v[52:55], a[44:47], v[88:91]
    v_mfma_f32_16x16x32_bf16 v[92:95], v[76:79], a[44:47], v[92:95]
L_up_join:
    v_mfma_f32_16x16x32_bf16 v[96:99], v[32:35], a[48:51], 0
    v_mfma_f32_16x16x32_bf16 v[100:103], v[56:59], a[48:51], 0
    v_mfma_f32_16x16x32_bf16 v[104:107], v[32:35], a[72:75], 0
    v_mfma_f32_16x16x32_bf16 v[108:111], v[56:59], a[72:75], 0
    v_cvt_pk_bf16_f32 v80, v80, v81
    v_cvt_pk_bf16_f32 v81, v82, v83
    v_mfma_f32_16x16x32_bf16 v[96:99], v[36:39], a[52:55], v[96:99]
    v_cvt_pk_bf16_f32 v82, v84, v85
    v_cvt_pk_bf16_f32 v83, v86, v87
    v_mfma_f32_16x16x32_bf16 v[100:103], v[60:63], a[52:55], v[100:103]
    s_add_u32 s29, s75, 0
    buffer_store_dwordx4 v[80:83], v4, s[4:7], s29 offen sc1
    v_mfma_f32_16x16x32_bf16 v[104:107], v[36:39], a[76:79], v[104:107]
    v_cvt_pk_bf16_f32 v88, v88, v89
    v_cvt_pk_bf16_f32 v89, v90, v91
    v_mfma_f32_16x16x32_bf16 v[108:111], v[60:63], a[76:79], v[108:111]
    v_cvt_pk_bf16_f32 v90, v92, v93
    v_cvt_pk_bf16_f32 v91, v94, v95
    v_mfma_f32_16x16x32_bf16 v[96:99], v[40:43], a[56:59], v[96:99]
    s_add_u32 s29, s75, 2117632
    buffer_store_dwordx4 v[88:91], v4, s[4:7], s29 offen sc1
    v_mfma_f32_16x16x32_bf16 v[100:103], v[64:67], a[56:59], v[100:103]
    v_mfma_f32_16x16x32_bf16 v[104:107], v[40:43], a[80:83], v[104:107]
    v_mfma_f32_16x16x32_bf16 v[108:111], v[64:67], a[80:83], v[108:111]
    v_mfma_f32_16x16x32_bf16 v[96:99], v[44:47], a[60:63], v[96:99]
    v_mfma_f32_16x16x32_bf16 v[100:103], v[68:71], a[60:63], v[100:103]
    v_mfma_f32_16x16x32_bf16 v[104:107], v[44:47], a[84:87], v[104:107]
    v_mfma_f32_16x16x32_bf16 v[108:111], v[68:71], a[84:87], v[108:111]
    v_mfma_f32_16x16x32_bf16 v[96:99], v[48:51], a[64:67], v[96:99]
    v_mfma_f32_16x16x32_bf16 v[100:103], v[72:75], a[64:67], v[100:103]
    v_mfma_f32_16x16x32_bf16 v[104:107], v[48:51], a[88:91], v[104:107]
    v_mfma_f32_16x16x32_bf16 v[108:111], v[72:75], a[88:91], v[108:111]
    v_mfma_f32_16x16x32_bf16 v[96:99], v[52:55], a[68:71], v[96:99]
    v_mfma_f32_16x16x32_bf16 v[100:103], v[76:79], a[68:71], v[100:103]
    v_mfma_f32_16x16x32_bf16 v[104:107], v[52:55], a[92:95], v[104:107]
    v_mfma_f32_16x16x32_bf16 v[108:111], v[76:79], a[92:95], v[108:111]
    v_mfma_f32_16x16x32_bf16 v[112:115], v[32:35], a[96:99], 0
    v_mfma_f32_16x16x32_bf16 v[116:119], v[56:59], a[96:99], 0
    v_mfma_f32_16x16x32_bf16 v[120:123], v[32:35], a[120:123], 0
    v_mfma_f32_16x16x32_bf16 v[124:127], v[56:59], a[120:123], 0
    v_cvt_pk_bf16_f32 v96, v96, v97
    v_cvt_pk_bf16_f32 v97, v98, v99
    v_mfma_f32_16x16x32_bf16 v[112:115], v[36:39], a[100:103], v[112:115]
    v_cvt_pk_bf16_f32 v98, v100, v101
    v_cvt_pk_bf16_f32 v99, v102, v103
    v_mfma_f32_16x16x32_bf16 v[116:119], v[60:63], a[100:103], v[116:119]
    s_add_u32 s29, s75, 16941056
    buffer_store_dwordx4 v[96:99], v4, s[4:7], s29 offen sc1
    v_mfma_f32_16x16x32_bf16 v[120:123], v[36:39], a[124:127], v[120:123]
    v_cvt_pk_bf16_f32 v104, v104, v105
    v_cvt_pk_bf16_f32 v105, v106, v107
    v_mfma_f32_16x16x32_bf16 v[124:127], v[60:63], a[124:127], v[124:127]
    v_cvt_pk_bf16_f32 v106, v108, v109
    v_cvt_pk_bf16_f32 v107, v110, v111
    v_mfma_f32_16x16x32_bf16 v[112:115], v[40:43], a[104:107], v[112:115]
    s_add_u32 s29, s75, 19058688
    buffer_store_dwordx4 v[104:107], v4, s[4:7], s29 offen sc1
    v_mfma_f32_16x16x32_bf16 v[116:119], v[64:67], a[104:107], v[116:119]
    v_mfma_f32_16x16x32_bf16 v[120:123], v[40:43], a[128:131], v[120:123]
    v_mfma_f32_16x16x32_bf16 v[124:127], v[64:67], a[128:131], v[124:127]
    v_mfma_f32_16x16x32_bf16 v[112:115], v[44:47], a[108:111], v[112:115]
    v_mfma_f32_16x16x32_bf16 v[116:119], v[68:71], a[108:111], v[116:119]
    v_mfma_f32_16x16x32_bf16 v[120:123], v[44:47], a[132:135], v[120:123]
    v_mfma_f32_16x16x32_bf16 v[124:127], v[68:71], a[132:135], v[124:127]
    v_mfma_f32_16x16x32_bf16 v[112:115], v[48:51], a[112:115], v[112:115]
    v_mfma_f32_16x16x32_bf16 v[116:119], v[72:75], a[112:115], v[116:119]
    v_mfma_f32_16x16x32_bf16 v[120:123], v[48:51], a[136:139], v[120:123]
    v_mfma_f32_16x16x32_bf16 v[124:127], v[72:75], a[136:139], v[124:127]
    v_mfma_f32_16x16x32_bf16 v[112:115], v[52:55], a[116:119], v[112:115]
    v_mfma_f32_16x16x32_bf16 v[116:119], v[76:79], a[116:119], v[116:119]
    v_mfma_f32_16x16x32_bf16 v[120:123], v[52:55], a[140:143], v[120:123]
    v_mfma_f32_16x16x32_bf16 v[124:127], v[76:79], a[140:143], v[124:127]
    v_mfma_f32_16x16x32_bf16 v[80:83], v[32:35], a[144:147], 0
    v_mfma_f32_16x16x32_bf16 v[84:87], v[56:59], a[144:147], 0
    v_mfma_f32_16x16x32_bf16 v[88:91], v[32:35], a[168:171], 0
    v_mfma_f32_16x16x32_bf16 v[92:95], v[56:59], a[168:171], 0
    v_cvt_pk_bf16_f32 v112, v112, v113
    v_cvt_pk_bf16_f32 v113, v114, v115
    v_mfma_f32_16x16x32_bf16 v[80:83], v[36:39], a[148:151], v[80:83]
    v_cvt_pk_bf16_f32 v114, v116, v117
    v_cvt_pk_bf16_f32 v115, v118, v119
    v_mfma_f32_16x16x32_bf16 v[84:87], v[60:63], a[148:151], v[84:87]
    s_add_u32 s29, s75, 33882112
    buffer_store_dwordx4 v[112:115], v4, s[4:7], s29 offen sc1
    v_mfma_f32_16x16x32_bf16 v[88:91], v[36:39], a[172:175], v[88:91]
    v_cvt_pk_bf16_f32 v120, v120, v121
    v_cvt_pk_bf16_f32 v121, v122, v123
    v_mfma_f32_16x16x32_bf16 v[92:95], v[60:63], a[172:175], v[92:95]
    v_cvt_pk_bf16_f32 v122, v124, v125
    v_cvt_pk_bf16_f32 v123, v126, v127
    v_mfma_f32_16x16x32_bf16 v[80:83], v[40:43], a[152:155], v[80:83]
    s_add_u32 s29, s75, 35999744
    buffer_store_dwordx4 v[120:123], v4, s[4:7], s29 offen sc1
    v_mfma_f32_16x16x32_bf16 v[84:87], v[64:67], a[152:155], v[84:87]
    v_mfma_f32_16x16x32_bf16 v[88:91], v[40:43], a[176:179], v[88:91]
    v_mfma_f32_16x16x32_bf16 v[92:95], v[64:67], a[176:179], v[92:95]
    v_mfma_f32_16x16x32_bf16 v[80:83], v[44:47], a[156:159], v[80:83]
    v_mfma_f32_16x16x32_bf16 v[84:87], v[68:71], a[156:159], v[84:87]
    v_mfma_f32_16x16x32_bf16 v[88:91], v[44:47], a[180:183], v[88:91]
    v_mfma_f32_16x16x32_bf16 v[92:95], v[68:71], a[180:183], v[92:95]
    v_mfma_f32_16x16x32_bf16 v[80:83], v[48:51], a[160:163], v[80:83]
    v_mfma_f32_16x16x32_bf16 v[84:87], v[72:75], a[160:163], v[84:87]
    v_mfma_f32_16x16x32_bf16 v[88:91], v[48:51], a[184:187], v[88:91]
    v_mfma_f32_16x16x32_bf16 v[92:95], v[72:75], a[184:187], v[92:95]
    v_mfma_f32_16x16x32_bf16 v[80:83], v[52:55], a[164:167], v[80:83]
    v_mfma_f32_16x16x32_bf16 v[84:87], v[76:79], a[164:167], v[84:87]
    v_mfma_f32_16x16x32_bf16 v[88:91], v[52:55], a[188:191], v[88:91]
    v_mfma_f32_16x16x32_bf16 v[92:95], v[76:79], a[188:191], v[92:95]
    s_waitcnt vmcnt(6)
    s_barrier
    v_mfma_f32_16x16x32_bf16 v[96:99], v[32:35], a[192:195], 0
    v_mfma_f32_16x16x32_bf16 v[100:103], v[56:59], a[192:195], 0
    v_mfma_f32_16x16x32_bf16 v[104:107], v[32:35], a[216:219], 0
    ds_read_b128 v[32:35], v16 offset:0
    v_mfma_f32_16x16x32_bf16 v[108:111], v[56:59], a[216:219], 0
    ds_read_b128 v[56:59], v16 offset:6144
    v_mfma_f32_16x16x32_bf16 v[96:99], v[36:39], a[196:199], v[96:99]
    v_cvt_pk_bf16_f32 v80, v80, v81
    v_cvt_pk_bf16_f32 v81, v82, v83
    v_mfma_f32_16x16x32_bf16 v[100:103], v[60:63], a[196:199], v[100:103]
    v_cvt_pk_bf16_f32 v82, v84, v85
    v_cvt_pk_bf16_f32 v83, v86, v87
    v_mfma_f32_16x16x32_bf16 v[104:107], v[36:39], a[220:223], v[104:107]
    ds_read_b128 v[36:39], v16 offset:1024
    v_mfma_f32_16x16x32_bf16 v[108:111], v[60:63], a[220:223], v[108:111]
    ds_read_b128 v[60:63], v16 offset:7168
    v_mfma_f32_16x16x32_bf16 v[96:99], v[40:43], a[200:203], v[96:99]
    s_add_u32 s29, s75, 50823168
    buffer_store_dwordx4 v[80:83], v4, s[4:7], s29 offen sc1
    v_mfma_f32_16x16x32_bf16 v[100:103], v[64:67], a[200:203], v[100:103]
    v_cvt_pk_bf16_f32 v88, v88, v89
    v_cvt_pk_bf16_f32 v89, v90, v91
    v_mfma_f32_16x16x32_bf16 v[104:107], v[40:43], a[224:227], v[104:107]
    ds_read_b128 v[40:43], v16 offset:2048
    v_mfma_f32_16x16x32_bf16 v[108:111], v[64:67], a[224:227], v[108:111]
    ds_read_b128 v[64:67], v16 offset:8192
    v_mfma_f32_16x16x32_bf16 v[96:99], v[44:47], a[204:207], v[96:99]
    v_cvt_pk_bf16_f32 v90, v92, v93
    v_cvt_pk_bf16_f32 v91, v94, v95
    v_mfma_f32_16x16x32_bf16 v[100:103], v[68:71], a[204:207], v[100:103]
    s_add_u32 s29, s75, 52940800
    buffer_store_dwordx4 v[88:91], v4, s[4:7], s29 offen sc1
    v_mfma_f32_16x16x32_bf16 v[104:107], v[44:47], a[228:231], v[104:107]
    ds_read_b128 v[44:47], v16 offset:3072
    v_mfma_f32_16x16x32_bf16 v[108:111], v[68:71], a[228:231], v[108:111]
    ds_read_b128 v[68:71], v16 offset:9216
    v_mfma_f32_16x16x32_bf16 v[96:99], v[48:51], a[208:211], v[96:99]
    v_mov_b32 v6, s26
    s_mov_b64 exec, 1
    buffer_store_dword v6, v5, s[4:7], s74 offen sc1
    s_mov_b64 exec, -1
    v_mfma_f32_16x16x32_bf16 v[100:103], v[72:75], a[208:211], v[100:103]
    v_mfma_f32_16x16x32_bf16 v[104:107], v[48:51], a[232:235], v[104:107]
    ds_read_b128 v[48:51], v16 offset:4096
    v_mfma_f32_16x16x32_bf16 v[108:111], v[72:75], a[232:235], v[108:111]
    ds_read_b128 v[72:75], v16 offset:10240
    v_mfma_f32_16x16x32_bf16 v[96:99], v[52:55], a[212:215], v[96:99]
    v_mfma_f32_16x16x32_bf16 v[100:103], v[76:79], a[212:215], v[100:103]
    v_mfma_f32_16x16x32_bf16 v[104:107], v[52:55], a[236:239], v[104:107]
    ds_read_b128 v[52:55], v16 offset:5120
    v_mfma_f32_16x16x32_bf16 v[108:111], v[76:79], a[236:239], v[108:111]
    ds_read_b128 v[76:79], v16 offset:11264
    v_add_u32 v16, 16384, v16
    v_and_b32 v16, 0xffff, v16
    s_add_u32 s26, s26, 1
    s_sub_u32 s28, s26, 3
    s_cmp_lt_u32 s28, 61
    s_cbranch_scc1 L_up_top
    s_branch L_up_now
L_up_end:
    s_waitcnt lgkmcnt(0)
    s_cmp_ge_u32 s25, 0
    s_cbranch_scc1 L_exit
    s_branch L_join
L_k:
    s_mul_i32 s74, s24, 10240
    s_mov_b32 s75, s74
    s_and_b32 s28, s24, 1
    s_lshl_b32 s28, s28, 2
    v_add_u32 v17, s28, v3
    v_and_b32 v19, 7, v1
    v_xor_b32 v17, v17, v19
    v_lshrrev_b32 v19, 3, v1
    v_mul_u32_u24 v16, 1280, v19
    v_lshl_add_u32 v16, v17, 4, v16
    s_and_b32 s28, s24, 1
    s_lshl_b32 s29, s28, 7
    v_add_u32 v31, 128, v16
    v_subrev_u32 v31, s29, v31
    v_add_u32 v16, s29, v16
    s_lshl_b32 s29, s28, 10
    s_add_u32 s75, s75, s29
    s_lshl_b32 s29, s28, 11
    s_sub_u32 s92, 1024, s29
    s_add_u32 s93, s29, 768
    v_lshrrev_b32 v19, 1, v2
    v_xor_b32 v19, v19, v3
    v_lshlrev_b32 v17, 4, v19
    v_and_b32 v19, 7, v2
    v_lshl_add_u32 v17, v19, 7, v17
    v_lshrrev_b32 v19, 3, v2
    v_mul_u32_u24 v19, 10240, v19
    v_add_u32 v17, v17, v19
    v_xor_b32 v19, 64, v17
    s_mov_b32 m0, s75
    s_nop 0
    buffer_load_dwordx4 v16, s[8:11], s74 offen offset:0 lds
    s_add_u32 m0, m0, s92
    s_nop 0
    buffer_load_dwordx4 v31, s[8:11], s74 offen offset:0 lds
    s_add_u32 m0, m0, s93
    s_nop 0
    buffer_load_dwordx4 v16, s[8:11], s74 offen offset:256 lds
    s_add_u32 m0, m0, s92
    s_nop 0
    buffer_load_dwordx4 v31, s[8:11], s74 offen offset:256 lds
    s_add_u32 m0, m0, s93
    s_nop 0
    buffer_load_dwordx4 v16, s[8:11], s74 offen offset:512 lds
    s_add_u32 m0, m0, s92
    s_nop 0
    buffer_load_dwordx4 v31, s[8:11], s74 offen offset:512 lds
    s_add_u32 m0, m0, s93
    s_nop 0
    buffer_load_dwordx4 v16, s[8:11], s74 offen offset:768 lds
    s_add_u32 m0, m0, s92
    s_nop 0
    buffer_load_dwordx4 v31, s[8:11], s74 offen offset:768 lds
    s_add_u32 m0, m0, s93
    s_nop 0
    buffer_load_dwordx4 v16, s[8:11], s74 offen offset:1024 lds
    s_add_u32 m0, m0, s92
    s_nop 0
    buffer_load_dwordx4 v31, s[8:11], s74 offen offset:1024 lds
    s_mov_b32 s12, s38
    s_mov_b32 s13, s39
    s_mov_b32 s14, 0x780000
    s_mov_b32 s15, 0x20000
    s_cmp_eq_u32 s72, 7
    s_cselect_b32 s12, s40, s38
    s_cselect_b32 s13, s41, s39
    s_and_b32 s28, s24, 1
    s_lshl_b32 s28, s28, 2
    v_and_b32 v5, 1, v3
    v_lshlrev_b32 v5, 1, v5
    v_add_u32 v5, s28, v5
    v_and_b32 v6, 7, v1
    v_xor_b32 v5, v5, v6
    v_lshrrev_b32 v6, 3, v1
    v_mul_u32_u24 v6, 12288, v6
    v_lshl_add_u32 v32, v5, 4, v6
    s_mul_i32 s90, s24, 98304
    s_mul_i32 s28, s25, 384
    s_add_u32 s90, s90, s28
    s_mul_i32 s95, s24, 3072
    s_add_u32 s29, s90, 0
    s_add_u32 m0, s95, 40960
    s_nop 0
    buffer_load_dwordx4 v32, s[12:15], s29 offen offset:0 lds
    s_add_u32 m0, s95, 41856
    s_nop 0
    buffer_load_dwordx4 v32, s[12:15], s29 offen offset:128 lds
    s_add_u32 m0, s95, 42752
    s_nop 0
    buffer_load_dwordx4 v32, s[12:15], s29 offen offset:256 lds
    s_add_u32 s29, s90, 393216
    s_add_u32 m0, s95, 53248
    s_nop 0
    buffer_load_dwordx4 v32, s[12:15], s29 offen offset:0 lds
    s_add_u32 m0, s95, 54144
    s_nop 0
    buffer_load_dwordx4 v32, s[12:15], s29 offen offset:128 lds
    s_add_u32 m0, s95, 55040
    s_nop 0
    buffer_load_dwordx4 v32, s[12:15], s29 offen offset:256 lds
    s_add_u32 s29, s90, 786432
    s_add_u32 m0, s95, 65536
    s_nop 0
    buffer_load_dwordx4 v32, s[12:15], s29 offen offset:0 lds
    s_add_u32 m0, s95, 66432
    s_nop 0
    buffer_load_dwordx4 v32, s[12:15], s29 offen offset:128 lds
    s_add_u32 m0, s95, 67328
    s_nop 0
    buffer_load_dwordx4 v32, s[12:15], s29 offen offset:256 lds
    s_add_u32 s29, s90, 1179648
    s_add_u32 m0, s95, 77824
    s_nop 0
    buffer_load_dwordx4 v32, s[12:15], s29 offen offset:0 lds
    s_add_u32 m0, s95, 78720
    s_nop 0
    buffer_load_dwordx4 v32, s[12:15], s29 offen offset:128 lds
    s_add_u32 m0, s95, 79616
    s_nop 0
    buffer_load_dwordx4 v32, s[12:15], s29 offen offset:256 lds
    v_mov_b32 v5, 0
    buffer_load_dword v255, v5, s[20:23], 0 offen offset:144 sc1
    s_add_u32 s29, s90, 1572864
    s_add_u32 m0, s95, 90112
    s_nop 0
    buffer_load_dwordx4 v32, s[12:15], s29 offen offset:0 lds
    s_add_u32 m0, s95, 91008
    s_nop 0
    buffer_load_dwordx4 v32, s[12:15], s29 offen offset:128 lds
    s_add_u32 m0, s95, 91904
    s_nop 0
    buffer_load_dwordx4 v32, s[12:15], s29 offen offset:256 lds
    s_add_u32 s29, s90, 1966080
    s_add_u32 m0, s95, 102400
    s_nop 0
    buffer_load_dwordx4 v32, s[12:15], s29 offen offset:0 lds
    s_add_u32 m0, s95, 103296
    s_nop 0
    buffer_load_dwordx4 v32, s[12:15], s29 offen offset:128 lds
    s_add_u32 m0, s95, 104192
    s_nop 0
    buffer_load_dwordx4 v32, s[12:15], s29 offen offset:256 lds
    s_add_u32 s29, s90, 2359296
    s_add_u32 m0, s95, 114688
    s_nop 0
    buffer_load_dwordx4 v32, s[12:15], s29 offen offset:0 lds
    s_add_u32 m0, s95, 115584
    s_nop 0
    buffer_load_dwordx4 v32, s[12:15], s29 offen offset:128 lds
    s_add_u32 m0, s95, 116480
    s_nop 0
    buffer_load_dwordx4 v32, s[12:15], s29 offen offset:256 lds
    s_add_u32 s29, s90, 2752512
    s_add_u32 m0, s95, 126976
    s_nop 0
    buffer_load_dwordx4 v32, s[12:15], s29 offen offset:0 lds
    s_add_u32 m0, s95, 127872
    s_nop 0
    buffer_load_dwordx4 v32, s[12:15], s29 offen offset:128 lds
    s_add_u32 m0, s95, 128768
    s_nop 0
    buffer_load_dwordx4 v32, s[12:15], s29 offen offset:256 lds
    s_add_u32 s29, s90, 3145728
    s_add_u32 m0, s95, 139264
    s_nop 0
    buffer_load_dwordx4 v32, s[12:15], s29 offen offset:0 lds
    s_add_u32 m0, s95, 140160
    s_nop 0
    buffer_load_dwordx4 v32, s[12:15], s29 offen offset:128 lds
    s_add_u32 m0, s95, 141056
    s_nop 0
    buffer_load_dwordx4 v32, s[12:15], s29 offen offset:256 lds
    s_add_u32 s29, s90, 3538944
    s_add_u32 m0, s95, 151552
    s_nop 0
    buffer_load_dwordx4 v32, s[12:15], s29 offen offset:0 lds
    s_add_u32 m0, s95, 152448
    s_nop 0
    buffer_load_dwordx4 v32, s[12:15], s29 offen offset:128 lds
    s_add_u32 m0, s95, 153344
    s_nop 0
    buffer_load_dwordx4 v32, s[12:15], s29 offen offset:256 lds
    v_and_b32 v5, 1, v3
    v_lshlrev_b32 v5, 1, v5
    v_lshrrev_b32 v6, 3, v2
    v_add_u32 v5, v5, v6
    v_mul_u32_u24 v6, 3072, v3
    v_lshrrev_b32 v7, 2, v2
    v_lshl_add_u32 v6, v7, 7, v6
    v_and_b32 v7, 3, v2
    v_lshl_add_u32 v6, v7, 3, v6
    s_mul_i32 s28, s24, 3
    s_add_u32 s28, s28, 0
    s_and_b32 s29, s28, 3
    s_lshr_b32 s28, s28, 2
    s_lshl_b32 s28, s28, 10
    s_add_u32 s28, s28, 40960
    v_xor_b32 v7, s29, v5
    v_lshl_add_u32 v7, v7, 5, v6
    v_add_u32 v33, s28, v7
    v_add_u32 v34, 49152, v33
    v_add_u32 v35, 49152, v34
    s_mul_i32 s28, s24, 3
    s_add_u32 s28, s28, 1
    s_and_b32 s29, s28, 3
    s_lshr_b32 s28, s28, 2
    s_lshl_b32 s28, s28, 10
    s_add_u32 s28, s28, 40960
    v_xor_b32 v7, s29, v5
    v_lshl_add_u32 v7, v7, 5, v6
    v_add_u32 v36, s28, v7
    v_add_u32 v37, 49152, v36
    v_add_u32 v38, 49152, v37
    s_mul_i32 s28, s24, 3
    s_add_u32 s28, s28, 2
    s_and_b32 s29, s28, 3
    s_lshr_b32 s28, s28, 2
    s_lshl_b32 s28, s28, 10
    s_add_u32 s28, s28, 40960
    v_xor_b32 v7, s29, v5
    v_lshl_add_u32 v7, v7, 5, v6
    v_add_u32 v39, s28, v7
    v_add_u32 v40, 49152, v39
    v_add_u32 v41, 49152, v40
    s_waitcnt vmcnt(15)
    v_readfirstlane_b32 s28, v255
    s_nop 0
    s_cmp_lg_u32 s28, 0
    s_cbranch_scc1 Lcfd_83
    v_mov_b32 v5, 0
Lcf_82:
    s_sleep 4
    buffer_load_dword v255, v5, s[20:23], 0 offen offset:144 sc1
    s_sub_u32 s27, s27, 1
    s_cbranch_scc1 L_exit
    s_waitcnt vmcnt(0)
    v_readfirstlane_b32 s28, v255
    s_nop 0
    s_cmp_eq_u32 s28, 0
    s_cbranch_scc1 Lcf_82
Lcfd_83:
    s_cmp_lg_u32 s28, s3
    s_cbranch_scc1 L_redo
    s_barrier
    ds_read_b64_tr_b16 a[0:1], v33 offset:0
    ds_read_b64_tr_b16 a[2:3], v33 offset:512
    ds_read_b64_tr_b16 a[80:81], v36 offset:0
    ds_read_b64_tr_b16 a[82:83], v36 offset:512
    ds_read_b64_tr_b16 a[160:161], v39 offset:0
    ds_read_b64_tr_b16 a[162:163], v39 offset:512
    ds_read_b64_tr_b16 a[4:5], v33 offset:12288
    ds_read_b64_tr_b16 a[6:7], v33 offset:12800
    ds_read_b64_tr_b16 a[84:85], v36 offset:12288
    ds_read_b64_tr_b16 a[86:87], v36 offset:12800
    ds_read_b64_tr_b16 a[164:165], v39 offset:12288
    ds_read_b64_tr_b16 a[166:167], v39 offset:12800
    s_waitcnt lgkmcnt(2)
    ds_read_b64_tr_b16 a[8:9], v33 offset:24576
    ds_read_b64_tr_b16 a[10:11], v33 offset:25088
    ds_read_b64_tr_b16 a[88:89], v36 offset:24576
    ds_read_b64_tr_b16 a[90:91], v36 offset:25088
    ds_read_b64_tr_b16 a[168:169], v39 offset:24576
    ds_read_b64_tr_b16 a[170:171], v39 offset:25088
    ds_read_b64_tr_b16 a[12:13], v33 offset:36864
    ds_read_b64_tr_b16 a[14:15], v33 offset:37376
    ds_read_b64_tr_b16 a[92:93], v36 offset:36864
    ds_read_b64_tr_b16 a[94:95], v36 offset:37376
    s_waitcnt lgkmcnt(2)
    ds_read_b64_tr_b16 a[172:173], v39 offset:36864
    ds_read_b64_tr_b16 a[174:175], v39 offset:37376
    ds_read_b64_tr_b16 a[16:17], v34 offset:0
    ds_read_b64_tr_b16 a[18:19], v34 offset:512
    ds_read_b64_tr_b16 a[96:97], v37 offset:0
    ds_read_b64_tr_b16 a[98:99], v37 offset:512
    ds_read_b64_tr_b16 a[176:177], v40 offset:0
    ds_read_b64_tr_b16 a[178:179], v40 offset:512
Lwl_84:
    s_waitcnt lgkmcnt(0)
    s_barrier
    s_add_u32 s29, s90, 3932160
    s_add_u32 m0, s95, 40960
    s_nop 0
    buffer_load_dwordx4 v32, s[12:15], s29 offen offset:0 lds
    s_add_u32 m0, s95, 41856
    s_nop 0
    buffer_load_dwordx4 v32, s[12:15], s29 offen offset:128 lds
    s_add_u32 m0, s95, 42752
    s_nop 0
    buffer_load_dwordx4 v32, s[12:15], s29 offen offset:256 lds
    s_add_u32 s29, s90, 4325376
    s_add_u32 m0, s95, 53248
    s_nop 0
    buffer_load_dwordx4 v32, s[12:15], s29 offen offset:0 lds
    s_add_u32 m0, s95, 54144
    s_nop 0
    buffer_load_dwordx4 v32, s[12:15], s29 offen offset:128 lds
    s_add_u32 m0, s95, 55040
    s_nop 0
    buffer_load_dwordx4 v32, s[12:15], s29 offen offset:256 lds
    s_add_u32 s29, s90, 4718592
    s_add_u32 m0, s95, 65536
    s_nop 0
    buffer_load_dwordx4 v32, s[12:15], s29 offen offset:0 lds
    s_add_u32 m0, s95, 66432
    s_nop 0
    buffer_load_dwordx4 v32, s[12:15], s29 offen offset:128 lds
    s_add_u32 m0, s95, 67328
    s_nop 0
    buffer_load_dwordx4 v32, s[12:15], s29 offen offset:256 lds
    s_add_u32 s29, s90, 5111808
    s_add_u32 m0, s95, 77824
    s_nop 0
    buffer_load_dwordx4 v32, s[12:15], s29 offen offset:0 lds
    s_add_u32 m0, s95, 78720
    s_nop 0
    buffer_load_dwordx4 v32, s[12:15], s29 offen offset:128 lds
    s_add_u32 m0, s95, 79616
    s_nop 0
    buffer_load_dwordx4 v32, s[12:15], s29 offen offset:256 lds
    s_add_u32 s29, s90, 5505024
    s_add_u32 m0, s95, 90112
    s_nop 0
    buffer_load_dwordx4 v32, s[12:15], s29 offen offset:0 lds
    s_add_u32 m0, s95, 91008
    s_nop 0
    buffer_load_dwordx4 v32, s[12:15], s29 offen offset:128 lds
    s_add_u32 m0, s95, 91904
    s_nop 0
    buffer_load_dwordx4 v32, s[12:15], s29 offen offset:256 lds
    s_waitcnt vmcnt(15)
    s_barrier
    ds_read_b64_tr_b16 a[20:21], v34 offset:12288
    ds_read_b64_tr_b16 a[22:23], v34 offset:12800
    ds_read_b64_tr_b16 a[100:101], v37 offset:12288
    ds_read_b64_tr_b16 a[102:103], v37 offset:12800
    ds_read_b64_tr_b16 a[180:181], v40 offset:12288
    ds_read_b64_tr_b16 a[182:183], v40 offset:12800
    ds_read_b64_tr_b16 a[24:25], v34 offset:24576
    ds_read_b64_tr_b16 a[26:27], v34 offset:25088
    ds_read_b64_tr_b16 a[104:105], v37 offset:24576
    ds_read_b64_tr_b16 a[106:107], v37 offset:25088
    ds_read_b64_tr_b16 a[184:185], v40 offset:24576
    ds_read_b64_tr_b16 a[186:187], v40 offset:25088
    s_waitcnt lgkmcnt(2)
    ds_read_b64_tr_b16 a[28:29], v34 offset:36864
    ds_read_b64_tr_b16 a[30:31], v34 offset:37376
    ds_read_b64_tr_b16 a[108:109], v37 offset:36864
    ds_read_b64_tr_b16 a[110:111], v37 offset:37376
    ds_read_b64_tr_b16 a[188:189], v40 offset:36864
    ds_read_b64_tr_b16 a[190:191], v40 offset:37376
    ds_read_b64_tr_b16 a[32:33], v35 offset:0
    ds_read_b64_tr_b16 a[34:35], v35 offset:512
    ds_read_b64_tr_b16 a[112:113], v38 offset:0
    ds_read_b64_tr_b16 a[114:115], v38 offset:512
    s_waitcnt lgkmcnt(2)
    ds_read_b64_tr_b16 a[192:193], v41 offset:0
    ds_read_b64_tr_b16 a[194:195], v41 offset:512
    ds_read_b64_tr_b16 a[36:37], v35 offset:12288
    ds_read_b64_tr_b16 a[38:39], v35 offset:12800
    ds_read_b64_tr_b16 a[116:117], v38 offset:12288
    ds_read_b64_tr_b16 a[118:119], v38 offset:12800
    ds_read_b64_tr_b16 a[196:197], v41 offset:12288
    ds_read_b64_tr_b16 a[198:199], v41 offset:12800
Lwl_86:
    s_waitcnt lgkmcnt(0)
    s_barrier
    s_add_u32 s29, s90, 5898240
    s_add_u32 m0, s95, 102400
    s_nop 0
    buffer_load_dwordx4 v32, s[12:15], s29 offen offset:0 lds
    s_add_u32 m0, s95, 103296
    s_nop 0
    buffer_load_dwordx4 v32, s[12:15], s29 offen offset:128 lds
    s_add_u32 m0, s95, 104192
    s_nop 0
    buffer_load_dwordx4 v32, s[12:15], s29 offen offset:256 lds
    s_add_u32 s29, s90, 6291456
    s_add_u32 m0, s95, 114688
    s_nop 0
    buffer_load_dwordx4 v32, s[12:15], s29 offen offset:0 lds
    s_add_u32 m0, s95, 115584
    s_nop 0
    buffer_load_dwordx4 v32, s[12:15], s29 offen offset:128 lds
    s_add_u32 m0, s95, 116480
    s_nop 0
    buffer_load_dwordx4 v32, s[12:15], s29 offen offset:256 lds
    s_add_u32 s29, s90, 6684672
    s_add_u32 m0, s95, 126976
    s_nop 0
    buffer_load_dwordx4 v32, s[12:15], s29 offen offset:0 lds
    s_add_u32 m0, s95, 127872
    s_nop 0
    buffer_load_dwordx4 v32, s[12:15], s29 offen offset:128 lds
    s_add_u32 m0, s95, 128768
    s_nop 0
    buffer_load_dwordx4 v32, s[12:15], s29 offen offset:256 lds
    s_add_u32 s29, s90, 7077888
    s_add_u32 m0, s95, 139264
    s_nop 0
    buffer_load_dwordx4 v32, s[12:15], s29 offen offset:0 lds
    s_add_u32 m0, s95, 140160
    s_nop 0
    buffer_load_dwordx4 v32, s[12:15], s29 offen offset:128 lds
    s_add_u32 m0, s95, 141056
    s_nop 0
    buffer_load_dwordx4 v32, s[12:15], s29 offen offset:256 lds
    s_add_u32 s29, s90, 7471104
    s_add_u32 m0, s95, 151552
    s_nop 0
    buffer_load_dwordx4 v32, s[12:15], s29 offen offset:0 lds
    s_add_u32 m0, s95, 152448
    s_nop 0
    buffer_load_dwordx4 v32, s[12:15], s29 offen offset:128 lds
    s_add_u32 m0, s95, 153344
    s_nop 0
    buffer_load_dwordx4 v32, s[12:15], s29 offen offset:256 lds
    s_waitcnt vmcnt(15)
    s_barrier
    ds_read_b64_tr_b16 a[40:41], v33 offset:0
    ds_read_b64_tr_b16 a[42:43], v33 offset:512
    ds_read_b64_tr_b16 a[120:121], v36 offset:0
    ds_read_b64_tr_b16 a[122:123], v36 offset:512
    ds_read_b64_tr_b16 a[200:201], v39 offset:0
    ds_read_b64_tr_b16 a[202:203], v39 offset:512
    ds_read_b64_tr_b16 a[44:45], v33 offset:12288
    ds_read_b64_tr_b16 a[46:47], v33 offset:12800
    ds_read_b64_tr_b16 a[124:125], v36 offset:12288
    ds_read_b64_tr_b16 a[126:127], v36 offset:12800
    ds_read_b64_tr_b16 a[204:205], v39 offset:12288
    ds_read_b64_tr_b16 a[206:207], v39 offset:12800
    s_waitcnt lgkmcnt(2)
    ds_read_b64_tr_b16 a[48:49], v33 offset:24576
    ds_read_b64_tr_b16 a[50:51], v33 offset:25088
    ds_read_b64_tr_b16 a[128:129], v36 offset:24576
    ds_read_b64_tr_b16 a[130:131], v36 offset:25088
    ds_read_b64_tr_b16 a[208:209], v39 offset:24576
    ds_read_b64_tr_b16 a[210:211], v39 offset:25088
    ds_read_b64_tr_b16 a[52:53], v33 offset:36864
    ds_read_b64_tr_b16 a[54:55], v33 offset:37376
    ds_read_b64_tr_b16 a[132:133], v36 offset:36864
    ds_read_b64_tr_b16 a[134:135], v36 offset:37376
    s_waitcnt lgkmcnt(2)
    ds_read_b64_tr_b16 a[212:213], v39 offset:36864
    ds_read_b64_tr_b16 a[214:215], v39 offset:37376
    ds_read_b64_tr_b16 a[56:57], v34 offset:0
    ds_read_b64_tr_b16 a[58:59], v34 offset:512
    ds_read_b64_tr_b16 a[136:137], v37 offset:0
    ds_read_b64_tr_b16 a[138:139], v37 offset:512
    ds_read_b64_tr_b16 a[216:217], v40 offset:0
    ds_read_b64_tr_b16 a[218:219], v40 offset:512
Lwl_88:
    s_waitcnt lgkmcnt(0)
    s_waitcnt vmcnt(0)
    s_barrier
    ds_read_b64_tr_b16 a[60:61], v34 offset:12288
    ds_read_b64_tr_b16 a[62:63], v34 offset:12800
    ds_read_b64_tr_b16 a[140:141], v37 offset:12288
    ds_read_b64_tr_b16 a[142:143], v37 offset:12800
    ds_read_b64_tr_b16 a[220:221], v40 offset:12288
    ds_read_b64_tr_b16 a[222:223], v40 offset:12800
    ds_read_b64_tr_b16 a[64:65], v34 offset:24576
    ds_read_b64_tr_b16 a[66:67], v34 offset:25088
    ds_read_b64_tr_b16 a[144:145], v37 offset:24576
    ds_read_b64_tr_b16 a[146:147], v37 offset:25088
    ds_read_b64_tr_b16 a[224:225], v40 offset:24576
    ds_read_b64_tr_b16 a[226:227], v40 offset:25088
    s_waitcnt lgkmcnt(2)
    ds_read_b64_tr_b16 a[68:69], v34 offset:36864
    ds_read_b64_tr_b16 a[70:71], v34 offset:37376
    ds_read_b64_tr_b16 a[148:149], v37 offset:36864
    ds_read_b64_tr_b16 a[150:151], v37 offset:37376
    ds_read_b64_tr_b16 a[228:229], v40 offset:36864
    ds_read_b64_tr_b16 a[230:231], v40 offset:37376
    ds_read_b64_tr_b16 a[72:73], v35 offset:0
    ds_read_b64_tr_b16 a[74:75], v35 offset:512
    ds_read_b64_tr_b16 a[152:153], v38 offset:0
    ds_read_b64_tr_b16 a[154:155], v38 offset:512
    s_waitcnt lgkmcnt(2)
    ds_read_b64_tr_b16 a[232:233], v41 offset:0
    ds_read_b64_tr_b16 a[234:235], v41 offset:512
    ds_read_b64_tr_b16 a[76:77], v35 offset:12288
    ds_read_b64_tr_b16 a[78:79], v35 offset:12800
    ds_read_b64_tr_b16 a[156:157], v38 offset:12288
    ds_read_b64_tr_b16 a[158:159], v38 offset:12800
    ds_read_b64_tr_b16 a[236:237], v41 offset:12288
    ds_read_b64_tr_b16 a[238:239], v41 offset:12800
Lwl_90:
    s_waitcnt lgkmcnt(0)
    s_cmp_lg_u32 s24, 0
    s_cbranch_scc1 Lgod_93
    v_mov_b32 v5, 132
Lgo_92:
    buffer_load_dword v6, v5, s[20:23], 0 offen sc1
    s_waitcnt vmcnt(0)
    v_cmp_eq_u32 vcc, 0, v6
    s_cbranch_vccz Lgod_93
    s_sleep 2
    s_sub_u32 s27, s27, 1
    s_cbranch_scc1 L_exit
    s_branch Lgo_92
Lgod_93:
    s_barrier
    s_mov_b32 s26, 0
    v_mov_b32 v5, 0
    v_lshlrev_b32 v18, 3, v1
    s_mul_i32 s77, s25, 786432
    s_mul_i32 s28, s24, 1536
    s_add_u32 s77, s77, s28
    s_add_u32 s77, s77, 0x2a00000
    s_lshl_b32 s78, s25, 7
    s_add_u32 s78, s78, 0xba10000
    s_cmp_lg_u32 s72, 7
    s_cbranch_scc1 L_k_nv
    s_add_u32 s77, s77, 0x9e00000
    s_add_u32 s78, s78, 0x7000
    v_lshrrev_b32 v6, 1, v3
    v_lshlrev_b32 v18, 8, v6
    v_lshl_add_u32 v18, v2, 4, v18
    v_and_b32 v6, 1, v3
    v_lshl_add_u32 v18, v6, 3, v18
L_k_nv:
    s_add_u32 s79, s77, 6144
    s_cmp_eq_u32 s24, 0
    s_cselect_b32 s89, s78, 0x10000000
    s_mov_b32 s87, 0
    s_mov_b32 s88, 40960
    s_add_u32 s74, s74, 40960
    s_add_u32 m0, s88, s75
    s_add_u32 s88, s88, 40960
    s_cmp_eq_u32 s88, 122880
    s_cselect_b32 s88, 0, s88
    buffer_load_dwordx4 v16, s[8:11], s74 offen offset:0 lds
    s_add_u32 m0, m0, s92
    s_nop 0
    buffer_load_dwordx4 v31, s[8:11], s74 offen offset:0 lds
    s_add_u32 m0, m0, s93
    s_nop 0
    buffer_load_dwordx4 v16, s[8:11], s74 offen offset:256 lds
    s_add_u32 m0, m0, s92
    s_nop 0
    buffer_load_dwordx4 v31, s[8:11], s74 offen offset:256 lds
    s_add_u32 m0, m0, s93
    s_nop 0
    buffer_load_dwordx4 v16, s[8:11], s74 offen offset:512 lds
    s_add_u32 m0, m0, s92
    s_nop 0
    buffer_load_dwordx4 v31, s[8:11], s74 offen offset:512 lds
    s_add_u32 m0, m0, s93
    s_nop 0
    buffer_load_dwordx4 v16, s[8:11], s74 offen offset:768 lds
    s_add_u32 m0, m0, s92
    s_nop 0
    buffer_load_dwordx4 v31, s[8:11], s74 offen offset:768 lds
    s_add_u32 m0, m0, s93
    s_nop 0
    buffer_load_dwordx4 v16, s[8:11], s74 offen offset:1024 lds
    s_add_u32 m0, m0, s92
    s_nop 0
    buffer_load_dwordx4 v31, s[8:11], s74 offen offset:1024 lds
    s_waitcnt vmcnt(10)
    s_barrier
    ds_read_b128 v[32:35], v17 offset:0
    ds_read_b128 v[36:39], v17 offset:20480
    ds_read_b128 v[40:43], v19 offset:0
    ds_read_b128 v[44:47], v19 offset:20480
    ds_read_b128 v[48:51], v17 offset:1024
    ds_read_b128 v[52:55], v17 offset:21504
    s_waitcnt lgkmcnt(4)
    v_mfma_f32_16x16x32_bf16 v[64:67], a[0:3], v[32:35], 0
    ds_read_b128 v[56:59], v19 offset:1024
    v_mfma_f32_16x16x32_bf16 v[68:71], a[0:3], v[36:39], 0
    ds_read_b128 v[60:63], v19 offset:21504
    v_mfma_f32_16x16x32_bf16 v[72:75], a[80:83], v[32:35], 0
    v_mfma_f32_16x16x32_bf16 v[76:79], a[80:83], v[36:39], 0
    v_mfma_f32_16x16x32_bf16 v[80:83], a[160:163], v[32:35], 0
    v_mfma_f32_16x16x32_bf16 v[84:87], a[160:163], v[36:39], 0
    s_waitcnt lgkmcnt(4)
    v_mfma_f32_16x16x32_bf16 v[64:67], a[4:7], v[40:43], v[64:67]
    ds_read_b128 v[32:35], v17 offset:2048
    v_mfma_f32_16x16x32_bf16 v[68:71], a[4:7], v[44:47], v[68:71]
    ds_read_b128 v[36:39], v17 offset:22528
    v_mfma_f32_16x16x32_bf16 v[72:75], a[84:87], v[40:43], v[72:75]
    v_mfma_f32_16x16x32_bf16 v[76:79], a[84:87], v[44:47], v[76:79]
    v_mfma_f32_16x16x32_bf16 v[80:83], a[164:167], v[40:43], v[80:83]
    v_mfma_f32_16x16x32_bf16 v[84:87], a[164:167], v[44:47], v[84:87]
    s_waitcnt lgkmcnt(0)
    s_branch L_k_go
L_k_now:
    s_waitcnt vmcnt(0) lgkmcnt(0)
    s_barrier
    v_mov_b32 v6, s26
    s_mov_b64 exec, 1
    buffer_store_dword v6, v5, s[4:7], s89 offen sc1
    s_mov_b64 exec, -1
    s_cmp_ge_u32 s26, 64
    s_cbranch_scc1 L_k_end
L_k_go:
    s_add_u32 s74, s74, 40960
    s_add_u32 m0, s88, s75
    s_add_u32 s88, s88, 40960
    s_cmp_eq_u32 s88, 122880
    s_cselect_b32 s88, 0, s88
    v_mfma_f32_16x16x32_bf16 v[64:67], a[8:11], v[48:51], v[64:67]
    ds_read_b128 v[40:43], v19 offset:2048
    v_mfma_f32_16x16x32_bf16 v[68:71], a[8:11], v[52:55], v[68:71]
    ds_read_b128 v[44:47], v19 offset:22528
    v_mfma_f32_16x16x32_bf16 v[72:75], a[88:91], v[48:51], v[72:75]
    buffer_load_dwordx4 v16, s[8:11], s74 offen offset:0 lds
    s_add_u32 m0, m0, s92
    v_mfma_f32_16x16x32_bf16 v[76:79], a[88:91], v[52:55], v[76:79]
    v_mfma_f32_16x16x32_bf16 v[80:83], a[168:171], v[48:51], v[80:83]
    v_mfma_f32_16x16x32_bf16 v[84:87], a[168:171], v[52:55], v[84:87]
    v_mfma_f32_16x16x32_bf16 v[64:67], a[12:15], v[56:59], v[64:67]
    ds_read_b128 v[48:51], v17 offset:3072
    v_mfma_f32_16x16x32_bf16 v[68:71], a[12:15], v[60:63], v[68:71]
    ds_read_b128 v[52:55], v17 offset:23552
    v_mfma_f32_16x16x32_bf16 v[72:75], a[92:95], v[56:59], v[72:75]
    buffer_load_dwordx4 v31, s[8:11], s74 offen offset:0 lds
    s_add_u32 m0, m0, s93
    v_mfma_f32_16x16x32_bf16 v[76:79], a[92:95], v[60:63], v[76:79]
    v_mfma_f32_16x16x32_bf16 v[80:83], a[172:175], v[56:59], v[80:83]
    v_mfma_f32_16x16x32_bf16 v[84:87], a[172:175], v[60:63], v[84:87]
    v_mfma_f32_16x16x32_bf16 v[64:67], a[16:19], v[32:35], v[64:67]
    ds_read_b128 v[56:59], v19 offset:3072
    v_mfma_f32_16x16x32_bf16 v[68:71], a[16:19], v[36:39], v[68:71]
    ds_read_b128 v[60:63], v19 offset:23552
    v_mfma_f32_16x16x32_bf16 v[72:75], a[96:99], v[32:35], v[72:75]
    buffer_load_dwordx4 v16, s[8:11], s74 offen offset:256 lds
    s_add_u32 m0, m0, s92
    v_mfma_f32_16x16x32_bf16 v[76:79], a[96:99], v[36:39], v[76:79]
    v_mfma_f32_16x16x32_bf16 v[80:83], a[176:179], v[32:35], v[80:83]
    v_mfma_f32_16x16x32_bf16 v[84:87], a[176:179], v[36:39], v[84:87]
    s_waitcnt lgkmcnt(4)
    v_mfma_f32_16x16x32_bf16 v[64:67], a[20:23], v[40:43], v[64:67]
    ds_read_b128 v[32:35], v17 offset:4096
    v_mfma_f32_16x16x32_bf16 v[68:71], a[20:23], v[44:47], v[68:71]
    ds_read_b128 v[36:39], v17 offset:24576
    v_mfma_f32_16x16x32_bf16 v[72:75], a[100:103], v[40:43], v[72:75]
    buffer_load_dwordx4 v31, s[8:11], s74 offen offset:256 lds
    s_add_u32 m0, m0, s93
    v_mfma_f32_16x16x32_bf16 v[76:79], a[100:103], v[44:47], v[76:79]
    v_mfma_f32_16x16x32_bf16 v[80:83], a[180:183], v[40:43], v[80:83]
    v_mfma_f32_16x16x32_bf16 v[84:87], a[180:183], v[44:47], v[84:87]
    s_waitcnt lgkmcnt(4)
    v_mfma_f32_16x16x32_bf16 v[64:67], a[24:27], v[48:51], v[64:67]
    ds_read_b128 v[40:43], v19 offset:4096
    v_mfma_f32_16x16x32_bf16 v[68:71], a[24:27], v[52:55], v[68:71]
    ds_read_b128 v[44:47], v19 offset:24576
    v_mfma_f32_16x16x32_bf16 v[72:75], a[104:107], v[48:51], v[72:75]
    buffer_load_dwordx4 v16, s[8:11], s74 offen offset:512 lds
    s_add_u32 m0, m0, s92
    v_mfma_f32_16x16x32_bf16 v[76:79], a[104:107], v[52:55], v[76:79]
    v_mfma_f32_16x16x32_bf16 v[80:83], a[184:187], v[48:51], v[80:83]
    v_mfma_f32_16x16x32_bf16 v[84:87], a[184:187], v[52:55], v[84:87]
    s_waitcnt lgkmcnt(4)
    v_mfma_f32_16x16x32_bf16 v[64:67], a[28:31], v[56:59], v[64:67]
    ds_read_b128 v[48:51], v17 offset:5120
    v_mfma_f32_16x16x32_bf16 v[68:71], a[28:31], v[60:63], v[68:71]
    ds_read_b128 v[52:55], v17 offset:25600
    v_mfma_f32_16x16x32_bf16 v[72:75], a[108:111], v[56:59], v[72:75]
    buffer_load_dwordx4 v31, s[8:11], s74 offen offset:512 lds
    s_add_u32 m0, m0, s93
    v_mfma_f32_16x16x32_bf16 v[76:79], a[108:111], v[60:63], v[76:79]
    v_mfma_f32_16x16x32_bf16 v[80:83], a[188:191], v[56:59], v[80:83]
    v_mfma_f32_16x16x32_bf16 v[84:87], a[188:191], v[60:63], v[84:87]
    s_waitcnt lgkmcnt(4)
    v_mfma_f32_16x16x32_bf16 v[64:67], a[32:35], v[32:35], v[64:67]
    ds_read_b128 v[56:59], v19 offset:5120
    v_mfma_f32_16x16x32_bf16 v[68:71], a[32:35], v[36:39], v[68:71]
    ds_read_b128 v[60:63], v19 offset:25600
    v_mfma_f32_16x16x32_bf16 v[72:75], a[112:115], v[32:35], v[72:75]
    buffer_load_dwordx4 v16, s[8:11], s74 offen offset:768 lds
    s_add_u32 m0, m0, s92
    v_mfma_f32_16x16x32_bf16 v[76:79], a[112:115], v[36:39], v[76:79]
    v_mfma_f32_16x16x32_bf16 v[80:83], a[192:195], v[32:35], v[80:83]
    v_mfma_f32_16x16x32_bf16 v[84:87], a[192:195], v[36:39], v[84:87]
    s_waitcnt lgkmcnt(4)
    v_mfma_f32_16x16x32_bf16 v[64:67], a[36:39], v[40:43], v[64:67]
    ds_read_b128 v[32:35], v17 offset:6144
    v_mfma_f32_16x16x32_bf16 v[68:71], a[36:39], v[44:47], v[68:71]
    ds_read_b128 v[36:39], v17 offset:26624
    v_mfma_f32_16x16x32_bf16 v[72:75], a[116:119], v[40:43], v[72:75]
    buffer_load_dwordx4 v31, s[8:11], s74 offen offset:768 lds
    s_add_u32 m0, m0, s93
    v_mfma_f32_16x16x32_bf16 v[76:79], a[116:119], v[44:47], v[76:79]
    v_mfma_f32_16x16x32_bf16 v[80:83], a[196:199], v[40:43], v[80:83]
    v_mfma_f32_16x16x32_bf16 v[84:87], a[196:199], v[44:47], v[84:87]
    s_waitcnt lgkmcnt(4)
    v_mfma_f32_16x16x32_bf16 v[64:67], a[40:43], v[48:51], v[64:67]
    ds_read_b128 v[40:43], v19 offset:6144
    v_mfma_f32_16x16x32_bf16 v[68:71], a[40:43], v[52:55], v[68:71]
    ds_read_b128 v[44:47], v19 offset:26624
    v_mfma_f32_16x16x32_bf16 v[72:75], a[120:123], v[48:51], v[72:75]
    buffer_load_dwordx4 v16, s[8:11], s74 offen offset:1024 lds
    s_add_u32 m0, m0, s92
    v_mfma_f32_16x16x32_bf16 v[76:79], a[120:123], v[52:55], v[76:79]
    v_mfma_f32_16x16x32_bf16 v[80:83], a[200:203], v[48:51], v[80:83]
    v_mfma_f32_16x16x32_bf16 v[84:87], a[200:203], v[52:55], v[84:87]
    s_waitcnt lgkmcnt(4)
    v_mfma_f32_16x16x32_bf16 v[64:67], a[44:47], v[56:59], v[64:67]
    ds_read_b128 v[48:51], v17 offset:7168
    v_mfma_f32_16x16x32_bf16 v[68:71], a[44:47], v[60:63], v[68:71]
    ds_read_b128 v[52:55], v17 offset:27648
    v_mfma_f32_16x16x32_bf16 v[72:75], a[124:127], v[56:59], v[72:75]
    buffer_load_dwordx4 v31, s[8:11], s74 offen offset:1024 lds
    v_mfma_f32_16x16x32_bf16 v[76:79], a[124:127], v[60:63], v[76:79]
    v_mfma_f32_16x16x32_bf16 v[80:83], a[204:207], v[56:59], v[80:83]
    v_mfma_f32_16x16x32_bf16 v[84:87], a[204:207], v[60:63], v[84:87]
    s_waitcnt vmcnt(10)
    s_branch L_k_join
L_k_top:
    s_add_u32 s74, s74, 40960
    s_add_u32 m0, s88, s75
    s_add_u32 s88, s88, 40960
    s_cmp_eq_u32 s88, 122880
    s_cselect_b32 s88, 0, s88
    v_mfma_f32_16x16x32_bf16 v[64:67], a[8:11], v[48:51], v[64:67]
    ds_read_b128 v[40:43], v19 offset:2048
    v_mfma_f32_16x16x32_bf16 v[68:71], a[8:11], v[52:55], v[68:71]
    ds_read_b128 v[44:47], v19 offset:22528
    v_mfma_f32_16x16x32_bf16 v[72:75], a[88:91], v[48:51], v[72:75]
    buffer_load_dwordx4 v16, s[8:11], s74 offen offset:0 lds
    s_add_u32 m0, m0, s92
    v_mfma_f32_16x16x32_bf16 v[76:79], a[88:91], v[52:55], v[76:79]
    v_mfma_f32_16x16x32_bf16 v[80:83], a[168:171], v[48:51], v[80:83]
    v_mfma_f32_16x16x32_bf16 v[84:87], a[168:171], v[52:55], v[84:87]
    v_mfma_f32_16x16x32_bf16 v[64:67], a[12:15], v[56:59], v[64:67]
    ds_read_b128 v[48:51], v17 offset:3072
    v_mfma_f32_16x16x32_bf16 v[68:71], a[12:15], v[60:63], v[68:71]
    ds_read_b128 v[52:55], v17 offset:23552
    v_mfma_f32_16x16x32_bf16 v[72:75], a[92:95], v[56:59], v[72:75]
    buffer_load_dwordx4 v31, s[8:11], s74 offen offset:0 lds
    s_add_u32 m0, m0, s93
    v_mfma_f32_16x16x32_bf16 v[76:79], a[92:95], v[60:63], v[76:79]
    v_mfma_f32_16x16x32_bf16 v[80:83], a[172:175], v[56:59], v[80:83]
    v_mfma_f32_16x16x32_bf16 v[84:87], a[172:175], v[60:63], v[84:87]
    v_mfma_f32_16x16x32_bf16 v[64:67], a[16:19], v[32:35], v[64:67]
    ds_read_b128 v[56:59], v19 offset:3072
    v_mfma_f32_16x16x32_bf16 v[68:71], a[16:19], v[36:39], v[68:71]
    ds_read_b128 v[60:63], v19 offset:23552
    v_mfma_f32_16x16x32_bf16 v[72:75], a[96:99], v[32:35], v[72:75]
    buffer_load_dwordx4 v16, s[8:11], s74 offen offset:256 lds
    s_add_u32 m0, m0, s92
    v_mfma_f32_16x16x32_bf16 v[76:79], a[96:99], v[36:39], v[76:79]
    v_mfma_f32_16x16x32_bf16 v[80:83], a[176:179], v[32:35], v[80:83]
    v_mfma_f32_16x16x32_bf16 v[84:87], a[176:179], v[36:39], v[84:87]
    s_waitcnt lgkmcnt(4)
    v_mfma_f32_16x16x32_bf16 v[64:67], a[20:23], v[40:43], v[64:67]
    ds_read_b128 v[32:35], v17 offset:4096
    v_mfma_f32_16x16x32_bf16 v[68:71], a[20:23], v[44:47], v[68:71]
    ds_read_b128 v[36:39], v17 offset:24576
    v_mfma_f32_16x16x32_bf16 v[72:75], a[100:103], v[40:43], v[72:75]
    buffer_load_dwordx4 v31, s[8:11], s74 offen offset:256 lds
    s_add_u32 m0, m0, s93
    v_mfma_f32_16x16x32_bf16 v[76:79], a[100:103], v[44:47], v[76:79]
    v_mfma_f32_16x16x32_bf16 v[80:83], a[180:183], v[40:43], v[80:83]
    v_mfma_f32_16x16x32_bf16 v[84:87], a[180:183], v[44:47], v[84:87]
    s_waitcnt lgkmcnt(4)
    v_mfma_f32_16x16x32_bf16 v[64:67], a[24:27], v[48:51], v[64:67]
    ds_read_b128 v[40:43], v19 offset:4096
    v_mfma_f32_16x16x32_bf16 v[68:71], a[24:27], v[52:55], v[68:71]
    ds_read_b128 v[44:47], v19 offset:24576
    v_mfma_f32_16x16x32_bf16 v[72:75], a[104:107], v[48:51], v[72:75]
    buffer_load_dwordx4 v16, s[8:11], s74 offen offset:512 lds
    s_add_u32 m0, m0, s92
    v_mfma_f32_16x16x32_bf16 v[76:79], a[104:107], v[52:55], v[76:79]
    v_mfma_f32_16x16x32_bf16 v[80:83], a[184:187], v[48:51], v[80:83]
    v_mfma_f32_16x16x32_bf16 v[84:87], a[184:187], v[52:55], v[84:87]
    s_waitcnt lgkmcnt(4)
    v_mfma_f32_16x16x32_bf16 v[64:67], a[28:31], v[56:59], v[64:67]
    ds_read_b128 v[48:51], v17 offset:5120
    v_mfma_f32_16x16x32_bf16 v[68:71], a[28:31], v[60:63], v[68:71]
    ds_read_b128 v[52:55], v17 offset:25600
    v_mfma_f32_16x16x32_bf16 v[72:75], a[108:111], v[56:59], v[72:75]
    buffer_load_dwordx4 v31, s[8:11], s74 offen offset:512 lds
    s_add_u32 m0, m0, s93
    v_mfma_f32_16x16x32_bf16 v[76:79], a[108:111], v[60:63], v[76:79]
    v_mfma_f32_16x16x32_bf16 v[80:83], a[188:191], v[56:59], v[80:83]
    v_mfma_f32_16x16x32_bf16 v[84:87], a[188:191], v[60:63], v[84:87]
    s_waitcnt lgkmcnt(4)
    v_mfma_f32_16x16x32_bf16 v[64:67], a[32:35], v[32:35], v[64:67]
    ds_read_b128 v[56:59], v19 offset:5120
    v_mfma_f32_16x16x32_bf16 v[68:71], a[32:35], v[36:39], v[68:71]
    ds_read_b128 v[60:63], v19 offset:25600
    v_mfma_f32_16x16x32_bf16 v[72:75], a[112:115], v[32:35], v[72:75]
    buffer_load_dwordx4 v16, s[8:11], s74 offen offset:768 lds
    s_add_u32 m0, m0, s92
    v_mfma_f32_16x16x32_bf16 v[76:79], a[112:115], v[36:39], v[76:79]
    v_mfma_f32_16x16x32_bf16 v[80:83], a[192:195], v[32:35], v[80:83]
    v_mfma_f32_16x16x32_bf16 v[84:87], a[192:195], v[36:39], v[84:87]
    s_waitcnt lgkmcnt(4)
    v_mfma_f32_16x16x32_bf16 v[64:67], a[36:39], v[40:43], v[64:67]
    ds_read_b128 v[32:35], v17 offset:6144
    v_mfma_f32_16x16x32_bf16 v[68:71], a[36:39], v[44:47], v[68:71]
    ds_read_b128 v[36:39], v17 offset:26624
    v_mfma_f32_16x16x32_bf16 v[72:75], a[116:119], v[40:43], v[72:75]
    buffer_load_dwordx4 v31, s[8:11], s74 offen offset:768 lds
    s_add_u32 m0, m0, s93
    v_mfma_f32_16x16x32_bf16 v[76:79], a[116:119], v[44:47], v[76:79]
    v_mfma_f32_16x16x32_bf16 v[80:83], a[196:199], v[40:43], v[80:83]
    v_mfma_f32_16x16x32_bf16 v[84:87], a[196:199], v[44:47], v[84:87]
    s_waitcnt lgkmcnt(4)
    v_mfma_f32_16x16x32_bf16 v[64:67], a[40:43], v[48:51], v[64:67]
    ds_read_b128 v[40:43], v19 offset:6144
    v_mfma_f32_16x16x32_bf16 v[68:71], a[40:43], v[52:55], v[68:71]
    ds_read_b128 v[44:47], v19 offset:26624
    v_mfma_f32_16x16x32_bf16 v[72:75], a[120:123], v[48:51], v[72:75]
    buffer_load_dwordx4 v16, s[8:11], s74 offen offset:1024 lds
    s_add_u32 m0, m0, s92
    v_mfma_f32_16x16x32_bf16 v[76:79], a[120:123], v[52:55], v[76:79]
    v_mfma_f32_16x16x32_bf16 v[80:83], a[200:203], v[48:51], v[80:83]
    v_mfma_f32_16x16x32_bf16 v[84:87], a[200:203], v[52:55], v[84:87]
    s_waitcnt lgkmcnt(4)
    v_mfma_f32_16x16x32_bf16 v[64:67], a[44:47], v[56:59], v[64:67]
    ds_read_b128 v[48:51], v17 offset:7168
    v_mfma_f32_16x16x32_bf16 v[68:71], a[44:47], v[60:63], v[68:71]
    ds_read_b128 v[52:55], v17 offset:27648
    v_mfma_f32_16x16x32_bf16 v[72:75], a[124:127], v[56:59], v[72:75]
    buffer_load_dwordx4 v31, s[8:11], s74 offen offset:1024 lds
    v_mfma_f32_16x16x32_bf16 v[76:79], a[124:127], v[60:63], v[76:79]
    v_mfma_f32_16x16x32_bf16 v[80:83], a[204:207], v[56:59], v[80:83]
    v_mfma_f32_16x16x32_bf16 v[84:87], a[204:207], v[60:63], v[84:87]
L_k_join:
    s_waitcnt lgkmcnt(4)
    v_mfma_f32_16x16x32_bf16 v[64:67], a[48:51], v[32:35], v[64:67]
    ds_read_b128 v[56:59], v19 offset:7168
    v_mfma_f32_16x16x32_bf16 v[68:71], a[48:51], v[36:39], v[68:71]
    ds_read_b128 v[60:63], v19 offset:27648
    v_mfma_f32_16x16x32_bf16 v[72:75], a[128:131], v[32:35], v[72:75]
    v_mfma_f32_16x16x32_bf16 v[76:79], a[128:131], v[36:39], v[76:79]
    v_mfma_f32_16x16x32_bf16 v[80:83], a[208:211], v[32:35], v[80:83]
    v_mfma_f32_16x16x32_bf16 v[84:87], a[208:211], v[36:39], v[84:87]
    s_waitcnt lgkmcnt(4)
    v_mfma_f32_16x16x32_bf16 v[64:67], a[52:55], v[40:43], v[64:67]
    ds_read_b128 v[32:35], v17 offset:8192
    v_mfma_f32_16x16x32_bf16 v[68:71], a[52:55], v[44:47], v[68:71]
    ds_read_b128 v[36:39], v17 offset:28672
    v_mfma_f32_16x16x32_bf16 v[72:75], a[132:135], v[40:43], v[72:75]
    v_mfma_f32_16x16x32_bf16 v[76:79], a[132:135], v[44:47], v[76:79]
    v_mfma_f32_16x16x32_bf16 v[80:83], a[212:215], v[40:43], v[80:83]
    v_mfma_f32_16x16x32_bf16 v[84:87], a[212:215], v[44:47], v[84:87]
    s_waitcnt lgkmcnt(4)
    v_mfma_f32_16x16x32_bf16 v[64:67], a[56:59], v[48:51], v[64:67]
    ds_read_b128 v[40:43], v19 offset:8192
    v_mfma_f32_16x16x32_bf16 v[68:71], a[56:59], v[52:55], v[68:71]
    ds_read_b128 v[44:47], v19 offset:28672
    v_mfma_f32_16x16x32_bf16 v[72:75], a[136:139], v[48:51], v[72:75]
    v_mfma_f32_16x16x32_bf16 v[76:79], a[136:139], v[52:55], v[76:79]
    v_mfma_f32_16x16x32_bf16 v[80:83], a[216:219], v[48:51], v[80:83]
    v_mfma_f32_16x16x32_bf16 v[84:87], a[216:219], v[52:55], v[84:87]
    s_waitcnt lgkmcnt(4)
    v_mfma_f32_16x16x32_bf16 v[64:67], a[60:63], v[56:59], v[64:67]
    ds_read_b128 v[48:51], v17 offset:9216
    v_mfma_f32_16x16x32_bf16 v[68:71], a[60:63], v[60:63], v[68:71]
    ds_read_b128 v[52:55], v17 offset:29696
    v_mfma_f32_16x16x32_bf16 v[72:75], a[140:143], v[56:59], v[72:75]
    v_mfma_f32_16x16x32_bf16 v[76:79], a[140:143], v[60:63], v[76:79]
    v_mfma_f32_16x16x32_bf16 v[80:83], a[220:223], v[56:59], v[80:83]
    v_mfma_f32_16x16x32_bf16 v[84:87], a[220:223], v[60:63], v[84:87]
    s_waitcnt lgkmcnt(4)
    v_mfma_f32_16x16x32_bf16 v[64:67], a[64:67], v[32:35], v[64:67]
    ds_read_b128 v[56:59], v19 offset:9216
    v_mfma_f32_16x16x32_bf16 v[68:71], a[64:67], v[36:39], v[68:71]
    ds_read_b128 v[60:63], v19 offset:29696
    v_mfma_f32_16x16x32_bf16 v[72:75], a[144:147], v[32:35], v[72:75]
    v_mfma_f32_16x16x32_bf16 v[76:79], a[144:147], v[36:39], v[76:79]
    v_mfma_f32_16x16x32_bf16 v[80:83], a[224:227], v[32:35], v[80:83]
    v_mfma_f32_16x16x32_bf16 v[84:87], a[224:227], v[36:39], v[84:87]
    s_waitcnt vmcnt(17) lgkmcnt(0)
    s_barrier
    s_add_u32 s87, s87, 1
    s_cmp_eq_u32 s87, 3
    s_cselect_b32 s87, 0, s87
    s_cselect_b32 s28, -2, 1
    s_mul_i32 s28, s28, 40960
    v_add_u32 v17, s28, v17
    v_add_u32 v19, s28, v19
    s_sub_u32 s29, s26, 1
    s_cmp_lt_u32 s26, 3
    s_cselect_b32 s29, s26, s29
    v_mfma_f32_16x16x32_bf16 v[64:67], a[68:71], v[40:43], v[64:67]
    v_mov_b32 v6, s29
    s_mov_b64 exec, 1
    buffer_store_dword v6, v5, s[4:7], s89 offen sc1
    s_mov_b64 exec, -1
    v_mfma_f32_16x16x32_bf16 v[68:71], a[68:71], v[44:47], v[68:71]
    v_mfma_f32_16x16x32_bf16 v[72:75], a[148:151], v[40:43], v[72:75]
    v_mfma_f32_16x16x32_bf16 v[64:67], a[72:75], v[48:51], v[64:67]
    v_mfma_f32_16x16x32_bf16 v[68:71], a[72:75], v[52:55], v[68:71]
    v_mfma_f32_16x16x32_bf16 v[72:75], a[152:155], v[48:51], v[72:75]
    v_mfma_f32_16x16x32_bf16 v[64:67], a[76:79], v[56:59], v[64:67]
    v_mfma_f32_16x16x32_bf16 v[68:71], a[76:79], v[60:63], v[68:71]
    v_mfma_f32_16x16x32_bf16 v[72:75], a[156:159], v[56:59], v[72:75]
    v_mfma_f32_16x16x32_bf16 v[76:79], a[148:151], v[44:47], v[76:79]
    ds_read_b128 v[32:35], v17 offset:0
    v_mfma_f32_16x16x32_bf16 v[80:83], a[228:231], v[40:43], v[80:83]
    ds_read_b128 v[36:39], v17 offset:20480
    v_mfma_f32_16x16x32_bf16 v[84:87], a[228:231], v[44:47], v[84:87]
    v_cvt_pk_bf16_f32 v88, v64, v65
    v_cvt_pk_bf16_f32 v89, v66, v67
    v_mfma_f32_16x16x32_bf16 v[76:79], a[152:155], v[52:55], v[76:79]
    buffer_store_dwordx2 v[88:89], v18, s[4:7], s77 offen offset:0 sc1
    v_mfma_f32_16x16x32_bf16 v[80:83], a[232:235], v[48:51], v[80:83]
    v_cvt_pk_bf16_f32 v90, v68, v69
    v_cvt_pk_bf16_f32 v91, v70, v71
    v_mfma_f32_16x16x32_bf16 v[84:87], a[232:235], v[52:55], v[84:87]
    buffer_store_dwordx2 v[90:91], v18, s[4:7], s79 offen offset:0 sc1
    v_mfma_f32_16x16x32_bf16 v[76:79], a[156:159], v[60:63], v[76:79]
    v_cvt_pk_bf16_f32 v92, v72, v73
    v_cvt_pk_bf16_f32 v93, v74, v75
    v_mfma_f32_16x16x32_bf16 v[80:83], a[236:239], v[56:59], v[80:83]
    buffer_store_dwordx2 v[92:93], v18, s[4:7], s77 offen offset:512 sc1
    v_mfma_f32_16x16x32_bf16 v[84:87], a[236:239], v[60:63], v[84:87]
    ds_read_b128 v[40:43], v19 offset:0
    ds_read_b128 v[44:47], v19 offset:20480
    ds_read_b128 v[48:51], v17 offset:1024
    ds_read_b128 v[52:55], v17 offset:21504
    s_waitcnt lgkmcnt(4)
    v_mfma_f32_16x16x32_bf16 v[64:67], a[0:3], v[32:35], 0
    ds_read_b128 v[56:59], v19 offset:1024
    v_mfma_f32_16x16x32_bf16 v[68:71], a[0:3], v[36:39], 0
    ds_read_b128 v[60:63], v19 offset:21504
    v_mfma_f32_16x16x32_bf16 v[72:75], a[80:83], v[32:35], 0
    v_cvt_pk_bf16_f32 v94, v76, v77
    v_cvt_pk_bf16_f32 v95, v78, v79
    buffer_store_dwordx2 v[94:95], v18, s[4:7], s79 offen offset:512 sc1
    v_mfma_f32_16x16x32_bf16 v[76:79], a[80:83], v[36:39], 0
    v_cvt_pk_bf16_f32 v96, v80, v81
    v_cvt_pk_bf16_f32 v97, v82, v83
    buffer_store_dwordx2 v[96:97], v18, s[4:7], s77 offen offset:1024 sc1
    s_add_u32 s77, s77, 12288
    v_mfma_f32_16x16x32_bf16 v[80:83], a[160:163], v[32:35], 0
    v_cvt_pk_bf16_f32 v98, v84, v85
    v_cvt_pk_bf16_f32 v99, v86, v87
    buffer_store_dwordx2 v[98:99], v18, s[4:7], s79 offen offset:1024 sc1
    s_add_u32 s79, s79, 12288
    v_mfma_f32_16x16x32_bf16 v[84:87], a[160:163], v[36:39], 0
    s_waitcnt lgkmcnt(4)
    v_mfma_f32_16x16x32_bf16 v[64:67], a[4:7], v[40:43], v[64:67]
    ds_read_b128 v[32:35], v17 offset:2048
    v_mfma_f32_16x16x32_bf16 v[68:71], a[4:7], v[44:47], v[68:71]
    ds_read_b128 v[36:39], v17 offset:22528
    v_mfma_f32_16x16x32_bf16 v[72:75], a[84:87], v[40:43], v[72:75]
    v_mfma_f32_16x16x32_bf16 v[76:79], a[84:87], v[44:47], v[76:79]
    v_mfma_f32_16x16x32_bf16 v[80:83], a[164:167], v[40:43], v[80:83]
    v_mfma_f32_16x16x32_bf16 v[84:87], a[164:167], v[44:47], v[84:87]
    s_waitcnt lgkmcnt(0)
    s_add_u32 s26, s26, 1
    s_sub_u32 s28, s26, 3
    s_cmp_lt_u32 s28, 61
    s_cbranch_scc1 L_k_top
    s_branch L_k_now
L_k_end:
    s_cmp_lg_u32 s72, 7
    s_cbranch_scc1 L_k_j
    s_cmp_ge_u32 s25, 10
    s_cbranch_scc1 L_exit
    s_branch L_join
L_k_j:
    s_and_b32 s28, s25, 3
    s_add_u32 s28, s28, 6
    s_lshr_b32 s29, s25, 1
    s_mul_i32 s30, s29, 43
    s_lshr_b32 s30, s30, 8
    s_mul_i32 s30, s30, 6
    s_sub_u32 s29, s29, s30
    s_lshr_b32 s28, s25, 1
    s_and_b32 s28, s28, 3
    s_add_u32 s28, s28, 6
    s_bitcmp1_b32 s25, 0
    s_cselect_b32 s25, s28, s29
    s_branch L_join
L_q:
    v_lshlrev_b32 v6, 4, v0
    s_mul_i32 s28, s25, 81920
    buffer_load_dwordx4 v[216:219], v6, s[8:11], s28 offen
    s_add_u32 s28, s28, 4096
    buffer_load_dwordx4 v[216:219], v6, s[8:11], s28 offen
    s_add_u32 s28, s28, 4096
    buffer_load_dwordx4 v[216:219], v6, s[8:11], s28 offen
    s_add_u32 s28, s28, 4096
    buffer_load_dwordx4 v[216:219], v6, s[8:11], s28 offen
    s_add_u32 s28, s28, 4096
    buffer_load_dwordx4 v[216:219], v6, s[8:11], s28 offen
    s_add_u32 s28, s28, 4096
    buffer_load_dwordx4 v[216:219], v6, s[8:11], s28 offen
    s_add_u32 s28, s28, 4096
    buffer_load_dwordx4 v[216:219], v6, s[8:11], s28 offen
    s_add_u32 s28, s28, 4096
    buffer_load_dwordx4 v[216:219], v6, s[8:11], s28 offen
    s_add_u32 s28, s28, 4096
    buffer_load_dwordx4 v[216:219], v6, s[8:11], s28 offen
    s_add_u32 s28, s28, 4096
    buffer_load_dwordx4 v[216:219], v6, s[8:11], s28 offen
    s_add_u32 s28, s28, 4096
    buffer_load_dwordx4 v[216:219], v6, s[8:11], s28 offen
    s_add_u32 s28, s28, 4096
    buffer_load_dwordx4 v[216:219], v6, s[8:11], s28 offen
    s_add_u32 s28, s28, 4096
    buffer_load_dwordx4 v[216:219], v6, s[8:11], s28 offen
    s_add_u32 s28, s28, 4096
    buffer_load_dwordx4 v[216:219], v6, s[8:11], s28 offen
    s_add_u32 s28, s28, 4096
    buffer_load_dwordx4 v[216:219], v6, s[8:11], s28 offen
    s_add_u32 s28, s28, 4096
    buffer_load_dwordx4 v[216:219], v6, s[8:11], s28 offen
    s_add_u32 s28, s28, 4096
    buffer_load_dwordx4 v[216:219], v6, s[8:11], s28 offen
    s_add_u32 s28, s28, 4096
    buffer_load_dwordx4 v[216:219], v6, s[8:11], s28 offen
    s_add_u32 s28, s28, 4096
    buffer_load_dwordx4 v[216:219], v6, s[8:11], s28 offen
    s_add_u32 s28, s28, 4096
    buffer_load_dwordx4 v[216:219], v6, s[8:11], s28 offen
    s_add_u32 s28, s28, 4096
    s_sub_u32 s28, s25, 10
    s_cmp_ge_u32 s28, 20
    s_cbranch_scc1 Lf_94
    s_waitcnt vmcnt(10)
    s_mov_b32 s12, s56
    s_mov_b32 s13, s57
    s_mov_b32 s14, 0xc8000
    s_mov_b32 s15, 0x20000
    s_mov_b32 s84, s58
    s_mov_b32 s85, s59
    s_mov_b32 s86, 0xc8000
    s_mov_b32 s87, 0x20000
    s_lshl_b32 s28, s28, 2
    s_add_u32 s28, s28, s24
    s_mul_i32 s30, s28, 20480
    s_add_u32 s30, s30, 0xbe00000
    s_lshr_b32 s29, s28, 1
    s_mul_i32 s29, s29, 20480
    s_and_b32 s28, s28, 1
    s_mul_i32 s28, s28, 640
    s_add_u32 s29, s29, s28
    v_mul_u32_u24 v7, 1280, v2
    v_lshl_add_u32 v7, v3, 3, v7
    buffer_load_dwordx2 v[32:33], v7, s[12:15], s29 offen offset:0
    buffer_load_dwordx2 v[34:35], v7, s[84:87], s29 offen offset:0
    buffer_load_dwordx2 v[36:37], v7, s[12:15], s29 offen offset:32
    buffer_load_dwordx2 v[38:39], v7, s[84:87], s29 offen offset:32
    buffer_load_dwordx2 v[40:41], v7, s[12:15], s29 offen offset:64
    buffer_load_dwordx2 v[42:43], v7, s[84:87], s29 offen offset:64
    buffer_load_dwordx2 v[44:45], v7, s[12:15], s29 offen offset:96
    buffer_load_dwordx2 v[46:47], v7, s[84:87], s29 offen offset:96
    buffer_load_dwordx2 v[48:49], v7, s[12:15], s29 offen offset:128
    buffer_load_dwordx2 v[50:51], v7, s[84:87], s29 offen offset:128
    buffer_load_dwordx2 v[52:53], v7, s[12:15], s29 offen offset:160
    buffer_load_dwordx2 v[54:55], v7, s[84:87], s29 offen offset:160
    buffer_load_dwordx2 v[56:57], v7, s[12:15], s29 offen offset:192
    buffer_load_dwordx2 v[58:59], v7, s[84:87], s29 offen offset:192
    buffer_load_dwordx2 v[60:61], v7, s[12:15], s29 offen offset:224
    buffer_load_dwordx2 v[62:63], v7, s[84:87], s29 offen offset:224
    buffer_load_dwordx2 v[64:65], v7, s[12:15], s29 offen offset:256
    buffer_load_dwordx2 v[66:67], v7, s[84:87], s29 offen offset:256
    buffer_load_dwordx2 v[68:69], v7, s[12:15], s29 offen offset:288
    buffer_load_dwordx2 v[70:71], v7, s[84:87], s29 offen offset:288
    buffer_load_dwordx2 v[72:73], v7, s[12:15], s29 offen offset:320
    buffer_load_dwordx2 v[74:75], v7, s[84:87], s29 offen offset:320
    buffer_load_dwordx2 v[76:77], v7, s[12:15], s29 offen offset:352
    buffer_load_dwordx2 v[78:79], v7, s[84:87], s29 offen offset:352
    buffer_load_dwordx2 v[80:81], v7, s[12:15], s29 offen offset:384
    buffer_load_dwordx2 v[82:83], v7, s[84:87], s29 offen offset:384
    buffer_load_dwordx2 v[84:85], v7, s[12:15], s29 offen offset:416
    buffer_load_dwordx2 v[86:87], v7, s[84:87], s29 offen offset:416
    buffer_load_dwordx2 v[88:89], v7, s[12:15], s29 offen offset:448
    buffer_load_dwordx2 v[90:91], v7, s[84:87], s29 offen offset:448
    buffer_load_dwordx2 v[92:93], v7, s[12:15], s29 offen offset:480
    buffer_load_dwordx2 v[94:95], v7, s[84:87], s29 offen offset:480
    buffer_load_dwordx2 v[96:97], v7, s[12:15], s29 offen offset:512
    buffer_load_dwordx2 v[98:99], v7, s[84:87], s29 offen offset:512
    buffer_load_dwordx2 v[100:101], v7, s[12:15], s29 offen offset:544
    buffer_load_dwordx2 v[102:103], v7, s[84:87], s29 offen offset:544
    buffer_load_dwordx2 v[104:105], v7, s[12:15], s29 offen offset:576
    buffer_load_dwordx2 v[106:107], v7, s[84:87], s29 offen offset:576
    buffer_load_dwordx2 v[108:109], v7, s[12:15], s29 offen offset:608
    buffer_load_dwordx2 v[110:111], v7, s[84:87], s29 offen offset:608
    s_waitcnt vmcnt(0)
    buffer_store_dwordx4 v[32:35], v4, s[4:7], s30 offen offset:0 sc1
    buffer_store_dwordx4 v[36:39], v4, s[4:7], s30 offen offset:1024 sc1
    buffer_store_dwordx4 v[40:43], v4, s[4:7], s30 offen offset:2048 sc1
    buffer_store_dwordx4 v[44:47], v4, s[4:7], s30 offen offset:3072 sc1
    s_add_u32 s30, s30, 4096
    buffer_store_dwordx4 v[48:51], v4, s[4:7], s30 offen offset:0 sc1
    buffer_store_dwordx4 v[52:55], v4, s[4:7], s30 offen offset:1024 sc1
    buffer_store_dwordx4 v[56:59], v4, s[4:7], s30 offen offset:2048 sc1
    buffer_store_dwordx4 v[60:63], v4, s[4:7], s30 offen offset:3072 sc1
    s_add_u32 s30, s30, 4096
    buffer_store_dwordx4 v[64:67], v4, s[4:7], s30 offen offset:0 sc1
    buffer_store_dwordx4 v[68:71], v4, s[4:7], s30 offen offset:1024 sc1
    buffer_store_dwordx4 v[72:75], v4, s[4:7], s30 offen offset:2048 sc1
    buffer_store_dwordx4 v[76:79], v4, s[4:7], s30 offen offset:3072 sc1
    s_add_u32 s30, s30, 4096
    buffer_store_dwordx4 v[80:83], v4, s[4:7], s30 offen offset:0 sc1
    buffer_store_dwordx4 v[84:87], v4, s[4:7], s30 offen offset:1024 sc1
    buffer_store_dwordx4 v[88:91], v4, s[4:7], s30 offen offset:2048 sc1
    buffer_store_dwordx4 v[92:95], v4, s[4:7], s30 offen offset:3072 sc1
    s_add_u32 s30, s30, 4096
    buffer_store_dwordx4 v[96:99], v4, s[4:7], s30 offen offset:0 sc1
    buffer_store_dwordx4 v[100:103], v4, s[4:7], s30 offen offset:1024 sc1
    buffer_store_dwordx4 v[104:107], v4, s[4:7], s30 offen offset:2048 sc1
    buffer_store_dwordx4 v[108:111], v4, s[4:7], s30 offen offset:3072 sc1
    s_add_u32 s30, s30, 4096
    s_waitcnt vmcnt(0)
    s_barrier
    s_cmp_lg_u32 s24, 0
    s_cbranch_scc1 Lf_94
    v_mov_b32 v5, 0
    v_mov_b32 v6, 1
    s_mov_b64 exec, 1
    buffer_atomic_add v6, v5, s[20:23], 0 offen offset:12 sc0 sc1
    s_waitcnt vmcnt(0)
    v_cmp_eq_u32 vcc, 19, v6
    s_cbranch_vccz Lar_95
    buffer_store_dword v6, v5, s[20:23], 0 offen offset:140 sc1
Lar_95:
    s_mov_b64 exec, -1
Lf_94:
    s_waitcnt vmcnt(0)
    s_mul_i32 s74, s24, 10240
    s_mov_b32 s75, s74
    s_and_b32 s28, s24, 1
    s_lshl_b32 s28, s28, 2
    v_add_u32 v17, s28, v3
    v_and_b32 v19, 7, v1
    v_xor_b32 v17, v17, v19
    v_lshrrev_b32 v19, 3, v1
    v_mul_u32_u24 v16, 1280, v19
    v_lshl_add_u32 v16, v17, 4, v16
    s_and_b32 s28, s24, 1
    s_lshl_b32 s29, s28, 7
    v_add_u32 v31, 128, v16
    v_subrev_u32 v31, s29, v31
    v_add_u32 v16, s29, v16
    s_lshl_b32 s29, s28, 10
    s_add_u32 s75, s75, s29
    s_lshl_b32 s29, s28, 11
    s_sub_u32 s92, 1024, s29
    s_add_u32 s93, s29, 768
    v_lshrrev_b32 v19, 1, v2
    v_xor_b32 v19, v19, v3
    v_lshlrev_b32 v17, 4, v19
    v_and_b32 v19, 7, v2
    v_lshl_add_u32 v17, v19, 7, v17
    v_lshrrev_b32 v19, 3, v2
    v_mul_u32_u24 v19, 10240, v19
    v_add_u32 v17, v17, v19
    v_xor_b32 v19, 64, v17
    s_mov_b32 m0, s75
    s_nop 0
    buffer_load_dwordx4 v16, s[8:11], s74 offen offset:0 lds
    s_add_u32 m0, m0, s92
    s_nop 0
    buffer_load_dwordx4 v31, s[8:11], s74 offen offset:0 lds
    s_add_u32 m0, m0, s93
    s_nop 0
    buffer_load_dwordx4 v16, s[8:11], s74 offen offset:256 lds
    s_add_u32 m0, m0, s92
    s_nop 0
    buffer_load_dwordx4 v31, s[8:11], s74 offen offset:256 lds
    s_add_u32 m0, m0, s93
    s_nop 0
    buffer_load_dwordx4 v16, s[8:11], s74 offen offset:512 lds
    s_add_u32 m0, m0, s92
    s_nop 0
    buffer_load_dwordx4 v31, s[8:11], s74 offen offset:512 lds
    s_add_u32 m0, m0, s93
    s_nop 0
    buffer_load_dwordx4 v16, s[8:11], s74 offen offset:768 lds
    s_add_u32 m0, m0, s92
    s_nop 0
    buffer_load_dwordx4 v31, s[8:11], s74 offen offset:768 lds
    s_add_u32 m0, m0, s93
    s_nop 0
    buffer_load_dwordx4 v16, s[8:11], s74 offen offset:1024 lds
    s_add_u32 m0, m0, s92
    s_nop 0
    buffer_load_dwordx4 v31, s[8:11], s74 offen offset:1024 lds
    s_mov_b32 s12, s36
    s_mov_b32 s13, s37
    s_mov_b32 s14, 0x780000
    s_mov_b32 s15, 0x20000
    s_and_b32 s28, s24, 1
    s_lshl_b32 s28, s28, 2
    v_and_b32 v5, 1, v3
    v_lshlrev_b32 v5, 1, v5
    v_add_u32 v5, s28, v5
    v_and_b32 v6, 7, v1
    v_xor_b32 v5, v5, v6
    v_lshrrev_b32 v6, 3, v1
    v_mul_u32_u24 v6, 12288, v6
    v_lshl_add_u32 v32, v5, 4, v6
    s_mul_i32 s90, s24, 98304
    s_mul_i32 s28, s25, 384
    s_add_u32 s90, s90, s28
    s_mul_i32 s95, s24, 3072
    s_add_u32 s29, s90, 0
    s_add_u32 m0, s95, 40960
    s_nop 0
    buffer_load_dwordx4 v32, s[12:15], s29 offen offset:0 nt lds
    s_add_u32 m0, s95, 41856
    s_nop 0
    buffer_load_dwordx4 v32, s[12:15], s29 offen offset:128 nt lds
    s_add_u32 m0, s95, 42752
    s_nop 0
    buffer_load_dwordx4 v32, s[12:15], s29 offen offset:256 nt lds
    s_add_u32 s29, s90, 393216
    s_add_u32 m0, s95, 53248
    s_nop 0
    buffer_load_dwordx4 v32, s[12:15], s29 offen offset:0 nt lds
    s_add_u32 m0, s95, 54144
    s_nop 0
    buffer_load_dwordx4 v32, s[12:15], s29 offen offset:128 nt lds
    s_add_u32 m0, s95, 55040
    s_nop 0
    buffer_load_dwordx4 v32, s[12:15], s29 offen offset:256 nt lds
    s_add_u32 s29, s90, 786432
    s_add_u32 m0, s95, 65536
    s_nop 0
    buffer_load_dwordx4 v32, s[12:15], s29 offen offset:0 nt lds
    s_add_u32 m0, s95, 66432
    s_nop 0
    buffer_load_dwordx4 v32, s[12:15], s29 offen offset:128 nt lds
    s_add_u32 m0, s95, 67328
    s_nop 0
    buffer_load_dwordx4 v32, s[12:15], s29 offen offset:256 nt lds
    s_add_u32 s29, s90, 1179648
    s_add_u32 m0, s95, 77824
    s_nop 0
    buffer_load_dwordx4 v32, s[12:15], s29 offen offset:0 nt lds
    s_add_u32 m0, s95, 78720
    s_nop 0
    buffer_load_dwordx4 v32, s[12:15], s29 offen offset:128 nt lds
    s_add_u32 m0, s95, 79616
    s_nop 0
    buffer_load_dwordx4 v32, s[12:15], s29 offen offset:256 nt lds
    s_add_u32 s29, s90, 1572864
    s_add_u32 m0, s95, 90112
    s_nop 0
    buffer_load_dwordx4 v32, s[12:15], s29 offen offset:0 nt lds
    s_add_u32 m0, s95, 91008
    s_nop 0
    buffer_load_dwordx4 v32, s[12:15], s29 offen offset:128 nt lds
    s_add_u32 m0, s95, 91904
    s_nop 0
    buffer_load_dwordx4 v32, s[12:15], s29 offen offset:256 nt lds
    s_add_u32 s29, s90, 1966080
    s_add_u32 m0, s95, 102400
    s_nop 0
    buffer_load_dwordx4 v32, s[12:15], s29 offen offset:0 nt lds
    s_add_u32 m0, s95, 103296
    s_nop 0
    buffer_load_dwordx4 v32, s[12:15], s29 offen offset:128 nt lds
    s_add_u32 m0, s95, 104192
    s_nop 0
    buffer_load_dwordx4 v32, s[12:15], s29 offen offset:256 nt lds
    s_add_u32 s29, s90, 2359296
    s_add_u32 m0, s95, 114688
    s_nop 0
    buffer_load_dwordx4 v32, s[12:15], s29 offen offset:0 nt lds
    s_add_u32 m0, s95, 115584
    s_nop 0
    buffer_load_dwordx4 v32, s[12:15], s29 offen offset:128 nt lds
    s_add_u32 m0, s95, 116480
    s_nop 0
    buffer_load_dwordx4 v32, s[12:15], s29 offen offset:256 nt lds
    s_add_u32 s29, s90, 2752512
    s_add_u32 m0, s95, 126976
    s_nop 0
    buffer_load_dwordx4 v32, s[12:15], s29 offen offset:0 nt lds
    s_add_u32 m0, s95, 127872
    s_nop 0
    buffer_load_dwordx4 v32, s[12:15], s29 offen offset:128 nt lds
    s_add_u32 m0, s95, 128768
    s_nop 0
    buffer_load_dwordx4 v32, s[12:15], s29 offen offset:256 nt lds
    s_add_u32 s29, s90, 3145728
    s_add_u32 m0, s95, 139264
    s_nop 0
    buffer_load_dwordx4 v32, s[12:15], s29 offen offset:0 nt lds
    s_add_u32 m0, s95, 140160
    s_nop 0
    buffer_load_dwordx4 v32, s[12:15], s29 offen offset:128 nt lds
    s_add_u32 m0, s95, 141056
    s_nop 0
    buffer_load_dwordx4 v32, s[12:15], s29 offen offset:256 nt lds
    s_add_u32 s29, s90, 3538944
    s_add_u32 m0, s95, 151552
    s_nop 0
    buffer_load_dwordx4 v32, s[12:15], s29 offen offset:0 nt lds
    s_add_u32 m0, s95, 152448
    s_nop 0
    buffer_load_dwordx4 v32, s[12:15], s29 offen offset:128 nt lds
    s_add_u32 m0, s95, 153344
    s_nop 0
    buffer_load_dwordx4 v32, s[12:15], s29 offen offset:256 nt lds
    v_and_b32 v5, 1, v3
    v_lshlrev_b32 v5, 1, v5
    v_lshrrev_b32 v6, 3, v2
    v_add_u32 v5, v5, v6
    v_mul_u32_u24 v6, 3072, v3
    v_lshrrev_b32 v7, 2, v2
    v_lshl_add_u32 v6, v7, 7, v6
    v_and_b32 v7, 3, v2
    v_lshl_add_u32 v6, v7, 3, v6
    s_mul_i32 s28, s24, 3
    s_add_u32 s28, s28, 0
    s_and_b32 s29, s28, 3
    s_lshr_b32 s28, s28, 2
    s_lshl_b32 s28, s28, 10
    s_add_u32 s28, s28, 40960
    v_xor_b32 v7, s29, v5
    v_lshl_add_u32 v7, v7, 5, v6
    v_add_u32 v33, s28, v7
    v_add_u32 v34, 49152, v33
    v_add_u32 v35, 49152, v34
    s_mul_i32 s28, s24, 3
    s_add_u32 s28, s28, 1
    s_and_b32 s29, s28, 3
    s_lshr_b32 s28, s28, 2
    s_lshl_b32 s28, s28, 10
    s_add_u32 s28, s28, 40960
    v_xor_b32 v7, s29, v5
    v_lshl_add_u32 v7, v7, 5, v6
    v_add_u32 v36, s28, v7
    v_add_u32 v37, 49152, v36
    v_add_u32 v38, 49152, v37
    s_mul_i32 s28, s24, 3
    s_add_u32 s28, s28, 2
    s_and_b32 s29, s28, 3
    s_lshr_b32 s28, s28, 2
    s_lshl_b32 s28, s28, 10
    s_add_u32 s28, s28, 40960
    v_xor_b32 v7, s29, v5
    v_lshl_add_u32 v7, v7, 5, v6
    v_add_u32 v39, s28, v7
    v_add_u32 v40, 49152, v39
    v_add_u32 v41, 49152, v40
    s_waitcnt vmcnt(15)
    s_barrier
    ds_read_b64_tr_b16 a[0:1], v33 offset:0
    ds_read_b64_tr_b16 a[2:3], v33 offset:512
    ds_read_b64_tr_b16 a[80:81], v36 offset:0
    ds_read_b64_tr_b16 a[82:83], v36 offset:512
    ds_read_b64_tr_b16 a[160:161], v39 offset:0
    ds_read_b64_tr_b16 a[162:163], v39 offset:512
    ds_read_b64_tr_b16 a[4:5], v33 offset:12288
    ds_read_b64_tr_b16 a[6:7], v33 offset:12800
    ds_read_b64_tr_b16 a[84:85], v36 offset:12288
    ds_read_b64_tr_b16 a[86:87], v36 offset:12800
    ds_read_b64_tr_b16 a[164:165], v39 offset:12288
    ds_read_b64_tr_b16 a[166:167], v39 offset:12800
    s_waitcnt lgkmcnt(2)
    ds_read_b64_tr_b16 a[8:9], v33 offset:24576
    ds_read_b64_tr_b16 a[10:11], v33 offset:25088
    ds_read_b64_tr_b16 a[88:89], v36 offset:24576
    ds_read_b64_tr_b16 a[90:91], v36 offset:25088
    ds_read_b64_tr_b16 a[168:169], v39 offset:24576
    ds_read_b64_tr_b16 a[170:171], v39 offset:25088
    ds_read_b64_tr_b16 a[12:13], v33 offset:36864
    ds_read_b64_tr_b16 a[14:15], v33 offset:37376
    ds_read_b64_tr_b16 a[92:93], v36 offset:36864
    ds_read_b64_tr_b16 a[94:95], v36 offset:37376
    s_waitcnt lgkmcnt(2)
    ds_read_b64_tr_b16 a[172:173], v39 offset:36864
    ds_read_b64_tr_b16 a[174:175], v39 offset:37376
    ds_read_b64_tr_b16 a[16:17], v34 offset:0
    ds_read_b64_tr_b16 a[18:19], v34 offset:512
    ds_read_b64_tr_b16 a[96:97], v37 offset:0
    ds_read_b64_tr_b16 a[98:99], v37 offset:512
    ds_read_b64_tr_b16 a[176:177], v40 offset:0
    ds_read_b64_tr_b16 a[178:179], v40 offset:512
Lwl_96:
    s_waitcnt lgkmcnt(0)
    s_barrier
    s_add_u32 s29, s90, 3932160
    s_add_u32 m0, s95, 40960
    s_nop 0
    buffer_load_dwordx4 v32, s[12:15], s29 offen offset:0 nt lds
    s_add_u32 m0, s95, 41856
    s_nop 0
    buffer_load_dwordx4 v32, s[12:15], s29 offen offset:128 nt lds
    s_add_u32 m0, s95, 42752
    s_nop 0
    buffer_load_dwordx4 v32, s[12:15], s29 offen offset:256 nt lds
    s_add_u32 s29, s90, 4325376
    s_add_u32 m0, s95, 53248
    s_nop 0
    buffer_load_dwordx4 v32, s[12:15], s29 offen offset:0 nt lds
    s_add_u32 m0, s95, 54144
    s_nop 0
    buffer_load_dwordx4 v32, s[12:15], s29 offen offset:128 nt lds
    s_add_u32 m0, s95, 55040
    s_nop 0
    buffer_load_dwordx4 v32, s[12:15], s29 offen offset:256 nt lds
    s_add_u32 s29, s90, 4718592
    s_add_u32 m0, s95, 65536
    s_nop 0
    buffer_load_dwordx4 v32, s[12:15], s29 offen offset:0 nt lds
    s_add_u32 m0, s95, 66432
    s_nop 0
    buffer_load_dwordx4 v32, s[12:15], s29 offen offset:128 nt lds
    s_add_u32 m0, s95, 67328
    s_nop 0
    buffer_load_dwordx4 v32, s[12:15], s29 offen offset:256 nt lds
    s_add_u32 s29, s90, 5111808
    s_add_u32 m0, s95, 77824
    s_nop 0
    buffer_load_dwordx4 v32, s[12:15], s29 offen offset:0 nt lds
    s_add_u32 m0, s95, 78720
    s_nop 0
    buffer_load_dwordx4 v32, s[12:15], s29 offen offset:128 nt lds
    s_add_u32 m0, s95, 79616
    s_nop 0
    buffer_load_dwordx4 v32, s[12:15], s29 offen offset:256 nt lds
    s_add_u32 s29, s90, 5505024
    s_add_u32 m0, s95, 90112
    s_nop 0
    buffer_load_dwordx4 v32, s[12:15], s29 offen offset:0 nt lds
    s_add_u32 m0, s95, 91008
    s_nop 0
    buffer_load_dwordx4 v32, s[12:15], s29 offen offset:128 nt lds
    s_add_u32 m0, s95, 91904
    s_nop 0
    buffer_load_dwordx4 v32, s[12:15], s29 offen offset:256 nt lds
    s_waitcnt vmcnt(15)
    s_barrier
    ds_read_b64_tr_b16 a[20:21], v34 offset:12288
    ds_read_b64_tr_b16 a[22:23], v34 offset:12800
    ds_read_b64_tr_b16 a[100:101], v37 offset:12288
    ds_read_b64_tr_b16 a[102:103], v37 offset:12800
    ds_read_b64_tr_b16 a[180:181], v40 offset:12288
    ds_read_b64_tr_b16 a[182:183], v40 offset:12800
    ds_read_b64_tr_b16 a[24:25], v34 offset:24576
    ds_read_b64_tr_b16 a[26:27], v34 offset:25088
    ds_read_b64_tr_b16 a[104:105], v37 offset:24576
    ds_read_b64_tr_b16 a[106:107], v37 offset:25088
    ds_read_b64_tr_b16 a[184:185], v40 offset:24576
    ds_read_b64_tr_b16 a[186:187], v40 offset:25088
    s_waitcnt lgkmcnt(2)
    ds_read_b64_tr_b16 a[28:29], v34 offset:36864
    ds_read_b64_tr_b16 a[30:31], v34 offset:37376
    ds_read_b64_tr_b16 a[108:109], v37 offset:36864
    ds_read_b64_tr_b16 a[110:111], v37 offset:37376
    ds_read_b64_tr_b16 a[188:189], v40 offset:36864
    ds_read_b64_tr_b16 a[190:191], v40 offset:37376
    ds_read_b64_tr_b16 a[32:33], v35 offset:0
    ds_read_b64_tr_b16 a[34:35], v35 offset:512
    ds_read_b64_tr_b16 a[112:113], v38 offset:0
    ds_read_b64_tr_b16 a[114:115], v38 offset:512
    s_waitcnt lgkmcnt(2)
    ds_read_b64_tr_b16 a[192:193], v41 offset:0
    ds_read_b64_tr_b16 a[194:195], v41 offset:512
    ds_read_b64_tr_b16 a[36:37], v35 offset:12288
    ds_read_b64_tr_b16 a[38:39], v35 offset:12800
    ds_read_b64_tr_b16 a[116:117], v38 offset:12288
    ds_read_b64_tr_b16 a[118:119], v38 offset:12800
    ds_read_b64_tr_b16 a[196:197], v41 offset:12288
    ds_read_b64_tr_b16 a[198:199], v41 offset:12800
Lwl_98:
    s_waitcnt lgkmcnt(0)
    s_barrier
    s_add_u32 s29, s90, 5898240
    s_add_u32 m0, s95, 102400
    s_nop 0
    buffer_load_dwordx4 v32, s[12:15], s29 offen offset:0 nt lds
    s_add_u32 m0, s95, 103296
    s_nop 0
    buffer_load_dwordx4 v32, s[12:15], s29 offen offset:128 nt lds
    s_add_u32 m0, s95, 104192
    s_nop 0
    buffer_load_dwordx4 v32, s[12:15], s29 offen offset:256 nt lds
    s_add_u32 s29, s90, 6291456
    s_add_u32 m0, s95, 114688
    s_nop 0
    buffer_load_dwordx4 v32, s[12:15], s29 offen offset:0 nt lds
    s_add_u32 m0, s95, 115584
    s_nop 0
    buffer_load_dwordx4 v32, s[12:15], s29 offen offset:128 nt lds
    s_add_u32 m0, s95, 116480
    s_nop 0
    buffer_load_dwordx4 v32, s[12:15], s29 offen offset:256 nt lds
    s_add_u32 s29, s90, 6684672
    s_add_u32 m0, s95, 126976
    s_nop 0
    buffer_load_dwordx4 v32, s[12:15], s29 offen offset:0 nt lds
    s_add_u32 m0, s95, 127872
    s_nop 0
    buffer_load_dwordx4 v32, s[12:15], s29 offen offset:128 nt lds
    s_add_u32 m0, s95, 128768
    s_nop 0
    buffer_load_dwordx4 v32, s[12:15], s29 offen offset:256 nt lds
    s_add_u32 s29, s90, 7077888
    s_add_u32 m0, s95, 139264
    s_nop 0
    buffer_load_dwordx4 v32, s[12:15], s29 offen offset:0 nt lds
    s_add_u32 m0, s95, 140160
    s_nop 0
    buffer_load_dwordx4 v32, s[12:15], s29 offen offset:128 nt lds
    s_add_u32 m0, s95, 141056
    s_nop 0
    buffer_load_dwordx4 v32, s[12:15], s29 offen offset:256 nt lds
    s_add_u32 s29, s90, 7471104
    s_add_u32 m0, s95, 151552
    s_nop 0
    buffer_load_dwordx4 v32, s[12:15], s29 offen offset:0 nt lds
    s_add_u32 m0, s95, 152448
    s_nop 0
    buffer_load_dwordx4 v32, s[12:15], s29 offen offset:128 nt lds
    s_add_u32 m0, s95, 153344
    s_nop 0
    buffer_load_dwordx4 v32, s[12:15], s29 offen offset:256 nt lds
    s_waitcnt vmcnt(15)
    s_barrier
    ds_read_b64_tr_b16 a[40:41], v33 offset:0
    ds_read_b64_tr_b16 a[42:43], v33 offset:512
    ds_read_b64_tr_b16 a[120:121], v36 offset:0
    ds_read_b64_tr_b16 a[122:123], v36 offset:512
    ds_read_b64_tr_b16 a[200:201], v39 offset:0
    ds_read_b64_tr_b16 a[202:203], v39 offset:512
    ds_read_b64_tr_b16 a[44:45], v33 offset:12288
    ds_read_b64_tr_b16 a[46:47], v33 offset:12800
    ds_read_b64_tr_b16 a[124:125], v36 offset:12288
    ds_read_b64_tr_b16 a[126:127], v36 offset:12800
    ds_read_b64_tr_b16 a[204:205], v39 offset:12288
    ds_read_b64_tr_b16 a[206:207], v39 offset:12800
    s_waitcnt lgkmcnt(2)
    ds_read_b64_tr_b16 a[48:49], v33 offset:24576
    ds_read_b64_tr_b16 a[50:51], v33 offset:25088
    ds_read_b64_tr_b16 a[128:129], v36 offset:24576
    ds_read_b64_tr_b16 a[130:131], v36 offset:25088
    ds_read_b64_tr_b16 a[208:209], v39 offset:24576
    ds_read_b64_tr_b16 a[210:211], v39 offset:25088
    ds_read_b64_tr_b16 a[52:53], v33 offset:36864
    ds_read_b64_tr_b16 a[54:55], v33 offset:37376
    ds_read_b64_tr_b16 a[132:133], v36 offset:36864
    ds_read_b64_tr_b16 a[134:135], v36 offset:37376
    s_waitcnt lgkmcnt(2)
    ds_read_b64_tr_b16 a[212:213], v39 offset:36864
    ds_read_b64_tr_b16 a[214:215], v39 offset:37376
    ds_read_b64_tr_b16 a[56:57], v34 offset:0
    ds_read_b64_tr_b16 a[58:59], v34 offset:512
    ds_read_b64_tr_b16 a[136:137], v37 offset:0
    ds_read_b64_tr_b16 a[138:139], v37 offset:512
    ds_read_b64_tr_b16 a[216:217], v40 offset:0
    ds_read_b64_tr_b16 a[218:219], v40 offset:512
Lwl_100:
    s_waitcnt lgkmcnt(0)
    s_waitcnt vmcnt(0)
    s_barrier
    ds_read_b64_tr_b16 a[60:61], v34 offset:12288
    ds_read_b64_tr_b16 a[62:63], v34 offset:12800
    ds_read_b64_tr_b16 a[140:141], v37 offset:12288
    ds_read_b64_tr_b16 a[142:143], v37 offset:12800
    ds_read_b64_tr_b16 a[220:221], v40 offset:12288
    ds_read_b64_tr_b16 a[222:223], v40 offset:12800
    ds_read_b64_tr_b16 a[64:65], v34 offset:24576
    ds_read_b64_tr_b16 a[66:67], v34 offset:25088
    ds_read_b64_tr_b16 a[144:145], v37 offset:24576
    ds_read_b64_tr_b16 a[146:147], v37 offset:25088
    ds_read_b64_tr_b16 a[224:225], v40 offset:24576
    ds_read_b64_tr_b16 a[226:227], v40 offset:25088
    s_waitcnt lgkmcnt(2)
    ds_read_b64_tr_b16 a[68:69], v34 offset:36864
    ds_read_b64_tr_b16 a[70:71], v34 offset:37376
    ds_read_b64_tr_b16 a[148:149], v37 offset:36864
    ds_read_b64_tr_b16 a[150:151], v37 offset:37376
    ds_read_b64_tr_b16 a[228:229], v40 offset:36864
    ds_read_b64_tr_b16 a[230:231], v40 offset:37376
    ds_read_b64_tr_b16 a[72:73], v35 offset:0
    ds_read_b64_tr_b16 a[74:75], v35 offset:512
    ds_read_b64_tr_b16 a[152:153], v38 offset:0
    ds_read_b64_tr_b16 a[154:155], v38 offset:512
    s_waitcnt lgkmcnt(2)
    ds_read_b64_tr_b16 a[232:233], v41 offset:0
    ds_read_b64_tr_b16 a[234:235], v41 offset:512
    ds_read_b64_tr_b16 a[76:77], v35 offset:12288
    ds_read_b64_tr_b16 a[78:79], v35 offset:12800
    ds_read_b64_tr_b16 a[156:157], v38 offset:12288
    ds_read_b64_tr_b16 a[158:159], v38 offset:12800
    ds_read_b64_tr_b16 a[236:237], v41 offset:12288
    ds_read_b64_tr_b16 a[238:239], v41 offset:12800
Lwl_102:
    s_waitcnt lgkmcnt(0)
    s_cmp_lg_u32 s24, 0
    s_cbranch_scc1 Lgod_105
    v_mov_b32 v5, 132
Lgo_104:
    buffer_load_dword v6, v5, s[20:23], 0 offen sc1
    s_waitcnt vmcnt(0)
    v_cmp_eq_u32 vcc, 0, v6
    s_cbranch_vccz Lgod_105
    s_sleep 2
    s_sub_u32 s27, s27, 1
    s_cbranch_scc1 L_exit
    s_branch Lgo_104
Lgod_105:
    s_barrier
    s_mov_b32 s26, 0
    v_mov_b32 v5, 0
    v_lshlrev_b32 v18, 3, v1
    s_mul_i32 s28, s24, 1536
    s_add_u32 s28, s28, 90112
    v_add_u32 v20, s28, v18
    s_and_b32 s88, s24, 1
    s_lshr_b32 s89, s24, 1
    s_mul_i32 s28, s88, 6144
    s_add_u32 s28, s28, 90112
    v_add_u32 v21, s28, v18
    v_and_b32 v6, 7, v2
    v_lshlrev_b32 v22, 4, v6
    v_lshl_add_u32 v22, v3, 7, v22
    v_lshlrev_b32 v23, 4, v2
    v_lshl_add_u32 v23, v3, 3, v23
    v_mov_b32 v24, 0xd04e79ff
    v_mov_b32 v6, 0xff800000
    v_cmp_lt_u32 vcc, 1, v3
    s_nop 1
    v_cndmask_b32 v216, v5, v6, vcc
    v_cndmask_b32 v217, v5, v6, vcc
    v_cndmask_b32 v218, v5, v6, vcc
    v_cndmask_b32 v219, v5, v6, vcc
    s_lshl_b32 s28, s88, 4
    v_add_u32 v6, s28, v2
    v_lshlrev_b32 v7, 2, v3
    v_sub_u32 v6, v6, v7
    v_cmp_le_i32 s[32:33], 0, v6
    v_cmp_le_i32 s[34:35], 1, v6
    v_cmp_le_i32 s[36:37], 2, v6
    v_cmp_le_i32 s[38:39], 3, v6
    v_cmp_le_i32 s[40:41], 16, v6
    v_cmp_le_i32 s[42:43], 17, v6
    v_cmp_le_i32 s[44:45], 18, v6
    v_cmp_le_i32 s[46:47], 19, v6
    s_mov_b32 s84, 0x3dd53b95
    s_mul_i32 s77, s25, 786432
    s_add_u32 s77, s77, 0x2a00000
    s_mul_i32 s76, s24, 3072
    s_add_u32 s77, s77, s76
    s_add_u32 s76, s76, 102400
    v_add_u32 v18, 102400, v18
    s_mul_i32 s78, s25, 196608
    s_add_u32 s78, s78, 0x4200000
    s_mul_i32 s28, s89, 3072
    s_add_u32 s78, s78, s28
    s_lshl_b32 s28, s25, 7
    s_add_u32 s79, s28, 0xba10000
    s_add_u32 s80, s28, 0xba11000
    s_add_u32 s81, s28, 0xba12000
    s_mul_i32 s29, s24, 81920
    s_add_u32 s29, s29, 0x4800000
    s_lshl_b32 s82, s25, 10
    s_add_u32 s82, s82, s29
    s_lshl_b32 s83, s25, 8
    s_add_u32 s83, s83, s29
    s_add_u32 s83, s83, 32768
    s_mov_b32 s86, 0
    v_mov_b32 v25, 0
    s_waitcnt vmcnt(0)
    s_barrier
L_q_top:
    s_add_u32 s90, s26, s89
    s_sub_u32 s90, s90, 1
    s_and_b32 s87, s26, 1
    s_xor_b32 s87, s87, 1
    s_cmp_eq_u32 s26, 0
    s_cselect_b32 s87, 0, s87
    s_cmp_eq_u32 s26, 64
    s_cbranch_scc1 L_q_nog
    s_add_u32 s85, s26, 1
    s_cmp_ge_u32 s86, s85
    s_cbranch_scc1 L_q_kok
Lwf_106:
    buffer_load_dword v6, v5, s[4:7], s79 offen sc1
    s_waitcnt vmcnt(0)
    v_cmp_gt_u32 vcc, s85, v6
    s_cbranch_vccz Lwfd_107
    s_sleep 1
    s_sub_u32 s27, s27, 1
    s_cbranch_scc1 L_exit
    s_branch Lwf_106
Lwfd_107:
    v_readfirstlane_b32 s86, v6
L_q_kok:
    v_readfirstlane_b32 s28, v25
    s_cmp_eq_u32 s87, 0
    s_cbranch_scc1 L_q_g
    s_cmp_lt_u32 s28, s90
    s_cbranch_scc1 L_q_g
    buffer_load_dwordx4 v[148:151], v22, s[4:7], s78 offen offset:0 sc1
    buffer_load_dwordx4 v[152:155], v22, s[4:7], s78 offen offset:512 sc1
    buffer_load_dwordx4 v[156:159], v22, s[4:7], s78 offen offset:1024 sc1
    buffer_load_dwordx4 v[160:163], v22, s[4:7], s78 offen offset:1536 sc1
    buffer_load_dwordx4 v[164:167], v22, s[4:7], s78 offen offset:2048 sc1
    buffer_load_dwordx4 v[168:171], v22, s[4:7], s78 offen offset:2560 sc1
    s_add_u32 s78, s78, 6144
    s_mov_b32 s87, 2
L_q_g:
    s_add_u32 s74, s74, 40960
    s_and_b32 s28, s26, 1
    s_xor_b32 s28, s28, 1
    s_mul_i32 s28, s28, 49152
    s_add_u32 m0, s28, s75
    ds_read_b128 v[32:35], v17 offset:0
    ds_read_b128 v[36:39], v17 offset:20480
    ds_read_b128 v[40:43], v19 offset:0
    ds_read_b128 v[44:47], v19 offset:20480
    ds_read_b128 v[48:51], v17 offset:1024
    ds_read_b128 v[52:55], v17 offset:21504
    s_waitcnt lgkmcnt(4)
    v_mfma_f32_16x16x32_bf16 v[64:67], a[0:3], v[32:35], 0
    ds_read_b128 v[56:59], v19 offset:1024
    v_mfma_f32_16x16x32_bf16 v[68:71], a[0:3], v[36:39], 0
    ds_read_b128 v[60:63], v19 offset:21504
    v_mfma_f32_16x16x32_bf16 v[72:75], a[80:83], v[32:35], 0
    v_mfma_f32_16x16x32_bf16 v[76:79], a[80:83], v[36:39], 0
    buffer_load_dwordx4 v16, s[8:11], s74 offen offset:0 lds
    s_add_u32 m0, m0, s92
    v_mfma_f32_16x16x32_bf16 v[80:83], a[160:163], v[32:35], 0
    v_mfma_f32_16x16x32_bf16 v[84:87], a[160:163], v[36:39], 0
    s_waitcnt lgkmcnt(4)
    v_mfma_f32_16x16x32_bf16 v[64:67], a[4:7], v[40:43], v[64:67]
    ds_read_b128 v[32:35], v17 offset:2048
    v_mfma_f32_16x16x32_bf16 v[68:71], a[4:7], v[44:47], v[68:71]
    ds_read_b128 v[36:39], v17 offset:22528
    v_mfma_f32_16x16x32_bf16 v[72:75], a[84:87], v[40:43], v[72:75]
    v_mfma_f32_16x16x32_bf16 v[76:79], a[84:87], v[44:47], v[76:79]
    buffer_load_dwordx4 v31, s[8:11], s74 offen offset:0 lds
    s_add_u32 m0, m0, s93
    v_mfma_f32_16x16x32_bf16 v[80:83], a[164:167], v[40:43], v[80:83]
    v_mfma_f32_16x16x32_bf16 v[84:87], a[164:167], v[44:47], v[84:87]
    s_waitcnt lgkmcnt(4)
    v_mfma_f32_16x16x32_bf16 v[64:67], a[8:11], v[48:51], v[64:67]
    ds_read_b128 v[40:43], v19 offset:2048
    v_mfma_f32_16x16x32_bf16 v[68:71], a[8:11], v[52:55], v[68:71]
    ds_read_b128 v[44:47], v19 offset:22528
    v_mfma_f32_16x16x32_bf16 v[72:75], a[88:91], v[48:51], v[72:75]
    v_mfma_f32_16x16x32_bf16 v[76:79], a[88:91], v[52:55], v[76:79]
    buffer_load_dwordx4 v16, s[8:11], s74 offen offset:256 lds
    s_add_u32 m0, m0, s92
    v_mfma_f32_16x16x32_bf16 v[80:83], a[168:171], v[48:51], v[80:83]
    v_mfma_f32_16x16x32_bf16 v[84:87], a[168:171], v[52:55], v[84:87]
    s_waitcnt lgkmcnt(4)
    v_mfma_f32_16x16x32_bf16 v[64:67], a[12:15], v[56:59], v[64:67]
    ds_read_b128 v[48:51], v17 offset:3072
    v_mfma_f32_16x16x32_bf16 v[68:71], a[12:15], v[60:63], v[68:71]
    ds_read_b128 v[52:55], v17 offset:23552
    v_mfma_f32_16x16x32_bf16 v[72:75], a[92:95], v[56:59], v[72:75]
    v_mfma_f32_16x16x32_bf16 v[76:79], a[92:95], v[60:63], v[76:79]
    buffer_load_dwordx4 v31, s[8:11], s74 offen offset:256 lds
    s_add_u32 m0, m0, s93
    v_mfma_f32_16x16x32_bf16 v[80:83], a[172:175], v[56:59], v[80:83]
    v_mfma_f32_16x16x32_bf16 v[84:87], a[172:175], v[60:63], v[84:87]
    s_waitcnt lgkmcnt(4)
    v_mfma_f32_16x16x32_bf16 v[64:67], a[16:19], v[32:35], v[64:67]
    ds_read_b128 v[56:59], v19 offset:3072
    v_mfma_f32_16x16x32_bf16 v[68:71], a[16:19], v[36:39], v[68:71]
    ds_read_b128 v[60:63], v19 offset:23552
    v_mfma_f32_16x16x32_bf16 v[72:75], a[96:99], v[32:35], v[72:75]
    v_mfma_f32_16x16x32_bf16 v[76:79], a[96:99], v[36:39], v[76:79]
    buffer_load_dwordx4 v16, s[8:11], s74 offen offset:512 lds
    s_add_u32 m0, m0, s92
    v_mfma_f32_16x16x32_bf16 v[80:83], a[176:179], v[32:35], v[80:83]
    v_mfma_f32_16x16x32_bf16 v[84:87], a[176:179], v[36:39], v[84:87]
    s_waitcnt lgkmcnt(4)
    v_mfma_f32_16x16x32_bf16 v[64:67], a[20:23], v[40:43], v[64:67]
    ds_read_b128 v[32:35], v17 offset:4096
    v_mfma_f32_16x16x32_bf16 v[68:71], a[20:23], v[44:47], v[68:71]
    ds_read_b128 v[36:39], v17 offset:24576
    v_mfma_f32_16x16x32_bf16 v[72:75], a[100:103], v[40:43], v[72:75]
    v_mfma_f32_16x16x32_bf16 v[76:79], a[100:103], v[44:47], v[76:79]
    buffer_load_dwordx4 v31, s[8:11], s74 offen offset:512 lds
    s_add_u32 m0, m0, s93
    v_mfma_f32_16x16x32_bf16 v[80:83], a[180:183], v[40:43], v[80:83]
    v_mfma_f32_16x16x32_bf16 v[84:87], a[180:183], v[44:47], v[84:87]
    s_waitcnt lgkmcnt(4)
    v_mfma_f32_16x16x32_bf16 v[64:67], a[24:27], v[48:51], v[64:67]
    ds_read_b128 v[40:43], v19 offset:4096
    v_mfma_f32_16x16x32_bf16 v[68:71], a[24:27], v[52:55], v[68:71]
    ds_read_b128 v[44:47], v19 offset:24576
    v_mfma_f32_16x16x32_bf16 v[72:75], a[104:107], v[48:51], v[72:75]
    v_mfma_f32_16x16x32_bf16 v[76:79], a[104:107], v[52:55], v[76:79]
    buffer_load_dwordx4 v16, s[8:11], s74 offen offset:768 lds
    s_add_u32 m0, m0, s92
    v_mfma_f32_16x16x32_bf16 v[80:83], a[184:187], v[48:51], v[80:83]
    v_mfma_f32_16x16x32_bf16 v[84:87], a[184:187], v[52:55], v[84:87]
    s_waitcnt lgkmcnt(4)
    v_mfma_f32_16x16x32_bf16 v[64:67], a[28:31], v[56:59], v[64:67]
    ds_read_b128 v[48:51], v17 offset:5120
    v_mfma_f32_16x16x32_bf16 v[68:71], a[28:31], v[60:63], v[68:71]
    ds_read_b128 v[52:55], v17 offset:25600
    v_mfma_f32_16x16x32_bf16 v[72:75], a[108:111], v[56:59], v[72:75]
    v_mfma_f32_16x16x32_bf16 v[76:79], a[108:111], v[60:63], v[76:79]
    buffer_load_dwordx4 v31, s[8:11], s74 offen offset:768 lds
    s_add_u32 m0, m0, s93
    v_mfma_f32_16x16x32_bf16 v[80:83], a[188:191], v[56:59], v[80:83]
    v_mfma_f32_16x16x32_bf16 v[84:87], a[188:191], v[60:63], v[84:87]
    s_waitcnt lgkmcnt(4)
    v_mfma_f32_16x16x32_bf16 v[64:67], a[32:35], v[32:35], v[64:67]
    ds_read_b128 v[56:59], v19 offset:5120
    v_mfma_f32_16x16x32_bf16 v[68:71], a[32:35], v[36:39], v[68:71]
    ds_read_b128 v[60:63], v19 offset:25600
    v_mfma_f32_16x16x32_bf16 v[72:75], a[112:115], v[32:35], v[72:75]
    v_mfma_f32_16x16x32_bf16 v[76:79], a[112:115], v[36:39], v[76:79]
    buffer_load_dwordx4 v16, s[8:11], s74 offen offset:1024 lds
    s_add_u32 m0, m0, s92
    v_mfma_f32_16x16x32_bf16 v[80:83], a[192:195], v[32:35], v[80:83]
    v_mfma_f32_16x16x32_bf16 v[84:87], a[192:195], v[36:39], v[84:87]
    s_waitcnt lgkmcnt(4)
    v_mfma_f32_16x16x32_bf16 v[64:67], a[36:39], v[40:43], v[64:67]
    ds_read_b128 v[32:35], v17 offset:6144
    v_mfma_f32_16x16x32_bf16 v[68:71], a[36:39], v[44:47], v[68:71]
    ds_read_b128 v[36:39], v17 offset:26624
    v_mfma_f32_16x16x32_bf16 v[72:75], a[116:119], v[40:43], v[72:75]
    v_mfma_f32_16x16x32_bf16 v[76:79], a[116:119], v[44:47], v[76:79]
    buffer_load_dwordx4 v31, s[8:11], s74 offen offset:1024 lds
    v_mfma_f32_16x16x32_bf16 v[80:83], a[196:199], v[40:43], v[80:83]
    v_mfma_f32_16x16x32_bf16 v[84:87], a[196:199], v[44:47], v[84:87]
    s_waitcnt lgkmcnt(4)
    v_mfma_f32_16x16x32_bf16 v[64:67], a[40:43], v[48:51], v[64:67]
    ds_read_b128 v[40:43], v19 offset:6144
    v_mfma_f32_16x16x32_bf16 v[68:71], a[40:43], v[52:55], v[68:71]
    ds_read_b128 v[44:47], v19 offset:26624
    v_mfma_f32_16x16x32_bf16 v[72:75], a[120:123], v[48:51], v[72:75]
    v_mfma_f32_16x16x32_bf16 v[76:79], a[120:123], v[52:55], v[76:79]
    s_barrier
    s_mov_b32 m0, s76
    v_mfma_f32_16x16x32_bf16 v[80:83], a[200:203], v[48:51], v[80:83]
    v_mfma_f32_16x16x32_bf16 v[84:87], a[200:203], v[52:55], v[84:87]
    s_waitcnt lgkmcnt(4)
    v_mfma_f32_16x16x32_bf16 v[64:67], a[44:47], v[56:59], v[64:67]
    ds_read_b128 v[48:51], v17 offset:7168
    v_mfma_f32_16x16x32_bf16 v[68:71], a[44:47], v[60:63], v[68:71]
    ds_read_b128 v[52:55], v17 offset:27648
    v_mfma_f32_16x16x32_bf16 v[72:75], a[124:127], v[56:59], v[72:75]
    v_mfma_f32_16x16x32_bf16 v[76:79], a[124:127], v[60:63], v[76:79]
    buffer_load_dwordx4 v4, s[4:7], s77 offen offset:0 sc1 lds
    v_mfma_f32_16x16x32_bf16 v[80:83], a[204:207], v[56:59], v[80:83]
    v_mfma_f32_16x16x32_bf16 v[84:87], a[204:207], v[60:63], v[84:87]
    s_waitcnt lgkmcnt(4)
    v_mfma_f32_16x16x32_bf16 v[64:67], a[48:51], v[32:35], v[64:67]
    ds_read_b128 v[56:59], v19 offset:7168
    v_mfma_f32_16x16x32_bf16 v[68:71], a[48:51], v[36:39], v[68:71]
    ds_read_b128 v[60:63], v19 offset:27648
    v_mfma_f32_16x16x32_bf16 v[72:75], a[128:131], v[32:35], v[72:75]
    v_mfma_f32_16x16x32_bf16 v[76:79], a[128:131], v[36:39], v[76:79]
    buffer_load_dwordx4 v4, s[4:7], s77 offen offset:1024 sc1 lds
    v_mfma_f32_16x16x32_bf16 v[80:83], a[208:211], v[32:35], v[80:83]
    v_mfma_f32_16x16x32_bf16 v[84:87], a[208:211], v[36:39], v[84:87]
    s_waitcnt lgkmcnt(4)
    v_mfma_f32_16x16x32_bf16 v[64:67], a[52:55], v[40:43], v[64:67]
    ds_read_b128 v[32:35], v17 offset:8192
    v_mfma_f32_16x16x32_bf16 v[68:71], a[52:55], v[44:47], v[68:71]
    ds_read_b128 v[36:39], v17 offset:28672
    v_mfma_f32_16x16x32_bf16 v[72:75], a[132:135], v[40:43], v[72:75]
    v_mfma_f32_16x16x32_bf16 v[76:79], a[132:135], v[44:47], v[76:79]
    buffer_load_dwordx4 v4, s[4:7], s77 offen offset:2048 sc1 lds
    v_mfma_f32_16x16x32_bf16 v[80:83], a[212:215], v[40:43], v[80:83]
    v_mfma_f32_16x16x32_bf16 v[84:87], a[212:215], v[44:47], v[84:87]
    s_waitcnt lgkmcnt(4)
    v_mfma_f32_16x16x32_bf16 v[64:67], a[56:59], v[48:51], v[64:67]
    ds_read_b128 v[40:43], v19 offset:8192
    v_mfma_f32_16x16x32_bf16 v[68:71], a[56:59], v[52:55], v[68:71]
    ds_read_b128 v[44:47], v19 offset:28672
    v_mfma_f32_16x16x32_bf16 v[72:75], a[136:139], v[48:51], v[72:75]
    v_mfma_f32_16x16x32_bf16 v[76:79], a[136:139], v[52:55], v[76:79]
    s_add_u32 s77, s77, 12288
    v_mfma_f32_16x16x32_bf16 v[80:83], a[216:219], v[48:51], v[80:83]
    v_mfma_f32_16x16x32_bf16 v[84:87], a[216:219], v[52:55], v[84:87]
    s_waitcnt lgkmcnt(4)
    v_mfma_f32_16x16x32_bf16 v[64:67], a[60:63], v[56:59], v[64:67]
    ds_read_b128 v[48:51], v17 offset:9216
    v_mfma_f32_16x16x32_bf16 v[68:71], a[60:63], v[60:63], v[68:71]
    ds_read_b128 v[52:55], v17 offset:29696
    v_mfma_f32_16x16x32_bf16 v[72:75], a[140:143], v[56:59], v[72:75]
    v_mfma_f32_16x16x32_bf16 v[76:79], a[140:143], v[60:63], v[76:79]
    buffer_load_dword v25, v5, s[4:7], s80 offen sc1
    v_mfma_f32_16x16x32_bf16 v[80:83], a[220:223], v[56:59], v[80:83]
    v_mfma_f32_16x16x32_bf16 v[84:87], a[220:223], v[60:63], v[84:87]
    s_waitcnt lgkmcnt(4)
    v_mfma_f32_16x16x32_bf16 v[64:67], a[64:67], v[32:35], v[64:67]
    ds_read_b128 v[56:59], v19 offset:9216
    v_mfma_f32_16x16x32_bf16 v[68:71], a[64:67], v[36:39], v[68:71]
    ds_read_b128 v[60:63], v19 offset:29696
    v_mfma_f32_16x16x32_bf16 v[72:75], a[144:147], v[32:35], v[72:75]
    v_mfma_f32_16x16x32_bf16 v[76:79], a[144:147], v[36:39], v[76:79]
    v_mfma_f32_16x16x32_bf16 v[80:83], a[224:227], v[32:35], v[80:83]
    v_mfma_f32_16x16x32_bf16 v[84:87], a[224:227], v[36:39], v[84:87]
    s_waitcnt lgkmcnt(4)
    v_mfma_f32_16x16x32_bf16 v[64:67], a[68:71], v[40:43], v[64:67]
    v_mfma_f32_16x16x32_bf16 v[68:71], a[68:71], v[44:47], v[68:71]
    v_mfma_f32_16x16x32_bf16 v[72:75], a[148:151], v[40:43], v[72:75]
    v_mfma_f32_16x16x32_bf16 v[76:79], a[148:151], v[44:47], v[76:79]
    v_mfma_f32_16x16x32_bf16 v[80:83], a[228:231], v[40:43], v[80:83]
    v_mfma_f32_16x16x32_bf16 v[84:87], a[228:231], v[44:47], v[84:87]
    s_waitcnt lgkmcnt(2)
    v_mfma_f32_16x16x32_bf16 v[64:67], a[72:75], v[48:51], v[64:67]
    v_mfma_f32_16x16x32_bf16 v[68:71], a[72:75], v[52:55], v[68:71]
    v_mfma_f32_16x16x32_bf16 v[72:75], a[152:155], v[48:51], v[72:75]
    v_mfma_f32_16x16x32_bf16 v[76:79], a[152:155], v[52:55], v[76:79]
    v_mfma_f32_16x16x32_bf16 v[80:83], a[232:235], v[48:51], v[80:83]
    v_mfma_f32_16x16x32_bf16 v[84:87], a[232:235], v[52:55], v[84:87]
    s_waitcnt lgkmcnt(0)
    v_mfma_f32_16x16x32_bf16 v[64:67], a[76:79], v[56:59], v[64:67]
    v_mfma_f32_16x16x32_bf16 v[68:71], a[76:79], v[60:63], v[68:71]
    v_mfma_f32_16x16x32_bf16 v[72:75], a[156:159], v[56:59], v[72:75]
    v_mfma_f32_16x16x32_bf16 v[76:79], a[156:159], v[60:63], v[76:79]
    v_mfma_f32_16x16x32_bf16 v[80:83], a[236:239], v[56:59], v[80:83]
    v_mfma_f32_16x16x32_bf16 v[84:87], a[236:239], v[60:63], v[84:87]
    v_xor_b32 v17, 49152, v17
    v_xor_b32 v19, 49152, v19
    v_cvt_pk_bf16_f32 v88, v64, v65
    v_cvt_pk_bf16_f32 v89, v66, v67
    v_cvt_pk_bf16_f32 v90, v68, v69
    v_cvt_pk_bf16_f32 v91, v70, v71
    v_cvt_pk_bf16_f32 v92, v72, v73
    v_cvt_pk_bf16_f32 v93, v74, v75
    v_cvt_pk_bf16_f32 v94, v76, v77
    v_cvt_pk_bf16_f32 v95, v78, v79
    v_cvt_pk_bf16_f32 v96, v80, v81
    v_cvt_pk_bf16_f32 v97, v82, v83
    v_cvt_pk_bf16_f32 v98, v84, v85
    v_cvt_pk_bf16_f32 v99, v86, v87
    ds_write_b64 v20, v[88:89] offset:0
    ds_write_b64 v20, v[92:93] offset:512
    ds_write_b64 v20, v[96:97] offset:1024
    ds_write_b64 v20, v[90:91] offset:6144
    ds_write_b64 v20, v[94:95] offset:6656
    ds_write_b64 v20, v[98:99] offset:7168
L_q_nog:
    s_cmp_eq_u32 s87, 0
    s_cbranch_scc1 L_q_noa
    v_mfma_f32_16x16x32_bf16 v[196:199], v[100:103], v[172:175], 0
    v_mfma_f32_16x16x32_bf16 v[200:203], v[124:127], v[172:175], 0
    v_mfma_f32_16x16x32_bf16 v[196:199], v[104:107], v[176:179], v[196:199]
    v_mfma_f32_16x16x32_bf16 v[200:203], v[128:131], v[176:179], v[200:203]
    v_mfma_f32_16x16x32_bf16 v[196:199], v[108:111], v[180:183], v[196:199]
    v_mfma_f32_16x16x32_bf16 v[200:203], v[132:135], v[180:183], v[200:203]
    v_mfma_f32_16x16x32_bf16 v[196:199], v[112:115], v[184:187], v[196:199]
    v_mfma_f32_16x16x32_bf16 v[200:203], v[136:139], v[184:187], v[200:203]
    v_mfma_f32_16x16x32_bf16 v[196:199], v[116:119], v[188:191], v[196:199]
    v_mfma_f32_16x16x32_bf16 v[200:203], v[140:143], v[188:191], v[200:203]
    v_mfma_f32_16x16x32_bf16 v[196:199], v[120:123], v[192:195], v[196:199]
    v_mfma_f32_16x16x32_bf16 v[200:203], v[144:147], v[192:195], v[200:203]
    s_cmp_eq_u32 s87, 2
    s_cbranch_scc1 L_q_km
    s_cmp_eq_u32 s90, 64
    s_cbranch_scc1 L_q_kl
Lwf_108:
    buffer_load_dword v6, v5, s[4:7], s80 offen sc1
    s_waitcnt vmcnt(0)
    v_cmp_gt_u32 vcc, s90, v6
    s_cbranch_vccz Lwfd_109
    s_sleep 1
    s_sub_u32 s27, s27, 1
    s_cbranch_scc1 L_exit
    s_branch Lwf_108
Lwfd_109:
    buffer_load_dwordx4 v[148:151], v22, s[4:7], s78 offen offset:0 sc1
    buffer_load_dwordx4 v[152:155], v22, s[4:7], s78 offen offset:512 sc1
    buffer_load_dwordx4 v[156:159], v22, s[4:7], s78 offen offset:1024 sc1
    buffer_load_dwordx4 v[160:163], v22, s[4:7], s78 offen offset:1536 sc1
    buffer_load_dwordx4 v[164:167], v22, s[4:7], s78 offen offset:2048 sc1
    buffer_load_dwordx4 v[168:171], v22, s[4:7], s78 offen offset:2560 sc1
    s_add_u32 s78, s78, 6144
L_q_km:
    s_nop 7
    v_cndmask_b32 v196, v24, v196, s[32:33]
    v_cndmask_b32 v197, v24, v197, s[34:35]
    v_cndmask_b32 v198, v24, v198, s[36:37]
    v_cndmask_b32 v199, v24, v199, s[38:39]
    v_cndmask_b32 v200, v24, v200, s[40:41]
    v_cndmask_b32 v201, v24, v201, s[42:43]
    v_cndmask_b32 v202, v24, v202, s[44:45]
    v_cndmask_b32 v203, v24, v203, s[46:47]
    s_waitcnt vmcnt(0)
    v_mfma_f32_16x16x32_bf16 v[204:207], v[148:151], v[172:175], v[216:219]
    v_mfma_f32_16x16x32_bf16 v[204:207], v[152:155], v[176:179], v[204:207]
    v_mfma_f32_16x16x32_bf16 v[204:207], v[156:159], v[180:183], v[204:207]
    v_mfma_f32_16x16x32_bf16 v[204:207], v[160:163], v[184:187], v[204:207]
    v_mfma_f32_16x16x32_bf16 v[204:207], v[164:167], v[188:191], v[204:207]
    v_mfma_f32_16x16x32_bf16 v[204:207], v[168:171], v[192:195], v[204:207]
    v_max3_f32 v6, v196, v197, v198
    v_max3_f32 v7, v199, v200, v201
    v_max3_f32 v6, v6, v202, v203
    s_nop 4
    v_max3_f32 v7, v7, v204, v205
    v_max3_f32 v6, v6, v206, v207
    v_max_f32 v6, v6, v7
    v_mov_b32 v7, v6
    s_nop 1
    v_permlane16_swap_b32 v7, v6
    v_max_f32 v6, v6, v7
    v_mov_b32 v7, v6
    s_nop 1
    v_permlane32_swap_b32 v7, v6
    v_max_f32 v6, v6, v7
    v_mul_f32 v6, s84, v6
    v_fma_f32 v196, v196, s84, -v6
    v_fma_f32 v197, v197, s84, -v6
    v_fma_f32 v198, v198, s84, -v6
    v_fma_f32 v199, v199, s84, -v6
    v_fma_f32 v200, v200, s84, -v6
    v_fma_f32 v201, v201, s84, -v6
    v_fma_f32 v202, v202, s84, -v6
    v_fma_f32 v203, v203, s84, -v6
    v_fma_f32 v204, v204, s84, -v6
    v_fma_f32 v205, v205, s84, -v6
    v_fma_f32 v206, v206, s84, -v6
    v_fma_f32 v207, v207, s84, -v6
    v_exp_f32 v196, v196
    v_exp_f32 v197, v197
    v_exp_f32 v198, v198
    v_exp_f32 v199, v199
    v_exp_f32 v200, v200
    v_exp_f32 v201, v201
    v_exp_f32 v202, v202
    v_exp_f32 v203, v203
    v_exp_f32 v204, v204
    v_exp_f32 v205, v205
    v_exp_f32 v206, v206
    v_exp_f32 v207, v207
    v_add_f32 v6, v196, v197
    v_add_f32 v7, v198, v199
    v_add_f32 v6, v6, v200
    v_add_f32 v7, v7, v201
    v_add_f32 v6, v6, v202
    v_add_f32 v7, v7, v203
    v_add_f32 v6, v6, v204
    v_add_f32 v7, v7, v205
    v_add_f32 v6, v6, v206
    v_add_f32 v7, v7, v207
    v_add_f32 v6, v6, v7
    v_mov_b32 v7, v6
    s_nop 1
    v_permlane16_swap_b32 v7, v6
    v_add_f32 v6, v6, v7
    v_mov_b32 v7, v6
    s_nop 1
    v_permlane32_swap_b32 v7, v6
    v_add_f32 v6, v6, v7
    v_rcp_f32 v6, v6
    s_nop 0
    v_mul_f32 v196, v196, v6
    v_mul_f32 v197, v197, v6
    v_mul_f32 v198, v198, v6
    v_mul_f32 v199, v199, v6
    v_mul_f32 v200, v200, v6
    v_mul_f32 v201, v201, v6
    v_mul_f32 v202, v202, v6
    v_mul_f32 v203, v203, v6
    v_mul_f32 v204, v204, v6
    v_mul_f32 v205, v205, v6
    v_mul_f32 v206, v206, v6
    v_mul_f32 v207, v207, v6
    v_cvt_pk_bf16_f32 v208, v196, v197
    v_cvt_pk_bf16_f32 v209, v198, v199
    v_cvt_pk_bf16_f32 v210, v200, v201
    v_cvt_pk_bf16_f32 v211, v202, v203
    v_cvt_pk_bf16_f32 v212, v204, v205
    v_cvt_pk_bf16_f32 v213, v206, v207
    buffer_store_dwordx4 v[208:211], v4, s[4:7], s82 offen sc1
    s_mov_b32 exec_hi, 0
    buffer_store_dwordx2 v[212:213], v23, s[4:7], s83 offen sc1
    s_mov_b64 exec, -1
    s_add_u32 s82, s82, 327680
    s_add_u32 s83, s83, 327680
    s_cmp_eq_u32 s26, 64
    s_cbranch_scc1 L_q_fin
    s_waitcnt lgkmcnt(0)
    s_barrier
    s_branch L_q_rd
L_q_noa:
    s_waitcnt vmcnt(0) lgkmcnt(0)
    s_barrier
    s_cmp_lg_u32 s24, 0
    s_cbranch_scc1 L_q_rd
    s_max_u32 s29, s26, 1
    s_sub_u32 s29, s29, 1
    v_mov_b32 v6, s29
    s_mov_b64 exec, 1
    buffer_store_dword v6, v5, s[4:7], s81 offen sc1
    s_mov_b64 exec, -1
L_q_rd:
    s_and_b32 s28, s26, 1
    s_cmp_lg_u32 s28, s89
    s_cbranch_scc1 L_q_next
    ds_read2st64_b64 v[172:175], v21 offset0:0 offset1:1
    ds_read2st64_b64 v[176:179], v21 offset0:2 offset1:3
    ds_read2st64_b64 v[180:183], v21 offset0:4 offset1:5
    ds_read2st64_b64 v[184:187], v21 offset0:6 offset1:7
    ds_read2st64_b64 v[188:191], v21 offset0:8 offset1:9
    ds_read2st64_b64 v[192:195], v21 offset0:10 offset1:11
    s_waitcnt lgkmcnt(2)
    ds_read2st64_b64 v[100:103], v18 offset0:0 offset1:1
    ds_read2st64_b64 v[104:107], v18 offset0:2 offset1:3
    ds_read2st64_b64 v[108:111], v18 offset0:4 offset1:5
    ds_read2st64_b64 v[112:115], v18 offset0:6 offset1:7
    ds_read2st64_b64 v[116:119], v18 offset0:8 offset1:9
    ds_read2st64_b64 v[120:123], v18 offset0:10 offset1:11
    ds_read2st64_b64 v[124:127], v18 offset0:12 offset1:13
    ds_read2st64_b64 v[128:131], v18 offset0:14 offset1:15
    ds_read2st64_b64 v[132:135], v18 offset0:16 offset1:17
    ds_read2st64_b64 v[136:139], v18 offset0:18 offset1:19
    ds_read2st64_b64 v[140:143], v18 offset0:20 offset1:21
    ds_read2st64_b64 v[144:147], v18 offset0:22 offset1:23
    s_waitcnt lgkmcnt(0)
L_q_next:
    s_add_u32 s26, s26, 1
    s_branch L_q_top
L_q_kl:
    buffer_load_dwordx4 v[148:151], v22, s[4:7], s78 offen offset:0 sc1
    buffer_load_dwordx4 v[152:155], v22, s[4:7], s78 offen offset:512 sc1
    buffer_load_dwordx4 v[156:159], v22, s[4:7], s78 offen offset:1024 sc1
    buffer_load_dwordx4 v[160:163], v22, s[4:7], s78 offen offset:1536 sc1
    buffer_load_dwordx4 v[164:167], v22, s[4:7], s78 offen offset:2048 sc1
    buffer_load_dwordx4 v[168:171], v22, s[4:7], s78 offen offset:2560 sc1
    s_add_u32 s78, s78, 6144
    s_sub_u32 s78, s78, 6144
    s_sub_u32 s27, s27, 1
    s_cbranch_scc1 L_exit
    s_waitcnt vmcnt(0)
    v_max3_u32 v6, v148, v149, v150
    v_max3_u32 v6, v6, v151, v152
    v_max3_u32 v6, v6, v153, v154
    v_max3_u32 v6, v6, v155, v156
    v_max3_u32 v6, v6, v157, v158
    v_max3_u32 v6, v6, v159, v160
    v_max3_u32 v6, v6, v161, v162
    v_max3_u32 v6, v6, v163, v164
    v_max3_u32 v6, v6, v165, v166
    v_max3_u32 v6, v6, v167, v168
    v_max3_u32 v6, v6, v169, v170
    v_max_u32 v6, v6, v171
    v_cmp_eq_u32 vcc, -1, v6
    s_cbranch_vccnz L_q_kl
    s_branch L_q_km
L_q_fin:
    s_waitcnt vmcnt(0)
    s_barrier
    s_cmp_lg_u32 s24, 0
    s_cbranch_scc1 L_q_end
    v_mov_b32 v6, s26
    s_mov_b64 exec, 1
    buffer_store_dword v6, v5, s[4:7], s81 offen sc1
    s_mov_b64 exec, -1
L_q_end:
    s_endpgm
L_s5:
    s_cmp_lg_u32 s24, 0
    s_cbranch_scc1 Lgod_111
    v_mov_b32 v5, 132
Lgo_110:
    buffer_load_dword v6, v5, s[20:23], 0 offen sc1
    s_waitcnt vmcnt(0)
    v_cmp_eq_u32 vcc, 0, v6
    s_cbranch_vccz Lgod_111
    s_sleep 2
    s_sub_u32 s27, s27, 1
    s_cbranch_scc1 L_exit
    s_branch Lgo_110
Lgod_111:
    s_barrier
    s_mul_i32 s74, s24, 10240
    s_mov_b32 s75, s74
    s_and_b32 s28, s24, 1
    s_lshl_b32 s28, s28, 2
    v_add_u32 v17, s28, v3
    v_and_b32 v19, 7, v1
    v_xor_b32 v17, v17, v19
    v_lshrrev_b32 v19, 3, v1
    v_mul_u32_u24 v16, 1280, v19
    v_lshl_add_u32 v16, v17, 4, v16
    s_and_b32 s28, s24, 1
    s_lshl_b32 s29, s28, 7
    v_add_u32 v31, 128, v16
    v_subrev_u32 v31, s29, v31
    v_add_u32 v16, s29, v16
    s_lshl_b32 s29, s28, 10
    s_add_u32 s75, s75, s29
    s_lshl_b32 s29, s28, 11
    s_sub_u32 s92, 1024, s29
    s_add_u32 s93, s29, 768
    v_lshrrev_b32 v19, 1, v2
    v_xor_b32 v19, v19, v3
    v_lshlrev_b32 v17, 4, v19
    v_and_b32 v19, 7, v2
    v_lshl_add_u32 v17, v19, 7, v17
    v_lshrrev_b32 v19, 3, v2
    v_mul_u32_u24 v19, 10240, v19
    v_add_u32 v17, v17, v19
    v_xor_b32 v19, 64, v17
    s_mov_b32 m0, s75
    s_nop 0
    buffer_load_dwordx4 v16, s[8:11], s74 offen offset:0 lds
    s_add_u32 m0, m0, s92
    s_nop 0
    buffer_load_dwordx4 v31, s[8:11], s74 offen offset:0 lds
    s_add_u32 m0, m0, s93
    s_nop 0
    buffer_load_dwordx4 v16, s[8:11], s74 offen offset:256 lds
    s_add_u32 m0, m0, s92
    s_nop 0
    buffer_load_dwordx4 v31, s[8:11], s74 offen offset:256 lds
    s_add_u32 m0, m0, s93
    s_nop 0
    buffer_load_dwordx4 v16, s[8:11], s74 offen offset:512 lds
    s_add_u32 m0, m0, s92
    s_nop 0
    buffer_load_dwordx4 v31, s[8:11], s74 offen offset:512 lds
    s_add_u32 m0, m0, s93
    s_nop 0
    buffer_load_dwordx4 v16, s[8:11], s74 offen offset:768 lds
    s_add_u32 m0, m0, s92
    s_nop 0
    buffer_load_dwordx4 v31, s[8:11], s74 offen offset:768 lds
    s_add_u32 m0, m0, s93
    s_nop 0
    buffer_load_dwordx4 v16, s[8:11], s74 offen offset:1024 lds
    s_add_u32 m0, m0, s92
    s_nop 0
    buffer_load_dwordx4 v31, s[8:11], s74 offen offset:1024 lds
    s_lshl_b32 s76, s25, 2
    s_add_u32 s76, s76, s24
    s_mov_b32 s12, s52
    s_mov_b32 s13, s53
    s_mov_b32 s14, 0xc8000
    s_mov_b32 s15, 0x20000
    s_mov_b32 s16, s54
    s_mov_b32 s17, s55
    s_mov_b32 s18, 0xc8000
    s_mov_b32 s19, 0x20000
    s_mov_b32 s20, s48
    s_mov_b32 s21, s49
    s_mov_b32 s22, 0x500
    s_mov_b32 s23, 0x20000
    s_mov_b32 s80, s50
    s_mov_b32 s81, s51
    s_mov_b32 s82, 0x500
    s_mov_b32 s83, 0x20000
    s_mov_b32 s84, s60
    s_mov_b32 s85, s61
    s_mov_b32 s86, 0x500
    s_mov_b32 s87, 0x20000
    v_lshlrev_b32 v6, 1, v2
    s_lshl_b32 s28, s76, 5
    buffer_load_ushort v24, v6, s[20:23], s28 offen
    buffer_load_ushort v25, v6, s[80:83], s28 offen
    buffer_load_ushort v26, v6, s[84:87], s28 offen
    v_mul_u32_u24 v21, 1280, v2
    v_lshl_add_u32 v21, v3, 4, v21
    s_mul_i32 s28, s76, 20480
    buffer_load_dwordx4 a[0:3], v21, s[12:15], s28 offen offset:0
    buffer_load_dwordx4 a[4:7], v21, s[12:15], s28 offen offset:64
    buffer_load_dwordx4 a[8:11], v21, s[12:15], s28 offen offset:128
    buffer_load_dwordx4 a[12:15], v21, s[12:15], s28 offen offset:192
    buffer_load_dwordx4 a[16:19], v21, s[12:15], s28 offen offset:256
    buffer_load_dwordx4 a[20:23], v21, s[12:15], s28 offen offset:320
    buffer_load_dwordx4 a[24:27], v21, s[12:15], s28 offen offset:384
    buffer_load_dwordx4 a[28:31], v21, s[12:15], s28 offen offset:448
    buffer_load_dwordx4 a[32:35], v21, s[12:15], s28 offen offset:512
    buffer_load_dwordx4 a[36:39], v21, s[12:15], s28 offen offset:576
    buffer_load_dwordx4 a[40:43], v21, s[12:15], s28 offen offset:640
    buffer_load_dwordx4 a[44:47], v21, s[12:15], s28 offen offset:704
    buffer_load_dwordx4 a[48:51], v21, s[12:15], s28 offen offset:768
    buffer_load_dwordx4 a[52:55], v21, s[12:15], s28 offen offset:832
    buffer_load_dwordx4 a[56:59], v21, s[12:15], s28 offen offset:896
    buffer_load_dwordx4 a[60:63], v21, s[12:15], s28 offen offset:960
    buffer_load_dwordx4 a[64:67], v21, s[12:15], s28 offen offset:1024
    buffer_load_dwordx4 a[68:71], v21, s[12:15], s28 offen offset:1088
    buffer_load_dwordx4 a[72:75], v21, s[12:15], s28 offen offset:1152
    buffer_load_dwordx4 a[76:79], v21, s[12:15], s28 offen offset:1216
    buffer_load_dwordx4 a[80:83], v21, s[16:19], s28 offen offset:0
    buffer_load_dwordx4 a[84:87], v21, s[16:19], s28 offen offset:64
    buffer_load_dwordx4 a[88:91], v21, s[16:19], s28 offen offset:128
    buffer_load_dwordx4 a[92:95], v21, s[16:19], s28 offen offset:192
    buffer_load_dwordx4 a[96:99], v21, s[16:19], s28 offen offset:256
    buffer_load_dwordx4 a[100:103], v21, s[16:19], s28 offen offset:320
    buffer_load_dwordx4 a[104:107], v21, s[16:19], s28 offen offset:384
    buffer_load_dwordx4 a[108:111], v21, s[16:19], s28 offen offset:448
    buffer_load_dwordx4 a[112:115], v21, s[16:19], s28 offen offset:512
    buffer_load_dwordx4 a[116:119], v21, s[16:19], s28 offen offset:576
    buffer_load_dwordx4 a[120:123], v21, s[16:19], s28 offen offset:640
    buffer_load_dwordx4 a[124:127], v21, s[16:19], s28 offen offset:704
    buffer_load_dwordx4 a[128:131], v21, s[16:19], s28 offen offset:768
    buffer_load_dwordx4 a[132:135], v21, s[16:19], s28 offen offset:832
    buffer_load_dwordx4 a[136:139], v21, s[16:19], s28 offen offset:896
    buffer_load_dwordx4 a[140:143], v21, s[16:19], s28 offen offset:960
    buffer_load_dwordx4 a[144:147], v21, s[16:19], s28 offen offset:1024
    buffer_load_dwordx4 a[148:151], v21, s[16:19], s28 offen offset:1088
    buffer_load_dwordx4 a[152:155], v21, s[16:19], s28 offen offset:1152
    buffer_load_dwordx4 a[156:159], v21, s[16:19], s28 offen offset:1216
    v_mov_b32 v5, 0
    s_lshl_b32 s28, s24, 10
    s_add_u32 s28, s28, 122880
    v_lshlrev_b32 v18, 5, v2
    v_lshl_add_u32 v18, v3, 3, v18
    v_add_u32 v18, s28, v18
    v_lshlrev_b32 v20, 3, v1
    v_add_u32 v20, s28, v20
    v_cmp_eq_u32 s[32:33], 1, v3
    v_cmp_eq_u32 s[34:35], 2, v3
    v_cmp_eq_u32 s[36:37], 3, v3
    s_lshl_b32 s77, s76, 10
    s_add_u32 s77, s77, 0x480a000
    s_lshl_b32 s78, s25, 7
    s_add_u32 s78, s78, 0xba15800
    s_waitcnt vmcnt(40)
    v_lshlrev_b32 v24, 16, v24
    v_lshlrev_b32 v25, 16, v25
    v_lshlrev_b32 v26, 16, v26
    v_mul_f32 v26, 0x3fb8aa3b, v26
    v_exp_f32 v26, v26
    s_nop 0
    v_cvt_pk_bf16_f32 v26, v26, v26
    v_lshlrev_b32 v26, 16, v26
    v_mul_f32 v27, v26, v24
    v_mul_f32 v28, v26, v25
    v_mul_f32 v27, 0x3fb8aa3b, v27
    v_exp_f32 v27, v27
    v_mul_f32 v28, 0.15915494, v28
    v_rndne_f32 v29, v28
    v_sub_f32 v28, v28, v29
    v_cos_f32 v29, v28
    v_sin_f32 v30, v28
    v_mul_f32 v80, v27, v29
    v_mul_f32 v81, v27, v30
    v_sub_f32 v82, 0, v81
    v_mov_b32 v83, 0
    v_mov_b32 v84, 0
    v_fmac_f32 v83, v80, v80
    v_fmac_f32 v84, v80, v81
    v_fmac_f32 v83, v82, v81
    v_fmac_f32 v84, v81, v80
    v_sub_f32 v85, 0, v84
    v_mov_b32 v86, 0
    v_mov_b32 v87, 0
    v_fmac_f32 v86, v80, v83
    v_fmac_f32 v87, v80, v84
    v_fmac_f32 v86, v82, v84
    v_fmac_f32 v87, v81, v83
    v_sub_f32 v88, 0, v87
    v_mov_b32 v89, 0
    v_mov_b32 v90, 0
    v_fmac_f32 v89, v80, v86
    v_fmac_f32 v90, v80, v87
    v_fmac_f32 v89, v82, v87
    v_fmac_f32 v90, v81, v86
    v_sub_f32 v91, 0, v90
    v_add_f32 v27, -1.0, v80
    v_mul_f32 v28, v24, v24
    v_fmac_f32 v28, v25, v25
    v_rcp_f32 v28, v28
    s_nop 0
    v_add_f32 v28, v28, v28
    v_mul_f32 v29, v27, v24
    v_fmac_f32 v29, v81, v25
    v_mul_f32 v30, v27, v25
    v_fmac_f32 v30, v82, v24
    v_mul_f32 v94, v29, v28
    v_mul_f32 v95, v30, v28
    v_sub_f32 v96, 0, v94
    v_mov_b32 v92, 0
    v_mov_b32 v93, 0
    s_mov_b32 s80, s64
    s_mov_b32 s81, s65
    s_mov_b32 s82, 0x500
    s_mov_b32 s83, 0x20000
    s_and_b32 s28, s24, 1
    s_lshl_b32 s28, s28, 2
    v_add_u32 v6, s28, v3
    v_and_b32 v7, 7, v1
    v_xor_b32 v6, v6, v7
    v_lshlrev_b32 v6, 4, v6
    s_waitcnt vmcnt(0)
    buffer_load_dwordx4 v[200:203], v6, s[80:83], 0 offen offset:0
    buffer_load_dwordx4 v[204:207], v6, s[80:83], 0 offen offset:128
    buffer_load_dwordx4 v[208:211], v6, s[80:83], 0 offen offset:256
    buffer_load_dwordx4 v[212:215], v6, s[80:83], 0 offen offset:384
    buffer_load_dwordx4 v[216:219], v6, s[80:83], 0 offen offset:512
    buffer_load_dwordx4 v[220:223], v6, s[80:83], 0 offen offset:640
    buffer_load_dwordx4 v[224:227], v6, s[80:83], 0 offen offset:768
    buffer_load_dwordx4 v[228:231], v6, s[80:83], 0 offen offset:896
    buffer_load_dwordx4 v[232:235], v6, s[80:83], 0 offen offset:1024
    buffer_load_dwordx4 v[236:239], v6, s[80:83], 0 offen offset:1152
    s_mul_i32 s28, s24, 10240
    v_add_u32 v22, s28, v4
    v_lshrrev_b32 v23, 3, v1
    v_lshlrev_b32 v23, 2, v23
    s_lshl_b32 s28, s24, 5
    v_add_u32 v23, s28, v23
    s_mov_b32 s79, s25
    s_waitcnt vmcnt(0)
    v_lshlrev_b32 v120, 16, v200
    v_and_b32 v121, 0xffff0000, v200
    v_lshlrev_b32 v122, 16, v201
    v_and_b32 v123, 0xffff0000, v201
    v_lshlrev_b32 v124, 16, v202
    v_and_b32 v125, 0xffff0000, v202
    v_lshlrev_b32 v126, 16, v203
    v_and_b32 v127, 0xffff0000, v203
    v_lshlrev_b32 v128, 16, v204
    v_and_b32 v129, 0xffff0000, v204
    v_lshlrev_b32 v130, 16, v205
    v_and_b32 v131, 0xffff0000, v205
    v_lshlrev_b32 v132, 16, v206
    v_and_b32 v133, 0xffff0000, v206
    v_lshlrev_b32 v134, 16, v207
    v_and_b32 v135, 0xffff0000, v207
    v_lshlrev_b32 v136, 16, v208
    v_and_b32 v137, 0xffff0000, v208
    v_lshlrev_b32 v138, 16, v209
    v_and_b32 v139, 0xffff0000, v209
    v_lshlrev_b32 v140, 16, v210
    v_and_b32 v141, 0xffff0000, v210
    v_lshlrev_b32 v142, 16, v211
    v_and_b32 v143, 0xffff0000, v211
    v_lshlrev_b32 v144, 16, v212
    v_and_b32 v145, 0xffff0000, v212
    v_lshlrev_b32 v146, 16, v213
    v_and_b32 v147, 0xffff0000, v213
    v_lshlrev_b32 v148, 16, v214
    v_and_b32 v149, 0xffff0000, v214
    v_lshlrev_b32 v150, 16, v215
    v_and_b32 v151, 0xffff0000, v215
    v_lshlrev_b32 v152, 16, v216
    v_and_b32 v153, 0xffff0000, v216
    v_lshlrev_b32 v154, 16, v217
    v_and_b32 v155, 0xffff0000, v217
    v_lshlrev_b32 v156, 16, v218
    v_and_b32 v157, 0xffff0000, v218
    v_lshlrev_b32 v158, 16, v219
    v_and_b32 v159, 0xffff0000, v219
    v_lshlrev_b32 v160, 16, v220
    v_and_b32 v161, 0xffff0000, v220
    v_lshlrev_b32 v162, 16, v221
    v_and_b32 v163, 0xffff0000, v221
    v_lshlrev_b32 v164, 16, v222
    v_and_b32 v165, 0xffff0000, v222
    v_lshlrev_b32 v166, 16, v223
    v_and_b32 v167, 0xffff0000, v223
    v_lshlrev_b32 v168, 16, v224
    v_and_b32 v169, 0xffff0000, v224
    v_lshlrev_b32 v170, 16, v225
    v_and_b32 v171, 0xffff0000, v225
    v_lshlrev_b32 v172, 16, v226
    v_and_b32 v173, 0xffff0000, v226
    v_lshlrev_b32 v174, 16, v227
    v_and_b32 v175, 0xffff0000, v227
    v_lshlrev_b32 v176, 16, v228
    v_and_b32 v177, 0xffff0000, v228
    v_lshlrev_b32 v178, 16, v229
    v_and_b32 v179, 0xffff0000, v229
    v_lshlrev_b32 v180, 16, v230
    v_and_b32 v181, 0xffff0000, v230
    v_lshlrev_b32 v182, 16, v231
    v_and_b32 v183, 0xffff0000, v231
    v_lshlrev_b32 v184, 16, v232
    v_and_b32 v185, 0xffff0000, v232
    v_lshlrev_b32 v186, 16, v233
    v_and_b32 v187, 0xffff0000, v233
    v_lshlrev_b32 v188, 16, v234
    v_and_b32 v189, 0xffff0000, v234
    v_lshlrev_b32 v190, 16, v235
    v_and_b32 v191, 0xffff0000, v235
    v_lshlrev_b32 v192, 16, v236
    v_and_b32 v193, 0xffff0000, v236
    v_lshlrev_b32 v194, 16, v237
    v_and_b32 v195, 0xffff0000, v237
    v_lshlrev_b32 v196, 16, v238
    v_and_b32 v197, 0xffff0000, v238
    v_lshlrev_b32 v198, 16, v239
    v_and_b32 v199, 0xffff0000, v239
    s_cmp_eq_u32 s24, 0
    s_cselect_b32 s89, s78, 0x10000000
    s_mov_b32 s87, 0
    s_mov_b32 s88, 40960
    s_add_u32 s74, s74, 40960
    s_add_u32 m0, s88, s75
    s_add_u32 s88, s88, 40960
    s_cmp_eq_u32 s88, 122880
    s_cselect_b32 s88, 0, s88
    buffer_load_dwordx4 v16, s[8:11], s74 offen offset:0 lds
    s_add_u32 m0, m0, s92
    s_nop 0
    buffer_load_dwordx4 v31, s[8:11], s74 offen offset:0 lds
    s_add_u32 m0, m0, s93
    s_nop 0
    buffer_load_dwordx4 v16, s[8:11], s74 offen offset:256 lds
    s_add_u32 m0, m0, s92
    s_nop 0
    buffer_load_dwordx4 v31, s[8:11], s74 offen offset:256 lds
    s_add_u32 m0, m0, s93
    s_nop 0
    buffer_load_dwordx4 v16, s[8:11], s74 offen offset:512 lds
    s_add_u32 m0, m0, s92
    s_nop 0
    buffer_load_dwordx4 v31, s[8:11], s74 offen offset:512 lds
    s_add_u32 m0, m0, s93
    s_nop 0
    buffer_load_dwordx4 v16, s[8:11], s74 offen offset:768 lds
    s_add_u32 m0, m0, s92
    s_nop 0
    buffer_load_dwordx4 v31, s[8:11], s74 offen offset:768 lds
    s_add_u32 m0, m0, s93
    s_nop 0
    buffer_load_dwordx4 v16, s[8:11], s74 offen offset:1024 lds
    s_add_u32 m0, m0, s92
    s_nop 0
    buffer_load_dwordx4 v31, s[8:11], s74 offen offset:1024 lds
    s_waitcnt vmcnt(10)
    s_barrier
    ds_read_b128 v[32:35], v17 offset:0
    ds_read_b128 v[36:39], v17 offset:20480
    ds_read_b128 v[40:43], v19 offset:0
    ds_read_b128 v[44:47], v19 offset:20480
    ds_read_b128 v[48:51], v17 offset:1024
    ds_read_b128 v[52:55], v17 offset:21504
    s_waitcnt lgkmcnt(0)
    s_branch L_s5_go
L_s5_now:
    v_fmac_f32 v241, v80, v240
    v_fmac_f32 v245, v80, v244
    v_fmac_f32 v241, v82, v244
    v_fmac_f32 v245, v81, v240
    v_fmac_f32 v242, v80, v241
    v_fmac_f32 v246, v80, v245
    v_fmac_f32 v242, v82, v245
    v_fmac_f32 v246, v81, v241
    v_fmac_f32 v243, v80, v242
    v_fmac_f32 v247, v80, v246
    v_fmac_f32 v243, v82, v246
    v_fmac_f32 v247, v81, v242
    v_mov_b32 v100, v243
    v_mov_b32 v101, v243
    s_nop 1
    v_permlane16_swap_b32 v100, v101
    v_mov_b32 v102, v100
    v_mov_b32 v103, v101
    s_nop 0
    v_permlane32_swap_b32 v100, v102
    v_permlane32_swap_b32 v101, v103
    v_mov_b32 v104, v247
    v_mov_b32 v105, v247
    s_nop 1
    v_permlane16_swap_b32 v104, v105
    v_mov_b32 v106, v104
    v_mov_b32 v107, v105
    s_nop 0
    v_permlane32_swap_b32 v104, v106
    v_permlane32_swap_b32 v105, v107
    v_fmac_f32 v100, v89, v92
    v_fmac_f32 v104, v89, v93
    v_fmac_f32 v100, v91, v93
    v_fmac_f32 v104, v90, v92
    v_fmac_f32 v101, v89, v100
    v_fmac_f32 v105, v89, v104
    v_fmac_f32 v101, v91, v104
    v_fmac_f32 v105, v90, v100
    v_fmac_f32 v102, v89, v101
    v_fmac_f32 v106, v89, v105
    v_fmac_f32 v102, v91, v105
    v_fmac_f32 v106, v90, v101
    v_fmac_f32 v103, v89, v102
    v_fmac_f32 v107, v89, v106
    v_fmac_f32 v103, v91, v106
    v_fmac_f32 v107, v90, v102
    v_cndmask_b32 v108, v92, v100, s[32:33]
    v_cndmask_b32 v108, v108, v101, s[34:35]
    v_cndmask_b32 v108, v108, v102, s[36:37]
    v_cndmask_b32 v109, v93, v104, s[32:33]
    v_cndmask_b32 v109, v109, v105, s[34:35]
    v_cndmask_b32 v109, v109, v106, s[36:37]
    v_mov_b32 v92, v103
    v_mov_b32 v93, v107
    v_fmac_f32 v240, v80, v108
    v_fmac_f32 v244, v80, v109
    v_fmac_f32 v240, v82, v109
    v_fmac_f32 v244, v81, v108
    v_fmac_f32 v241, v83, v108
    v_fmac_f32 v245, v83, v109
    v_fmac_f32 v241, v85, v109
    v_fmac_f32 v245, v84, v108
    v_fmac_f32 v242, v86, v108
    v_fmac_f32 v246, v86, v109
    v_fmac_f32 v242, v88, v109
    v_fmac_f32 v246, v87, v108
    v_fmac_f32 v243, v89, v108
    v_fmac_f32 v247, v89, v109
    v_fmac_f32 v243, v91, v109
    v_fmac_f32 v247, v90, v108
    v_mul_f32 v112, v94, v240
    v_mul_f32 v116, v96, v244
    v_fmac_f32 v112, v95, v244
    v_fmac_f32 v116, v95, v240
    v_mul_f32 v113, v94, v241
    v_mul_f32 v117, v96, v245
    v_fmac_f32 v113, v95, v245
    v_fmac_f32 v117, v95, v241
    v_mul_f32 v114, v94, v242
    v_mul_f32 v118, v96, v246
    v_fmac_f32 v114, v95, v246
    v_fmac_f32 v118, v95, v242
    v_mul_f32 v115, v94, v243
    v_mul_f32 v119, v96, v247
    v_fmac_f32 v115, v95, v247
    v_fmac_f32 v119, v95, v243
    v_cvt_pk_bf16_f32 v100, v112, v113
    v_cvt_pk_bf16_f32 v101, v114, v115
    v_cvt_pk_bf16_f32 v102, v116, v117
    v_cvt_pk_bf16_f32 v103, v118, v119
    ds_write_b64 v18, v[100:101]
    ds_write_b64 v18, v[102:103] offset:512
    s_waitcnt lgkmcnt(0)
    ds_read_b64_tr_b16 v[24:25], v20
    ds_read_b64_tr_b16 v[26:27], v20 offset:512
    s_add_u32 s28, s77, 0
    s_waitcnt lgkmcnt(0)
    buffer_store_dwordx4 v[24:27], v4, s[4:7], s28 offen sc1
    v_fmac_f32 v249, v80, v248
    v_fmac_f32 v253, v80, v252
    v_fmac_f32 v249, v82, v252
    v_fmac_f32 v253, v81, v248
    v_fmac_f32 v250, v80, v249
    v_fmac_f32 v254, v80, v253
    v_fmac_f32 v250, v82, v253
    v_fmac_f32 v254, v81, v249
    v_fmac_f32 v251, v80, v250
    v_fmac_f32 v255, v80, v254
    v_fmac_f32 v251, v82, v254
    v_fmac_f32 v255, v81, v250
    v_mov_b32 v100, v251
    v_mov_b32 v101, v251
    s_nop 1
    v_permlane16_swap_b32 v100, v101
    v_mov_b32 v102, v100
    v_mov_b32 v103, v101
    s_nop 0
    v_permlane32_swap_b32 v100, v102
    v_permlane32_swap_b32 v101, v103
    v_mov_b32 v104, v255
    v_mov_b32 v105, v255
    s_nop 1
    v_permlane16_swap_b32 v104, v105
    v_mov_b32 v106, v104
    v_mov_b32 v107, v105
    s_nop 0
    v_permlane32_swap_b32 v104, v106
    v_permlane32_swap_b32 v105, v107
    v_fmac_f32 v100, v89, v92
    v_fmac_f32 v104, v89, v93
    v_fmac_f32 v100, v91, v93
    v_fmac_f32 v104, v90, v92
    v_fmac_f32 v101, v89, v100
    v_fmac_f32 v105, v89, v104
    v_fmac_f32 v101, v91, v104
    v_fmac_f32 v105, v90, v100
    v_fmac_f32 v102, v89, v101
    v_fmac_f32 v106, v89, v105
    v_fmac_f32 v102, v91, v105
    v_fmac_f32 v106, v90, v101
    v_fmac_f32 v103, v89, v102
    v_fmac_f32 v107, v89, v106
    v_fmac_f32 v103, v91, v106
    v_fmac_f32 v107, v90, v102
    v_cndmask_b32 v108, v92, v100, s[32:33]
    v_cndmask_b32 v108, v108, v101, s[34:35]
    v_cndmask_b32 v108, v108, v102, s[36:37]
    v_cndmask_b32 v109, v93, v104, s[32:33]
    v_cndmask_b32 v109, v109, v105, s[34:35]
    v_cndmask_b32 v109, v109, v106, s[36:37]
    v_mov_b32 v92, v103
    v_mov_b32 v93, v107
    v_fmac_f32 v248, v80, v108
    v_fmac_f32 v252, v80, v109
    v_fmac_f32 v248, v82, v109
    v_fmac_f32 v252, v81, v108
    v_fmac_f32 v249, v83, v108
    v_fmac_f32 v253, v83, v109
    v_fmac_f32 v249, v85, v109
    v_fmac_f32 v253, v84, v108
    v_fmac_f32 v250, v86, v108
    v_fmac_f32 v254, v86, v109
    v_fmac_f32 v250, v88, v109
    v_fmac_f32 v254, v87, v108
    v_fmac_f32 v251, v89, v108
    v_fmac_f32 v255, v89, v109
    v_fmac_f32 v251, v91, v109
    v_fmac_f32 v255, v90, v108
    v_mul_f32 v112, v94, v248
    v_mul_f32 v116, v96, v252
    v_fmac_f32 v112, v95, v252
    v_fmac_f32 v116, v95, v248
    v_mul_f32 v113, v94, v249
    v_mul_f32 v117, v96, v253
    v_fmac_f32 v113, v95, v253
    v_fmac_f32 v117, v95, v249
    v_mul_f32 v114, v94, v250
    v_mul_f32 v118, v96, v254
    v_fmac_f32 v114, v95, v254
    v_fmac_f32 v118, v95, v250
    v_mul_f32 v115, v94, v251
    v_mul_f32 v119, v96, v255
    v_fmac_f32 v115, v95, v255
    v_fmac_f32 v119, v95, v251
    v_cvt_pk_bf16_f32 v100, v112, v113
    v_cvt_pk_bf16_f32 v101, v114, v115
    v_cvt_pk_bf16_f32 v102, v116, v117
    v_cvt_pk_bf16_f32 v103, v118, v119
    ds_write_b64 v18, v[100:101]
    ds_write_b64 v18, v[102:103] offset:512
    s_waitcnt lgkmcnt(0)
    ds_read_b64_tr_b16 v[24:25], v20
    ds_read_b64_tr_b16 v[26:27], v20 offset:512
    s_add_u32 s28, s77, 81920
    s_waitcnt lgkmcnt(0)
    buffer_store_dwordx4 v[24:27], v4, s[4:7], s28 offen sc1
    s_add_u32 s77, s77, 163840
    s_waitcnt vmcnt(0) lgkmcnt(0)
    s_barrier
    v_mov_b32 v6, s26
    s_mov_b64 exec, 1
    buffer_store_dword v6, v5, s[4:7], s89 offen sc1
    s_mov_b64 exec, -1
    s_cmp_ge_u32 s26, 64
    s_cbranch_scc1 L_s5_end
L_s5_go:
    s_cmp_lg_u32 s79, s26
    s_cbranch_scc1 L_s5_noga
    s_add_u32 s79, s79, 10
    s_waitcnt lgkmcnt(0)
    ds_read_b128 v[200:203], v22 offset:0
    ds_read_b128 v[204:207], v22 offset:1024
    ds_read_b128 v[208:211], v22 offset:2048
    ds_read_b128 v[212:215], v22 offset:3072
    ds_read_b128 v[216:219], v22 offset:4096
    ds_read_b128 v[220:223], v22 offset:5120
    ds_read_b128 v[224:227], v22 offset:6144
    ds_read_b128 v[228:231], v22 offset:7168
    ds_read_b128 v[232:235], v22 offset:8192
    ds_read_b128 v[236:239], v22 offset:9216
    v_mov_b32 v112, 0
    v_mov_b32 v113, 0
    s_waitcnt lgkmcnt(0)
    v_lshlrev_b32 v114, 16, v200
    v_and_b32 v115, 0xffff0000, v200
    v_mul_f32 v114, v114, v120
    v_mul_f32 v115, v115, v121
    v_cvt_pk_bf16_f32 v116, v114, v115
    v_lshlrev_b32 v114, 16, v116
    v_and_b32 v115, 0xffff0000, v116
    v_add_f32 v112, v112, v114
    v_add_f32 v113, v113, v115
    v_lshlrev_b32 v114, 16, v201
    v_and_b32 v115, 0xffff0000, v201
    v_mul_f32 v114, v114, v122
    v_mul_f32 v115, v115, v123
    v_cvt_pk_bf16_f32 v116, v114, v115
    v_lshlrev_b32 v114, 16, v116
    v_and_b32 v115, 0xffff0000, v116
    v_add_f32 v112, v112, v114
    v_add_f32 v113, v113, v115
    v_lshlrev_b32 v114, 16, v202
    v_and_b32 v115, 0xffff0000, v202
    v_mul_f32 v114, v114, v124
    v_mul_f32 v115, v115, v125
    v_cvt_pk_bf16_f32 v116, v114, v115
    v_lshlrev_b32 v114, 16, v116
    v_and_b32 v115, 0xffff0000, v116
    v_add_f32 v112, v112, v114
    v_add_f32 v113, v113, v115
    v_lshlrev_b32 v114, 16, v203
    v_and_b32 v115, 0xffff0000, v203
    v_mul_f32 v114, v114, v126
    v_mul_f32 v115, v115, v127
    v_cvt_pk_bf16_f32 v116, v114, v115
    v_lshlrev_b32 v114, 16, v116
    v_and_b32 v115, 0xffff0000, v116
    v_add_f32 v112, v112, v114
    v_add_f32 v113, v113, v115
    v_lshlrev_b32 v114, 16, v204
    v_and_b32 v115, 0xffff0000, v204
    v_mul_f32 v114, v114, v128
    v_mul_f32 v115, v115, v129
    v_cvt_pk_bf16_f32 v116, v114, v115
    v_lshlrev_b32 v114, 16, v116
    v_and_b32 v115, 0xffff0000, v116
    v_add_f32 v112, v112, v114
    v_add_f32 v113, v113, v115
    v_lshlrev_b32 v114, 16, v205
    v_and_b32 v115, 0xffff0000, v205
    v_mul_f32 v114, v114, v130
    v_mul_f32 v115, v115, v131
    v_cvt_pk_bf16_f32 v116, v114, v115
    v_lshlrev_b32 v114, 16, v116
    v_and_b32 v115, 0xffff0000, v116
    v_add_f32 v112, v112, v114
    v_add_f32 v113, v113, v115
    v_lshlrev_b32 v114, 16, v206
    v_and_b32 v115, 0xffff0000, v206
    v_mul_f32 v114, v114, v132
    v_mul_f32 v115, v115, v133
    v_cvt_pk_bf16_f32 v116, v114, v115
    v_lshlrev_b32 v114, 16, v116
    v_and_b32 v115, 0xffff0000, v116
    v_add_f32 v112, v112, v114
    v_add_f32 v113, v113, v115
    v_lshlrev_b32 v114, 16, v207
    v_and_b32 v115, 0xffff0000, v207
    v_mul_f32 v114, v114, v134
    v_mul_f32 v115, v115, v135
    v_cvt_pk_bf16_f32 v116, v114, v115
    v_lshlrev_b32 v114, 16, v116
    v_and_b32 v115, 0xffff0000, v116
    v_add_f32 v112, v112, v114
    v_add_f32 v113, v113, v115
    v_lshlrev_b32 v114, 16, v208
    v_and_b32 v115, 0xffff0000, v208
    v_mul_f32 v114, v114, v136
    v_mul_f32 v115, v115, v137
    v_cvt_pk_bf16_f32 v116, v114, v115
    v_lshlrev_b32 v114, 16, v116
    v_and_b32 v115, 0xffff0000, v116
    v_add_f32 v112, v112, v114
    v_add_f32 v113, v113, v115
    v_lshlrev_b32 v114, 16, v209
    v_and_b32 v115, 0xffff0000, v209
    v_mul_f32 v114, v114, v138
    v_mul_f32 v115, v115, v139
    v_cvt_pk_bf16_f32 v116, v114, v115
    v_lshlrev_b32 v114, 16, v116
    v_and_b32 v115, 0xffff0000, v116
    v_add_f32 v112, v112, v114
    v_add_f32 v113, v113, v115
    v_lshlrev_b32 v114, 16, v210
    v_and_b32 v115, 0xffff0000, v210
    v_mul_f32 v114, v114, v140
    v_mul_f32 v115, v115, v141
    v_cvt_pk_bf16_f32 v116, v114, v115
    v_lshlrev_b32 v114, 16, v116
    v_and_b32 v115, 0xffff0000, v116
    v_add_f32 v112, v112, v114
    v_add_f32 v113, v113, v115
    v_lshlrev_b32 v114, 16, v211
    v_and_b32 v115, 0xffff0000, v211
    v_mul_f32 v114, v114, v142
    v_mul_f32 v115, v115, v143
    v_cvt_pk_bf16_f32 v116, v114, v115
    v_lshlrev_b32 v114, 16, v116
    v_and_b32 v115, 0xffff0000, v116
    v_add_f32 v112, v112, v114
    v_add_f32 v113, v113, v115
    v_lshlrev_b32 v114, 16, v212
    v_and_b32 v115, 0xffff0000, v212
    v_mul_f32 v114, v114, v144
    v_mul_f32 v115, v115, v145
    v_cvt_pk_bf16_f32 v116, v114, v115
    v_lshlrev_b32 v114, 16, v116
    v_and_b32 v115, 0xffff0000, v116
    v_add_f32 v112, v112, v114
    v_add_f32 v113, v113, v115
    v_lshlrev_b32 v114, 16, v213
    v_and_b32 v115, 0xffff0000, v213
    v_mul_f32 v114, v114, v146
    v_mul_f32 v115, v115, v147
    v_cvt_pk_bf16_f32 v116, v114, v115
    v_lshlrev_b32 v114, 16, v116
    v_and_b32 v115, 0xffff0000, v116
    v_add_f32 v112, v112, v114
    v_add_f32 v113, v113, v115
    v_lshlrev_b32 v114, 16, v214
    v_and_b32 v115, 0xffff0000, v214
    v_mul_f32 v114, v114, v148
    v_mul_f32 v115, v115, v149
    v_cvt_pk_bf16_f32 v116, v114, v115
    v_lshlrev_b32 v114, 16, v116
    v_and_b32 v115, 0xffff0000, v116
    v_add_f32 v112, v112, v114
    v_add_f32 v113, v113, v115
    v_lshlrev_b32 v114, 16, v215
    v_and_b32 v115, 0xffff0000, v215
    v_mul_f32 v114, v114, v150
    v_mul_f32 v115, v115, v151
    v_cvt_pk_bf16_f32 v116, v114, v115
    v_lshlrev_b32 v114, 16, v116
    v_and_b32 v115, 0xffff0000, v116
    v_add_f32 v112, v112, v114
    v_add_f32 v113, v113, v115
    v_lshlrev_b32 v114, 16, v216
    v_and_b32 v115, 0xffff0000, v216
    v_mul_f32 v114, v114, v152
    v_mul_f32 v115, v115, v153
    v_cvt_pk_bf16_f32 v116, v114, v115
    v_lshlrev_b32 v114, 16, v116
    v_and_b32 v115, 0xffff0000, v116
    v_add_f32 v112, v112, v114
    v_add_f32 v113, v113, v115
    v_lshlrev_b32 v114, 16, v217
    v_and_b32 v115, 0xffff0000, v217
    v_mul_f32 v114, v114, v154
    v_mul_f32 v115, v115, v155
    v_cvt_pk_bf16_f32 v116, v114, v115
    v_lshlrev_b32 v114, 16, v116
    v_and_b32 v115, 0xffff0000, v116
    v_add_f32 v112, v112, v114
    v_add_f32 v113, v113, v115
    v_lshlrev_b32 v114, 16, v218
    v_and_b32 v115, 0xffff0000, v218
    v_mul_f32 v114, v114, v156
    v_mul_f32 v115, v115, v157
    v_cvt_pk_bf16_f32 v116, v114, v115
    v_lshlrev_b32 v114, 16, v116
    v_and_b32 v115, 0xffff0000, v116
    v_add_f32 v112, v112, v114
    v_add_f32 v113, v113, v115
    v_lshlrev_b32 v114, 16, v219
    v_and_b32 v115, 0xffff0000, v219
    v_mul_f32 v114, v114, v158
    v_mul_f32 v115, v115, v159
    v_cvt_pk_bf16_f32 v116, v114, v115
    v_lshlrev_b32 v114, 16, v116
    v_and_b32 v115, 0xffff0000, v116
    v_add_f32 v112, v112, v114
    v_add_f32 v113, v113, v115
    v_lshlrev_b32 v114, 16, v220
    v_and_b32 v115, 0xffff0000, v220
    v_mul_f32 v114, v114, v160
    v_mul_f32 v115, v115, v161
    v_cvt_pk_bf16_f32 v116, v114, v115
    v_lshlrev_b32 v114, 16, v116
    v_and_b32 v115, 0xffff0000, v116
    v_add_f32 v112, v112, v114
    v_add_f32 v113, v113, v115
    v_lshlrev_b32 v114, 16, v221
    v_and_b32 v115, 0xffff0000, v221
    v_mul_f32 v114, v114, v162
    v_mul_f32 v115, v115, v163
    v_cvt_pk_bf16_f32 v116, v114, v115
    v_lshlrev_b32 v114, 16, v116
    v_and_b32 v115, 0xffff0000, v116
    v_add_f32 v112, v112, v114
    v_add_f32 v113, v113, v115
    v_lshlrev_b32 v114, 16, v222
    v_and_b32 v115, 0xffff0000, v222
    v_mul_f32 v114, v114, v164
    v_mul_f32 v115, v115, v165
    v_cvt_pk_bf16_f32 v116, v114, v115
    v_lshlrev_b32 v114, 16, v116
    v_and_b32 v115, 0xffff0000, v116
    v_add_f32 v112, v112, v114
    v_add_f32 v113, v113, v115
    v_lshlrev_b32 v114, 16, v223
    v_and_b32 v115, 0xffff0000, v223
    v_mul_f32 v114, v114, v166
    v_mul_f32 v115, v115, v167
    v_cvt_pk_bf16_f32 v116, v114, v115
    v_lshlrev_b32 v114, 16, v116
    v_and_b32 v115, 0xffff0000, v116
    v_add_f32 v112, v112, v114
    v_add_f32 v113, v113, v115
    v_lshlrev_b32 v114, 16, v224
    v_and_b32 v115, 0xffff0000, v224
    v_mul_f32 v114, v114, v168
    v_mul_f32 v115, v115, v169
    v_cvt_pk_bf16_f32 v116, v114, v115
    v_lshlrev_b32 v114, 16, v116
    v_and_b32 v115, 0xffff0000, v116
    v_add_f32 v112, v112, v114
    v_add_f32 v113, v113, v115
    v_lshlrev_b32 v114, 16, v225
    v_and_b32 v115, 0xffff0000, v225
    v_mul_f32 v114, v114, v170
    v_mul_f32 v115, v115, v171
    v_cvt_pk_bf16_f32 v116, v114, v115
    v_lshlrev_b32 v114, 16, v116
    v_and_b32 v115, 0xffff0000, v116
    v_add_f32 v112, v112, v114
    v_add_f32 v113, v113, v115
    v_lshlrev_b32 v114, 16, v226
    v_and_b32 v115, 0xffff0000, v226
    v_mul_f32 v114, v114, v172
    v_mul_f32 v115, v115, v173
    v_cvt_pk_bf16_f32 v116, v114, v115
    v_lshlrev_b32 v114, 16, v116
    v_and_b32 v115, 0xffff0000, v116
    v_add_f32 v112, v112, v114
    v_add_f32 v113, v113, v115
    v_lshlrev_b32 v114, 16, v227
    v_and_b32 v115, 0xffff0000, v227
    v_mul_f32 v114, v114, v174
    v_mul_f32 v115, v115, v175
    v_cvt_pk_bf16_f32 v116, v114, v115
    v_lshlrev_b32 v114, 16, v116
    v_and_b32 v115, 0xffff0000, v116
    v_add_f32 v112, v112, v114
    v_add_f32 v113, v113, v115
    v_lshlrev_b32 v114, 16, v228
    v_and_b32 v115, 0xffff0000, v228
    v_mul_f32 v114, v114, v176
    v_mul_f32 v115, v115, v177
    v_cvt_pk_bf16_f32 v116, v114, v115
    v_lshlrev_b32 v114, 16, v116
    v_and_b32 v115, 0xffff0000, v116
    v_add_f32 v112, v112, v114
    v_add_f32 v113, v113, v115
    v_lshlrev_b32 v114, 16, v229
    v_and_b32 v115, 0xffff0000, v229
    v_mul_f32 v114, v114, v178
    v_mul_f32 v115, v115, v179
    v_cvt_pk_bf16_f32 v116, v114, v115
    v_lshlrev_b32 v114, 16, v116
    v_and_b32 v115, 0xffff0000, v116
    v_add_f32 v112, v112, v114
    v_add_f32 v113, v113, v115
    v_lshlrev_b32 v114, 16, v230
    v_and_b32 v115, 0xffff0000, v230
    v_mul_f32 v114, v114, v180
    v_mul_f32 v115, v115, v181
    v_cvt_pk_bf16_f32 v116, v114, v115
    v_lshlrev_b32 v114, 16, v116
    v_and_b32 v115, 0xffff0000, v116
    v_add_f32 v112, v112, v114
    v_add_f32 v113, v113, v115
    v_lshlrev_b32 v114, 16, v231
    v_and_b32 v115, 0xffff0000, v231
    v_mul_f32 v114, v114, v182
    v_mul_f32 v115, v115, v183
    v_cvt_pk_bf16_f32 v116, v114, v115
    v_lshlrev_b32 v114, 16, v116
    v_and_b32 v115, 0xffff0000, v116
    v_add_f32 v112, v112, v114
    v_add_f32 v113, v113, v115
    v_lshlrev_b32 v114, 16, v232
    v_and_b32 v115, 0xffff0000, v232
    v_mul_f32 v114, v114, v184
    v_mul_f32 v115, v115, v185
    v_cvt_pk_bf16_f32 v116, v114, v115
    v_lshlrev_b32 v114, 16, v116
    v_and_b32 v115, 0xffff0000, v116
    v_add_f32 v112, v112, v114
    v_add_f32 v113, v113, v115
    v_lshlrev_b32 v114, 16, v233
    v_and_b32 v115, 0xffff0000, v233
    v_mul_f32 v114, v114, v186
    v_mul_f32 v115, v115, v187
    v_cvt_pk_bf16_f32 v116, v114, v115
    v_lshlrev_b32 v114, 16, v116
    v_and_b32 v115, 0xffff0000, v116
    v_add_f32 v112, v112, v114
    v_add_f32 v113, v113, v115
    v_lshlrev_b32 v114, 16, v234
    v_and_b32 v115, 0xffff0000, v234
    v_mul_f32 v114, v114, v188
    v_mul_f32 v115, v115, v189
    v_cvt_pk_bf16_f32 v116, v114, v115
    v_lshlrev_b32 v114, 16, v116
    v_and_b32 v115, 0xffff0000, v116
    v_add_f32 v112, v112, v114
    v_add_f32 v113, v113, v115
    v_lshlrev_b32 v114, 16, v235
    v_and_b32 v115, 0xffff0000, v235
    v_mul_f32 v114, v114, v190
    v_mul_f32 v115, v115, v191
    v_cvt_pk_bf16_f32 v116, v114, v115
    v_lshlrev_b32 v114, 16, v116
    v_and_b32 v115, 0xffff0000, v116
    v_add_f32 v112, v112, v114
    v_add_f32 v113, v113, v115
    v_lshlrev_b32 v114, 16, v236
    v_and_b32 v115, 0xffff0000, v236
    v_mul_f32 v114, v114, v192
    v_mul_f32 v115, v115, v193
    v_cvt_pk_bf16_f32 v116, v114, v115
    v_lshlrev_b32 v114, 16, v116
    v_and_b32 v115, 0xffff0000, v116
    v_add_f32 v112, v112, v114
    v_add_f32 v113, v113, v115
    v_lshlrev_b32 v114, 16, v237
    v_and_b32 v115, 0xffff0000, v237
    v_mul_f32 v114, v114, v194
    v_mul_f32 v115, v115, v195
    v_cvt_pk_bf16_f32 v116, v114, v115
    v_lshlrev_b32 v114, 16, v116
    v_and_b32 v115, 0xffff0000, v116
    v_add_f32 v112, v112, v114
    v_add_f32 v113, v113, v115
    v_lshlrev_b32 v114, 16, v238
    v_and_b32 v115, 0xffff0000, v238
    v_mul_f32 v114, v114, v196
    v_mul_f32 v115, v115, v197
    v_cvt_pk_bf16_f32 v116, v114, v115
    v_lshlrev_b32 v114, 16, v116
    v_and_b32 v115, 0xffff0000, v116
    v_add_f32 v112, v112, v114
    v_add_f32 v113, v113, v115
    v_lshlrev_b32 v114, 16, v239
    v_and_b32 v115, 0xffff0000, v239
    v_mul_f32 v114, v114, v198
    v_mul_f32 v115, v115, v199
    v_cvt_pk_bf16_f32 v116, v114, v115
    v_lshlrev_b32 v114, 16, v116
    v_and_b32 v115, 0xffff0000, v116
    v_add_f32 v112, v112, v114
    v_add_f32 v113, v113, v115
    v_add_f32 v112, v112, v113
    s_nop 1
    v_add_f32_dpp v112, v112, v112 quad_perm:[1,0,3,2] row_mask:0xf bank_mask:0xf
    s_nop 1
    v_add_f32_dpp v112, v112, v112 quad_perm:[2,3,0,1] row_mask:0xf bank_mask:0xf
    s_nop 1
    v_add_f32_dpp v112, v112, v112 row_half_mirror row_mask:0xf bank_mask:0xf
    v_cvt_pk_bf16_f32 v116, v112, v113
    v_lshlrev_b32 v112, 16, v116
    v_and_b32 v113, 0xffff0000, v116
    v_mul_f32 v112, 0xbfb8aa3b, v112
    v_exp_f32 v112, v112
    s_nop 0
    v_add_f32 v112, 1.0, v112
    v_rcp_f32 v112, v112
    s_nop 0
    v_cvt_pk_bf16_f32 v116, v112, v113
    v_lshlrev_b32 v112, 16, v116
    v_and_b32 v113, 0xffff0000, v116
    s_lshl_b32 s28, s26, 7
    s_add_u32 s28, s28, 0xba30000
    s_mov_b32 exec_lo, 0x01010101
    s_mov_b32 exec_hi, 0x01010101
    buffer_store_dword v112, v23, s[4:7], s28 offen sc1
    s_mov_b64 exec, -1
L_s5_noga:
    s_add_u32 s74, s74, 40960
    s_add_u32 m0, s88, s75
    s_add_u32 s88, s88, 40960
    s_cmp_eq_u32 s88, 122880
    s_cselect_b32 s88, 0, s88
    v_mfma_f32_16x16x32_bf16 v[64:67], v[32:35], a[0:3], 0
    ds_read_b128 v[56:59], v19 offset:1024
    v_mfma_f32_16x16x32_bf16 v[68:71], v[32:35], a[80:83], 0
    ds_read_b128 v[60:63], v19 offset:21504
    v_mfma_f32_16x16x32_bf16 v[72:75], v[36:39], a[0:3], 0
    buffer_load_dwordx4 v16, s[8:11], s74 offen offset:0 lds
    s_add_u32 m0, m0, s92
    v_mfma_f32_16x16x32_bf16 v[76:79], v[36:39], a[80:83], 0
    v_mfma_f32_16x16x32_bf16 v[64:67], v[40:43], a[4:7], v[64:67]
    ds_read_b128 v[32:35], v17 offset:2048
    v_mfma_f32_16x16x32_bf16 v[68:71], v[40:43], a[84:87], v[68:71]
    ds_read_b128 v[36:39], v17 offset:22528
    v_mfma_f32_16x16x32_bf16 v[72:75], v[44:47], a[4:7], v[72:75]
    buffer_load_dwordx4 v31, s[8:11], s74 offen offset:0 lds
    s_add_u32 m0, m0, s93
    v_mfma_f32_16x16x32_bf16 v[76:79], v[44:47], a[84:87], v[76:79]
    v_mfma_f32_16x16x32_bf16 v[64:67], v[48:51], a[8:11], v[64:67]
    ds_read_b128 v[40:43], v19 offset:2048
    v_mfma_f32_16x16x32_bf16 v[68:71], v[48:51], a[88:91], v[68:71]
    ds_read_b128 v[44:47], v19 offset:22528
    v_mfma_f32_16x16x32_bf16 v[72:75], v[52:55], a[8:11], v[72:75]
    buffer_load_dwordx4 v16, s[8:11], s74 offen offset:256 lds
    s_add_u32 m0, m0, s92
    v_mfma_f32_16x16x32_bf16 v[76:79], v[52:55], a[88:91], v[76:79]
    s_waitcnt lgkmcnt(4)
    v_mfma_f32_16x16x32_bf16 v[64:67], v[56:59], a[12:15], v[64:67]
    ds_read_b128 v[48:51], v17 offset:3072
    v_mfma_f32_16x16x32_bf16 v[68:71], v[56:59], a[92:95], v[68:71]
    ds_read_b128 v[52:55], v17 offset:23552
    v_mfma_f32_16x16x32_bf16 v[72:75], v[60:63], a[12:15], v[72:75]
    buffer_load_dwordx4 v31, s[8:11], s74 offen offset:256 lds
    s_add_u32 m0, m0, s93
    v_mfma_f32_16x16x32_bf16 v[76:79], v[60:63], a[92:95], v[76:79]
    s_waitcnt lgkmcnt(4)
    v_mfma_f32_16x16x32_bf16 v[64:67], v[32:35], a[16:19], v[64:67]
    ds_read_b128 v[56:59], v19 offset:3072
    v_mfma_f32_16x16x32_bf16 v[68:71], v[32:35], a[96:99], v[68:71]
    ds_read_b128 v[60:63], v19 offset:23552
    v_mfma_f32_16x16x32_bf16 v[72:75], v[36:39], a[16:19], v[72:75]
    buffer_load_dwordx4 v16, s[8:11], s74 offen offset:512 lds
    s_add_u32 m0, m0, s92
    v_mfma_f32_16x16x32_bf16 v[76:79], v[36:39], a[96:99], v[76:79]
    s_waitcnt lgkmcnt(4)
    v_mfma_f32_16x16x32_bf16 v[64:67], v[40:43], a[20:23], v[64:67]
    ds_read_b128 v[32:35], v17 offset:4096
    v_mfma_f32_16x16x32_bf16 v[68:71], v[40:43], a[100:103], v[68:71]
    ds_read_b128 v[36:39], v17 offset:24576
    v_mfma_f32_16x16x32_bf16 v[72:75], v[44:47], a[20:23], v[72:75]
    buffer_load_dwordx4 v31, s[8:11], s74 offen offset:512 lds
    s_add_u32 m0, m0, s93
    v_mfma_f32_16x16x32_bf16 v[76:79], v[44:47], a[100:103], v[76:79]
    s_waitcnt lgkmcnt(4)
    v_mfma_f32_16x16x32_bf16 v[64:67], v[48:51], a[24:27], v[64:67]
    ds_read_b128 v[40:43], v19 offset:4096
    v_mfma_f32_16x16x32_bf16 v[68:71], v[48:51], a[104:107], v[68:71]
    ds_read_b128 v[44:47], v19 offset:24576
    v_mfma_f32_16x16x32_bf16 v[72:75], v[52:55], a[24:27], v[72:75]
    buffer_load_dwordx4 v16, s[8:11], s74 offen offset:768 lds
    s_add_u32 m0, m0, s92
    v_mfma_f32_16x16x32_bf16 v[76:79], v[52:55], a[104:107], v[76:79]
    s_waitcnt lgkmcnt(4)
    v_mfma_f32_16x16x32_bf16 v[64:67], v[56:59], a[28:31], v[64:67]
    ds_read_b128 v[48:51], v17 offset:5120
    v_mfma_f32_16x16x32_bf16 v[68:71], v[56:59], a[108:111], v[68:71]
    ds_read_b128 v[52:55], v17 offset:25600
    v_mfma_f32_16x16x32_bf16 v[72:75], v[60:63], a[28:31], v[72:75]
    buffer_load_dwordx4 v31, s[8:11], s74 offen offset:768 lds
    s_add_u32 m0, m0, s93
    v_mfma_f32_16x16x32_bf16 v[76:79], v[60:63], a[108:111], v[76:79]
    s_waitcnt lgkmcnt(4)
    v_mfma_f32_16x16x32_bf16 v[64:67], v[32:35], a[32:35], v[64:67]
    ds_read_b128 v[56:59], v19 offset:5120
    v_mfma_f32_16x16x32_bf16 v[68:71], v[32:35], a[112:115], v[68:71]
    ds_read_b128 v[60:63], v19 offset:25600
    v_mfma_f32_16x16x32_bf16 v[72:75], v[36:39], a[32:35], v[72:75]
    buffer_load_dwordx4 v16, s[8:11], s74 offen offset:1024 lds
    s_add_u32 m0, m0, s92
    v_mfma_f32_16x16x32_bf16 v[76:79], v[36:39], a[112:115], v[76:79]
    s_waitcnt lgkmcnt(4)
    v_mfma_f32_16x16x32_bf16 v[64:67], v[40:43], a[36:39], v[64:67]
    ds_read_b128 v[32:35], v17 offset:6144
    v_mfma_f32_16x16x32_bf16 v[68:71], v[40:43], a[116:119], v[68:71]
    ds_read_b128 v[36:39], v17 offset:26624
    v_mfma_f32_16x16x32_bf16 v[72:75], v[44:47], a[36:39], v[72:75]
    buffer_load_dwordx4 v31, s[8:11], s74 offen offset:1024 lds
    v_mfma_f32_16x16x32_bf16 v[76:79], v[44:47], a[116:119], v[76:79]
    s_waitcnt lgkmcnt(4)
    v_mfma_f32_16x16x32_bf16 v[64:67], v[48:51], a[40:43], v[64:67]
    ds_read_b128 v[40:43], v19 offset:6144
    v_mfma_f32_16x16x32_bf16 v[68:71], v[48:51], a[120:123], v[68:71]
    ds_read_b128 v[44:47], v19 offset:26624
    v_mfma_f32_16x16x32_bf16 v[72:75], v[52:55], a[40:43], v[72:75]
    v_mfma_f32_16x16x32_bf16 v[76:79], v[52:55], a[120:123], v[76:79]
    s_waitcnt lgkmcnt(4)
    v_mfma_f32_16x16x32_bf16 v[64:67], v[56:59], a[44:47], v[64:67]
    ds_read_b128 v[48:51], v17 offset:7168
    v_mfma_f32_16x16x32_bf16 v[68:71], v[56:59], a[124:127], v[68:71]
    ds_read_b128 v[52:55], v17 offset:27648
    v_mfma_f32_16x16x32_bf16 v[72:75], v[60:63], a[44:47], v[72:75]
    v_mfma_f32_16x16x32_bf16 v[76:79], v[60:63], a[124:127], v[76:79]
    s_waitcnt lgkmcnt(4)
    v_mfma_f32_16x16x32_bf16 v[64:67], v[32:35], a[48:51], v[64:67]
    ds_read_b128 v[56:59], v19 offset:7168
    v_mfma_f32_16x16x32_bf16 v[68:71], v[32:35], a[128:131], v[68:71]
    ds_read_b128 v[60:63], v19 offset:27648
    v_mfma_f32_16x16x32_bf16 v[72:75], v[36:39], a[48:51], v[72:75]
    v_mfma_f32_16x16x32_bf16 v[76:79], v[36:39], a[128:131], v[76:79]
    s_waitcnt lgkmcnt(4)
    v_mfma_f32_16x16x32_bf16 v[64:67], v[40:43], a[52:55], v[64:67]
    ds_read_b128 v[32:35], v17 offset:8192
    v_mfma_f32_16x16x32_bf16 v[68:71], v[40:43], a[132:135], v[68:71]
    ds_read_b128 v[36:39], v17 offset:28672
    v_mfma_f32_16x16x32_bf16 v[72:75], v[44:47], a[52:55], v[72:75]
    v_mfma_f32_16x16x32_bf16 v[76:79], v[44:47], a[132:135], v[76:79]
    s_waitcnt lgkmcnt(4)
    v_mfma_f32_16x16x32_bf16 v[64:67], v[48:51], a[56:59], v[64:67]
    ds_read_b128 v[40:43], v19 offset:8192
    v_mfma_f32_16x16x32_bf16 v[68:71], v[48:51], a[136:139], v[68:71]
    ds_read_b128 v[44:47], v19 offset:28672
    v_mfma_f32_16x16x32_bf16 v[72:75], v[52:55], a[56:59], v[72:75]
    v_mfma_f32_16x16x32_bf16 v[76:79], v[52:55], a[136:139], v[76:79]
    s_waitcnt lgkmcnt(4)
    v_mfma_f32_16x16x32_bf16 v[64:67], v[56:59], a[60:63], v[64:67]
    ds_read_b128 v[48:51], v17 offset:9216
    v_mfma_f32_16x16x32_bf16 v[68:71], v[56:59], a[140:143], v[68:71]
    ds_read_b128 v[52:55], v17 offset:29696
    v_mfma_f32_16x16x32_bf16 v[72:75], v[60:63], a[60:63], v[72:75]
    v_mfma_f32_16x16x32_bf16 v[76:79], v[60:63], a[140:143], v[76:79]
    s_waitcnt lgkmcnt(4)
    v_mfma_f32_16x16x32_bf16 v[64:67], v[32:35], a[64:67], v[64:67]
    ds_read_b128 v[56:59], v19 offset:9216
    v_mfma_f32_16x16x32_bf16 v[68:71], v[32:35], a[144:147], v[68:71]
    ds_read_b128 v[60:63], v19 offset:29696
    v_mfma_f32_16x16x32_bf16 v[72:75], v[36:39], a[64:67], v[72:75]
    v_mfma_f32_16x16x32_bf16 v[76:79], v[36:39], a[144:147], v[76:79]
    s_waitcnt vmcnt(10)
    s_branch L_s5_join
L_s5_top:
    s_cmp_lg_u32 s79, s26
    s_cbranch_scc1 L_s5_nogb
    s_add_u32 s79, s79, 10
    s_waitcnt lgkmcnt(0)
    ds_read_b128 v[200:203], v22 offset:0
    ds_read_b128 v[204:207], v22 offset:1024
    ds_read_b128 v[208:211], v22 offset:2048
    ds_read_b128 v[212:215], v22 offset:3072
    ds_read_b128 v[216:219], v22 offset:4096
    ds_read_b128 v[220:223], v22 offset:5120
    ds_read_b128 v[224:227], v22 offset:6144
    ds_read_b128 v[228:231], v22 offset:7168
    ds_read_b128 v[232:235], v22 offset:8192
    ds_read_b128 v[236:239], v22 offset:9216
    v_mov_b32 v112, 0
    v_mov_b32 v113, 0
    s_waitcnt lgkmcnt(0)
    v_lshlrev_b32 v114, 16, v200
    v_and_b32 v115, 0xffff0000, v200
    v_mul_f32 v114, v114, v120
    v_mul_f32 v115, v115, v121
    v_cvt_pk_bf16_f32 v116, v114, v115
    v_lshlrev_b32 v114, 16, v116
    v_and_b32 v115, 0xffff0000, v116
    v_add_f32 v112, v112, v114
    v_add_f32 v113, v113, v115
    v_lshlrev_b32 v114, 16, v201
    v_and_b32 v115, 0xffff0000, v201
    v_mul_f32 v114, v114, v122
    v_mul_f32 v115, v115, v123
    v_cvt_pk_bf16_f32 v116, v114, v115
    v_lshlrev_b32 v114, 16, v116
    v_and_b32 v115, 0xffff0000, v116
    v_add_f32 v112, v112, v114
    v_add_f32 v113, v113, v115
    v_lshlrev_b32 v114, 16, v202
    v_and_b32 v115, 0xffff0000, v202
    v_mul_f32 v114, v114, v124
    v_mul_f32 v115, v115, v125
    v_cvt_pk_bf16_f32 v116, v114, v115
    v_lshlrev_b32 v114, 16, v116
    v_and_b32 v115, 0xffff0000, v116
    v_add_f32 v112, v112, v114
    v_add_f32 v113, v113, v115
    v_lshlrev_b32 v114, 16, v203
    v_and_b32 v115, 0xffff0000, v203
    v_mul_f32 v114, v114, v126
    v_mul_f32 v115, v115, v127
    v_cvt_pk_bf16_f32 v116, v114, v115
    v_lshlrev_b32 v114, 16, v116
    v_and_b32 v115, 0xffff0000, v116
    v_add_f32 v112, v112, v114
    v_add_f32 v113, v113, v115
    v_lshlrev_b32 v114, 16, v204
    v_and_b32 v115, 0xffff0000, v204
    v_mul_f32 v114, v114, v128
    v_mul_f32 v115, v115, v129
    v_cvt_pk_bf16_f32 v116, v114, v115
    v_lshlrev_b32 v114, 16, v116
    v_and_b32 v115, 0xffff0000, v116
    v_add_f32 v112, v112, v114
    v_add_f32 v113, v113, v115
    v_lshlrev_b32 v114, 16, v205
    v_and_b32 v115, 0xffff0000, v205
    v_mul_f32 v114, v114, v130
    v_mul_f32 v115, v115, v131
    v_cvt_pk_bf16_f32 v116, v114, v115
    v_lshlrev_b32 v114, 16, v116
    v_and_b32 v115, 0xffff0000, v116
    v_add_f32 v112, v112, v114
    v_add_f32 v113, v113, v115
    v_lshlrev_b32 v114, 16, v206
    v_and_b32 v115, 0xffff0000, v206
    v_mul_f32 v114, v114, v132
    v_mul_f32 v115, v115, v133
    v_cvt_pk_bf16_f32 v116, v114, v115
    v_lshlrev_b32 v114, 16, v116
    v_and_b32 v115, 0xffff0000, v116
    v_add_f32 v112, v112, v114
    v_add_f32 v113, v113, v115
    v_lshlrev_b32 v114, 16, v207
    v_and_b32 v115, 0xffff0000, v207
    v_mul_f32 v114, v114, v134
    v_mul_f32 v115, v115, v135
    v_cvt_pk_bf16_f32 v116, v114, v115
    v_lshlrev_b32 v114, 16, v116
    v_and_b32 v115, 0xffff0000, v116
    v_add_f32 v112, v112, v114
    v_add_f32 v113, v113, v115
    v_lshlrev_b32 v114, 16, v208
    v_and_b32 v115, 0xffff0000, v208
    v_mul_f32 v114, v114, v136
    v_mul_f32 v115, v115, v137
    v_cvt_pk_bf16_f32 v116, v114, v115
    v_lshlrev_b32 v114, 16, v116
    v_and_b32 v115, 0xffff0000, v116
    v_add_f32 v112, v112, v114
    v_add_f32 v113, v113, v115
    v_lshlrev_b32 v114, 16, v209
    v_and_b32 v115, 0xffff0000, v209
    v_mul_f32 v114, v114, v138
    v_mul_f32 v115, v115, v139
    v_cvt_pk_bf16_f32 v116, v114, v115
    v_lshlrev_b32 v114, 16, v116
    v_and_b32 v115, 0xffff0000, v116
    v_add_f32 v112, v112, v114
    v_add_f32 v113, v113, v115
    v_lshlrev_b32 v114, 16, v210
    v_and_b32 v115, 0xffff0000, v210
    v_mul_f32 v114, v114, v140
    v_mul_f32 v115, v115, v141
    v_cvt_pk_bf16_f32 v116, v114, v115
    v_lshlrev_b32 v114, 16, v116
    v_and_b32 v115, 0xffff0000, v116
    v_add_f32 v112, v112, v114
    v_add_f32 v113, v113, v115
    v_lshlrev_b32 v114, 16, v211
    v_and_b32 v115, 0xffff0000, v211
    v_mul_f32 v114, v114, v142
    v_mul_f32 v115, v115, v143
    v_cvt_pk_bf16_f32 v116, v114, v115
    v_lshlrev_b32 v114, 16, v116
    v_and_b32 v115, 0xffff0000, v116
    v_add_f32 v112, v112, v114
    v_add_f32 v113, v113, v115
    v_lshlrev_b32 v114, 16, v212
    v_and_b32 v115, 0xffff0000, v212
    v_mul_f32 v114, v114, v144
    v_mul_f32 v115, v115, v145
    v_cvt_pk_bf16_f32 v116, v114, v115
    v_lshlrev_b32 v114, 16, v116
    v_and_b32 v115, 0xffff0000, v116
    v_add_f32 v112, v112, v114
    v_add_f32 v113, v113, v115
    v_lshlrev_b32 v114, 16, v213
    v_and_b32 v115, 0xffff0000, v213
    v_mul_f32 v114, v114, v146
    v_mul_f32 v115, v115, v147
    v_cvt_pk_bf16_f32 v116, v114, v115
    v_lshlrev_b32 v114, 16, v116
    v_and_b32 v115, 0xffff0000, v116
    v_add_f32 v112, v112, v114
    v_add_f32 v113, v113, v115
    v_lshlrev_b32 v114, 16, v214
    v_and_b32 v115, 0xffff0000, v214
    v_mul_f32 v114, v114, v148
    v_mul_f32 v115, v115, v149
    v_cvt_pk_bf16_f32 v116, v114, v115
    v_lshlrev_b32 v114, 16, v116
    v_and_b32 v115, 0xffff0000, v116
    v_add_f32 v112, v112, v114
    v_add_f32 v113, v113, v115
    v_lshlrev_b32 v114, 16, v215
    v_and_b32 v115, 0xffff0000, v215
    v_mul_f32 v114, v114, v150
    v_mul_f32 v115, v115, v151
    v_cvt_pk_bf16_f32 v116, v114, v115
    v_lshlrev_b32 v114, 16, v116
    v_and_b32 v115, 0xffff0000, v116
    v_add_f32 v112, v112, v114
    v_add_f32 v113, v113, v115
    v_lshlrev_b32 v114, 16, v216
    v_and_b32 v115, 0xffff0000, v216
    v_mul_f32 v114, v114, v152
    v_mul_f32 v115, v115, v153
    v_cvt_pk_bf16_f32 v116, v114, v115
    v_lshlrev_b32 v114, 16, v116
    v_and_b32 v115, 0xffff0000, v116
    v_add_f32 v112, v112, v114
    v_add_f32 v113, v113, v115
    v_lshlrev_b32 v114, 16, v217
    v_and_b32 v115, 0xffff0000, v217
    v_mul_f32 v114, v114, v154
    v_mul_f32 v115, v115, v155
    v_cvt_pk_bf16_f32 v116, v114, v115
    v_lshlrev_b32 v114, 16, v116
    v_and_b32 v115, 0xffff0000, v116
    v_add_f32 v112, v112, v114
    v_add_f32 v113, v113, v115
    v_lshlrev_b32 v114, 16, v218
    v_and_b32 v115, 0xffff0000, v218
    v_mul_f32 v114, v114, v156
    v_mul_f32 v115, v115, v157
    v_cvt_pk_bf16_f32 v116, v114, v115
    v_lshlrev_b32 v114, 16, v116
    v_and_b32 v115, 0xffff0000, v116
    v_add_f32 v112, v112, v114
    v_add_f32 v113, v113, v115
    v_lshlrev_b32 v114, 16, v219
    v_and_b32 v115, 0xffff0000, v219
    v_mul_f32 v114, v114, v158
    v_mul_f32 v115, v115, v159
    v_cvt_pk_bf16_f32 v116, v114, v115
    v_lshlrev_b32 v114, 16, v116
    v_and_b32 v115, 0xffff0000, v116
    v_add_f32 v112, v112, v114
    v_add_f32 v113, v113, v115
    v_lshlrev_b32 v114, 16, v220
    v_and_b32 v115, 0xffff0000, v220
    v_mul_f32 v114, v114, v160
    v_mul_f32 v115, v115, v161
    v_cvt_pk_bf16_f32 v116, v114, v115
    v_lshlrev_b32 v114, 16, v116
    v_and_b32 v115, 0xffff0000, v116
    v_add_f32 v112, v112, v114
    v_add_f32 v113, v113, v115
    v_lshlrev_b32 v114, 16, v221
    v_and_b32 v115, 0xffff0000, v221
    v_mul_f32 v114, v114, v162
    v_mul_f32 v115, v115, v163
    v_cvt_pk_bf16_f32 v116, v114, v115
    v_lshlrev_b32 v114, 16, v116
    v_and_b32 v115, 0xffff0000, v116
    v_add_f32 v112, v112, v114
    v_add_f32 v113, v113, v115
    v_lshlrev_b32 v114, 16, v222
    v_and_b32 v115, 0xffff0000, v222
    v_mul_f32 v114, v114, v164
    v_mul_f32 v115, v115, v165
    v_cvt_pk_bf16_f32 v116, v114, v115
    v_lshlrev_b32 v114, 16, v116
    v_and_b32 v115, 0xffff0000, v116
    v_add_f32 v112, v112, v114
    v_add_f32 v113, v113, v115
    v_lshlrev_b32 v114, 16, v223
    v_and_b32 v115, 0xffff0000, v223
    v_mul_f32 v114, v114, v166
    v_mul_f32 v115, v115, v167
    v_cvt_pk_bf16_f32 v116, v114, v115
    v_lshlrev_b32 v114, 16, v116
    v_and_b32 v115, 0xffff0000, v116
    v_add_f32 v112, v112, v114
    v_add_f32 v113, v113, v115
    v_lshlrev_b32 v114, 16, v224
    v_and_b32 v115, 0xffff0000, v224
    v_mul_f32 v114, v114, v168
    v_mul_f32 v115, v115, v169
    v_cvt_pk_bf16_f32 v116, v114, v115
    v_lshlrev_b32 v114, 16, v116
    v_and_b32 v115, 0xffff0000, v116
    v_add_f32 v112, v112, v114
    v_add_f32 v113, v113, v115
    v_lshlrev_b32 v114, 16, v225
    v_and_b32 v115, 0xffff0000, v225
    v_mul_f32 v114, v114, v170
    v_mul_f32 v115, v115, v171
    v_cvt_pk_bf16_f32 v116, v114, v115
    v_lshlrev_b32 v114, 16, v116
    v_and_b32 v115, 0xffff0000, v116
    v_add_f32 v112, v112, v114
    v_add_f32 v113, v113, v115
    v_lshlrev_b32 v114, 16, v226
    v_and_b32 v115, 0xffff0000, v226
    v_mul_f32 v114, v114, v172
    v_mul_f32 v115, v115, v173
    v_cvt_pk_bf16_f32 v116, v114, v115
    v_lshlrev_b32 v114, 16, v116
    v_and_b32 v115, 0xffff0000, v116
    v_add_f32 v112, v112, v114
    v_add_f32 v113, v113, v115
    v_lshlrev_b32 v114, 16, v227
    v_and_b32 v115, 0xffff0000, v227
    v_mul_f32 v114, v114, v174
    v_mul_f32 v115, v115, v175
    v_cvt_pk_bf16_f32 v116, v114, v115
    v_lshlrev_b32 v114, 16, v116
    v_and_b32 v115, 0xffff0000, v116
    v_add_f32 v112, v112, v114
    v_add_f32 v113, v113, v115
    v_lshlrev_b32 v114, 16, v228
    v_and_b32 v115, 0xffff0000, v228
    v_mul_f32 v114, v114, v176
    v_mul_f32 v115, v115, v177
    v_cvt_pk_bf16_f32 v116, v114, v115
    v_lshlrev_b32 v114, 16, v116
    v_and_b32 v115, 0xffff0000, v116
    v_add_f32 v112, v112, v114
    v_add_f32 v113, v113, v115
    v_lshlrev_b32 v114, 16, v229
    v_and_b32 v115, 0xffff0000, v229
    v_mul_f32 v114, v114, v178
    v_mul_f32 v115, v115, v179
    v_cvt_pk_bf16_f32 v116, v114, v115
    v_lshlrev_b32 v114, 16, v116
    v_and_b32 v115, 0xffff0000, v116
    v_add_f32 v112, v112, v114
    v_add_f32 v113, v113, v115
    v_lshlrev_b32 v114, 16, v230
    v_and_b32 v115, 0xffff0000, v230
    v_mul_f32 v114, v114, v180
    v_mul_f32 v115, v115, v181
    v_cvt_pk_bf16_f32 v116, v114, v115
    v_lshlrev_b32 v114, 16, v116
    v_and_b32 v115, 0xffff0000, v116
    v_add_f32 v112, v112, v114
    v_add_f32 v113, v113, v115
    v_lshlrev_b32 v114, 16, v231
    v_and_b32 v115, 0xffff0000, v231
    v_mul_f32 v114, v114, v182
    v_mul_f32 v115, v115, v183
    v_cvt_pk_bf16_f32 v116, v114, v115
    v_lshlrev_b32 v114, 16, v116
    v_and_b32 v115, 0xffff0000, v116
    v_add_f32 v112, v112, v114
    v_add_f32 v113, v113, v115
    v_lshlrev_b32 v114, 16, v232
    v_and_b32 v115, 0xffff0000, v232
    v_mul_f32 v114, v114, v184
    v_mul_f32 v115, v115, v185
    v_cvt_pk_bf16_f32 v116, v114, v115
    v_lshlrev_b32 v114, 16, v116
    v_and_b32 v115, 0xffff0000, v116
    v_add_f32 v112, v112, v114
    v_add_f32 v113, v113, v115
    v_lshlrev_b32 v114, 16, v233
    v_and_b32 v115, 0xffff0000, v233
    v_mul_f32 v114, v114, v186
    v_mul_f32 v115, v115, v187
    v_cvt_pk_bf16_f32 v116, v114, v115
    v_lshlrev_b32 v114, 16, v116
    v_and_b32 v115, 0xffff0000, v116
    v_add_f32 v112, v112, v114
    v_add_f32 v113, v113, v115
    v_lshlrev_b32 v114, 16, v234
    v_and_b32 v115, 0xffff0000, v234
    v_mul_f32 v114, v114, v188
    v_mul_f32 v115, v115, v189
    v_cvt_pk_bf16_f32 v116, v114, v115
    v_lshlrev_b32 v114, 16, v116
    v_and_b32 v115, 0xffff0000, v116
    v_add_f32 v112, v112, v114
    v_add_f32 v113, v113, v115
    v_lshlrev_b32 v114, 16, v235
    v_and_b32 v115, 0xffff0000, v235
    v_mul_f32 v114, v114, v190
    v_mul_f32 v115, v115, v191
    v_cvt_pk_bf16_f32 v116, v114, v115
    v_lshlrev_b32 v114, 16, v116
    v_and_b32 v115, 0xffff0000, v116
    v_add_f32 v112, v112, v114
    v_add_f32 v113, v113, v115
    v_lshlrev_b32 v114, 16, v236
    v_and_b32 v115, 0xffff0000, v236
    v_mul_f32 v114, v114, v192
    v_mul_f32 v115, v115, v193
    v_cvt_pk_bf16_f32 v116, v114, v115
    v_lshlrev_b32 v114, 16, v116
    v_and_b32 v115, 0xffff0000, v116
    v_add_f32 v112, v112, v114
    v_add_f32 v113, v113, v115
    v_lshlrev_b32 v114, 16, v237
    v_and_b32 v115, 0xffff0000, v237
    v_mul_f32 v114, v114, v194
    v_mul_f32 v115, v115, v195
    v_cvt_pk_bf16_f32 v116, v114, v115
    v_lshlrev_b32 v114, 16, v116
    v_and_b32 v115, 0xffff0000, v116
    v_add_f32 v112, v112, v114
    v_add_f32 v113, v113, v115
    v_lshlrev_b32 v114, 16, v238
    v_and_b32 v115, 0xffff0000, v238
    v_mul_f32 v114, v114, v196
    v_mul_f32 v115, v115, v197
    v_cvt_pk_bf16_f32 v116, v114, v115
    v_lshlrev_b32 v114, 16, v116
    v_and_b32 v115, 0xffff0000, v116
    v_add_f32 v112, v112, v114
    v_add_f32 v113, v113, v115
    v_lshlrev_b32 v114, 16, v239
    v_and_b32 v115, 0xffff0000, v239
    v_mul_f32 v114, v114, v198
    v_mul_f32 v115, v115, v199
    v_cvt_pk_bf16_f32 v116, v114, v115
    v_lshlrev_b32 v114, 16, v116
    v_and_b32 v115, 0xffff0000, v116
    v_add_f32 v112, v112, v114
    v_add_f32 v113, v113, v115
    v_add_f32 v112, v112, v113
    s_nop 1
    v_add_f32_dpp v112, v112, v112 quad_perm:[1,0,3,2] row_mask:0xf bank_mask:0xf
    s_nop 1
    v_add_f32_dpp v112, v112, v112 quad_perm:[2,3,0,1] row_mask:0xf bank_mask:0xf
    s_nop 1
    v_add_f32_dpp v112, v112, v112 row_half_mirror row_mask:0xf bank_mask:0xf
    v_cvt_pk_bf16_f32 v116, v112, v113
    v_lshlrev_b32 v112, 16, v116
    v_and_b32 v113, 0xffff0000, v116
    v_mul_f32 v112, 0xbfb8aa3b, v112
    v_exp_f32 v112, v112
    s_nop 0
    v_add_f32 v112, 1.0, v112
    v_rcp_f32 v112, v112
    s_nop 0
    v_cvt_pk_bf16_f32 v116, v112, v113
    v_lshlrev_b32 v112, 16, v116
    v_and_b32 v113, 0xffff0000, v116
    s_lshl_b32 s28, s26, 7
    s_add_u32 s28, s28, 0xba30000
    s_mov_b32 exec_lo, 0x01010101
    s_mov_b32 exec_hi, 0x01010101
    buffer_store_dword v112, v23, s[4:7], s28 offen sc1
    s_mov_b64 exec, -1
L_s5_nogb:
    s_add_u32 s74, s74, 40960
    s_add_u32 m0, s88, s75
    s_add_u32 s88, s88, 40960
    s_cmp_eq_u32 s88, 122880
    s_cselect_b32 s88, 0, s88
    v_mfma_f32_16x16x32_bf16 v[64:67], v[32:35], a[0:3], 0
    ds_read_b128 v[56:59], v19 offset:1024
    v_fmac_f32 v241, v80, v240
    v_fmac_f32 v245, v80, v244
    v_fmac_f32 v241, v82, v244
    v_mfma_f32_16x16x32_bf16 v[68:71], v[32:35], a[80:83], 0
    ds_read_b128 v[60:63], v19 offset:21504
    v_fmac_f32 v245, v81, v240
    v_fmac_f32 v242, v80, v241
    v_fmac_f32 v246, v80, v245
    v_mfma_f32_16x16x32_bf16 v[72:75], v[36:39], a[0:3], 0
    buffer_load_dwordx4 v16, s[8:11], s74 offen offset:0 lds
    s_add_u32 m0, m0, s92
    v_fmac_f32 v242, v82, v245
    v_fmac_f32 v246, v81, v241
    v_fmac_f32 v243, v80, v242
    v_mfma_f32_16x16x32_bf16 v[76:79], v[36:39], a[80:83], 0
    v_fmac_f32 v247, v80, v246
    v_fmac_f32 v243, v82, v246
    v_fmac_f32 v247, v81, v242
    v_mov_b32 v100, v243
    v_mfma_f32_16x16x32_bf16 v[64:67], v[40:43], a[4:7], v[64:67]
    ds_read_b128 v[32:35], v17 offset:2048
    v_mov_b32 v101, v243
    s_nop 1
    v_permlane16_swap_b32 v100, v101
    v_mov_b32 v102, v100
    v_mfma_f32_16x16x32_bf16 v[68:71], v[40:43], a[84:87], v[68:71]
    ds_read_b128 v[36:39], v17 offset:22528
    v_mov_b32 v103, v101
    v_permlane32_swap_b32 v100, v102
    s_nop 0
    v_permlane32_swap_b32 v101, v103
    v_mfma_f32_16x16x32_bf16 v[72:75], v[44:47], a[4:7], v[72:75]
    buffer_load_dwordx4 v31, s[8:11], s74 offen offset:0 lds
    s_add_u32 m0, m0, s93
    v_mov_b32 v104, v247
    v_mov_b32 v105, v247
    s_nop 1
    v_permlane16_swap_b32 v104, v105
    v_mfma_f32_16x16x32_bf16 v[76:79], v[44:47], a[84:87], v[76:79]
    v_mov_b32 v106, v104
    v_mov_b32 v107, v105
    s_nop 0
    v_permlane32_swap_b32 v104, v106
    v_permlane32_swap_b32 v105, v107
    v_mfma_f32_16x16x32_bf16 v[64:67], v[48:51], a[8:11], v[64:67]
    ds_read_b128 v[40:43], v19 offset:2048
    v_fmac_f32 v100, v89, v92
    v_fmac_f32 v104, v89, v93
    v_fmac_f32 v100, v91, v93
    v_mfma_f32_16x16x32_bf16 v[68:71], v[48:51], a[88:91], v[68:71]
    ds_read_b128 v[44:47], v19 offset:22528
    v_fmac_f32 v104, v90, v92
    v_fmac_f32 v101, v89, v100
    v_fmac_f32 v105, v89, v104
    v_mfma_f32_16x16x32_bf16 v[72:75], v[52:55], a[8:11], v[72:75]
    buffer_load_dwordx4 v16, s[8:11], s74 offen offset:256 lds
    s_add_u32 m0, m0, s92
    v_fmac_f32 v101, v91, v104
    v_fmac_f32 v105, v90, v100
    v_fmac_f32 v102, v89, v101
    v_mfma_f32_16x16x32_bf16 v[76:79], v[52:55], a[88:91], v[76:79]
    v_fmac_f32 v106, v89, v105
    v_fmac_f32 v102, v91, v105
    v_fmac_f32 v106, v90, v101
    v_fmac_f32 v103, v89, v102
    s_waitcnt lgkmcnt(4)
    v_mfma_f32_16x16x32_bf16 v[64:67], v[56:59], a[12:15], v[64:67]
    ds_read_b128 v[48:51], v17 offset:3072
    v_fmac_f32 v107, v89, v106
    v_fmac_f32 v103, v91, v106
    v_fmac_f32 v107, v90, v102
    v_mfma_f32_16x16x32_bf16 v[68:71], v[56:59], a[92:95], v[68:71]
    ds_read_b128 v[52:55], v17 offset:23552
    v_cndmask_b32 v108, v92, v100, s[32:33]
    v_cndmask_b32 v108, v108, v101, s[34:35]
    v_cndmask_b32 v108, v108, v102, s[36:37]
    v_mfma_f32_16x16x32_bf16 v[72:75], v[60:63], a[12:15], v[72:75]
    buffer_load_dwordx4 v31, s[8:11], s74 offen offset:256 lds
    s_add_u32 m0, m0, s93
    v_cndmask_b32 v109, v93, v104, s[32:33]
    v_cndmask_b32 v109, v109, v105, s[34:35]
    v_cndmask_b32 v109, v109, v106, s[36:37]
    v_mfma_f32_16x16x32_bf16 v[76:79], v[60:63], a[92:95], v[76:79]
    v_mov_b32 v92, v103
    v_mov_b32 v93, v107
    v_fmac_f32 v240, v80, v108
    v_fmac_f32 v244, v80, v109
    s_waitcnt lgkmcnt(4)
    v_mfma_f32_16x16x32_bf16 v[64:67], v[32:35], a[16:19], v[64:67]
    ds_read_b128 v[56:59], v19 offset:3072
    v_fmac_f32 v240, v82, v109
    v_fmac_f32 v244, v81, v108
    v_fmac_f32 v241, v83, v108
    v_mfma_f32_16x16x32_bf16 v[68:71], v[32:35], a[96:99], v[68:71]
    ds_read_b128 v[60:63], v19 offset:23552
    v_fmac_f32 v245, v83, v109
    v_fmac_f32 v241, v85, v109
    v_fmac_f32 v245, v84, v108
    v_mfma_f32_16x16x32_bf16 v[72:75], v[36:39], a[16:19], v[72:75]
    buffer_load_dwordx4 v16, s[8:11], s74 offen offset:512 lds
    s_add_u32 m0, m0, s92
    v_fmac_f32 v242, v86, v108
    v_fmac_f32 v246, v86, v109
    v_fmac_f32 v242, v88, v109
    v_mfma_f32_16x16x32_bf16 v[76:79], v[36:39], a[96:99], v[76:79]
    v_fmac_f32 v246, v87, v108
    v_fmac_f32 v243, v89, v108
    v_fmac_f32 v247, v89, v109
    v_fmac_f32 v243, v91, v109
    s_waitcnt lgkmcnt(4)
    v_mfma_f32_16x16x32_bf16 v[64:67], v[40:43], a[20:23], v[64:67]
    ds_read_b128 v[32:35], v17 offset:4096
    v_fmac_f32 v247, v90, v108
    v_mul_f32 v112, v94, v240
    v_mul_f32 v116, v96, v244
    v_mfma_f32_16x16x32_bf16 v[68:71], v[40:43], a[100:103], v[68:71]
    ds_read_b128 v[36:39], v17 offset:24576
    v_fmac_f32 v112, v95, v244
    v_fmac_f32 v116, v95, v240
    v_mul_f32 v113, v94, v241
    v_mfma_f32_16x16x32_bf16 v[72:75], v[44:47], a[20:23], v[72:75]
    buffer_load_dwordx4 v31, s[8:11], s74 offen offset:512 lds
    s_add_u32 m0, m0, s93
    v_mul_f32 v117, v96, v245
    v_fmac_f32 v113, v95, v245
    v_fmac_f32 v117, v95, v241
    v_mfma_f32_16x16x32_bf16 v[76:79], v[44:47], a[100:103], v[76:79]
    v_mul_f32 v114, v94, v242
    v_mul_f32 v118, v96, v246
    v_fmac_f32 v114, v95, v246
    v_fmac_f32 v118, v95, v242
    s_waitcnt lgkmcnt(4)
    v_mfma_f32_16x16x32_bf16 v[64:67], v[48:51], a[24:27], v[64:67]
    ds_read_b128 v[40:43], v19 offset:4096
    v_mul_f32 v115, v94, v243
    v_mul_f32 v119, v96, v247
    v_fmac_f32 v115, v95, v247
    v_mfma_f32_16x16x32_bf16 v[68:71], v[48:51], a[104:107], v[68:71]
    ds_read_b128 v[44:47], v19 offset:24576
    v_fmac_f32 v119, v95, v243
    v_cvt_pk_bf16_f32 v100, v112, v113
    v_cvt_pk_bf16_f32 v101, v114, v115
    v_mfma_f32_16x16x32_bf16 v[72:75], v[52:55], a[24:27], v[72:75]
    buffer_load_dwordx4 v16, s[8:11], s74 offen offset:768 lds
    s_add_u32 m0, m0, s92
    v_cvt_pk_bf16_f32 v102, v116, v117
    v_cvt_pk_bf16_f32 v103, v118, v119
    ds_write_b64 v18, v[100:101]
    v_mfma_f32_16x16x32_bf16 v[76:79], v[52:55], a[104:107], v[76:79]
    ds_write_b64 v18, v[102:103] offset:512
    s_waitcnt lgkmcnt(6)
    v_mfma_f32_16x16x32_bf16 v[64:67], v[56:59], a[28:31], v[64:67]
    ds_read_b128 v[48:51], v17 offset:5120
    v_mfma_f32_16x16x32_bf16 v[68:71], v[56:59], a[108:111], v[68:71]
    ds_read_b128 v[52:55], v17 offset:25600
    s_waitcnt lgkmcnt(2)
    ds_read_b64_tr_b16 v[24:25], v20
    ds_read_b64_tr_b16 v[26:27], v20 offset:512
    v_mfma_f32_16x16x32_bf16 v[72:75], v[60:63], a[28:31], v[72:75]
    buffer_load_dwordx4 v31, s[8:11], s74 offen offset:768 lds
    s_add_u32 m0, m0, s93
    s_add_u32 s28, s77, 0
    v_mfma_f32_16x16x32_bf16 v[76:79], v[60:63], a[108:111], v[76:79]
    v_mfma_f32_16x16x32_bf16 v[64:67], v[32:35], a[32:35], v[64:67]
    ds_read_b128 v[56:59], v19 offset:5120
    s_waitcnt lgkmcnt(1)
    buffer_store_dwordx4 v[24:27], v4, s[4:7], s28 offen sc1
    v_fmac_f32 v249, v80, v248
    v_mfma_f32_16x16x32_bf16 v[68:71], v[32:35], a[112:115], v[68:71]
    ds_read_b128 v[60:63], v19 offset:25600
    v_fmac_f32 v253, v80, v252
    v_fmac_f32 v249, v82, v252
    v_fmac_f32 v253, v81, v248
    v_mfma_f32_16x16x32_bf16 v[72:75], v[36:39], a[32:35], v[72:75]
    buffer_load_dwordx4 v16, s[8:11], s74 offen offset:1024 lds
    s_add_u32 m0, m0, s92
    v_fmac_f32 v250, v80, v249
    v_fmac_f32 v254, v80, v253
    v_fmac_f32 v250, v82, v253
    v_mfma_f32_16x16x32_bf16 v[76:79], v[36:39], a[112:115], v[76:79]
    v_fmac_f32 v254, v81, v249
    v_fmac_f32 v251, v80, v250
    v_fmac_f32 v255, v80, v254
    v_fmac_f32 v251, v82, v254
    v_mfma_f32_16x16x32_bf16 v[64:67], v[40:43], a[36:39], v[64:67]
    ds_read_b128 v[32:35], v17 offset:6144
    v_fmac_f32 v255, v81, v250
    v_mov_b32 v100, v251
    v_mov_b32 v101, v251
    v_mfma_f32_16x16x32_bf16 v[68:71], v[40:43], a[116:119], v[68:71]
    ds_read_b128 v[36:39], v17 offset:26624
    v_permlane16_swap_b32 v100, v101
    v_mov_b32 v102, v100
    v_mov_b32 v103, v101
    v_mfma_f32_16x16x32_bf16 v[72:75], v[44:47], a[36:39], v[72:75]
    buffer_load_dwordx4 v31, s[8:11], s74 offen offset:1024 lds
    v_permlane32_swap_b32 v100, v102
    v_permlane32_swap_b32 v101, v103
    v_mov_b32 v104, v255
    v_mfma_f32_16x16x32_bf16 v[76:79], v[44:47], a[116:119], v[76:79]
    v_mov_b32 v105, v255
    s_nop 1
    v_permlane16_swap_b32 v104, v105
    v_mov_b32 v106, v104
    v_mov_b32 v107, v105
    v_mfma_f32_16x16x32_bf16 v[64:67], v[48:51], a[40:43], v[64:67]
    ds_read_b128 v[40:43], v19 offset:6144
    v_permlane32_swap_b32 v104, v106
    v_permlane32_swap_b32 v105, v107
    v_fmac_f32 v100, v89, v92
    v_mfma_f32_16x16x32_bf16 v[68:71], v[48:51], a[120:123], v[68:71]
    ds_read_b128 v[44:47], v19 offset:26624
    v_fmac_f32 v104, v89, v93
    v_fmac_f32 v100, v91, v93
    v_fmac_f32 v104, v90, v92
    v_mfma_f32_16x16x32_bf16 v[72:75], v[52:55], a[40:43], v[72:75]
    v_fmac_f32 v101, v89, v100
    v_fmac_f32 v105, v89, v104
    v_fmac_f32 v101, v91, v104
    v_fmac_f32 v105, v90, v100
    v_fmac_f32 v102, v89, v101
    v_fmac_f32 v106, v89, v105
    v_fmac_f32 v102, v91, v105
    v_mfma_f32_16x16x32_bf16 v[76:79], v[52:55], a[120:123], v[76:79]
    v_fmac_f32 v106, v90, v101
    v_fmac_f32 v103, v89, v102
    v_fmac_f32 v107, v89, v106
    v_fmac_f32 v103, v91, v106
    s_waitcnt lgkmcnt(4)
    v_mfma_f32_16x16x32_bf16 v[64:67], v[56:59], a[44:47], v[64:67]
    ds_read_b128 v[48:51], v17 offset:7168
    v_fmac_f32 v107, v90, v102
    v_cndmask_b32 v108, v92, v100, s[32:33]
    v_cndmask_b32 v108, v108, v101, s[34:35]
    v_mfma_f32_16x16x32_bf16 v[68:71], v[56:59], a[124:127], v[68:71]
    ds_read_b128 v[52:55], v17 offset:27648
    v_cndmask_b32 v108, v108, v102, s[36:37]
    v_cndmask_b32 v109, v93, v104, s[32:33]
    v_cndmask_b32 v109, v109, v105, s[34:35]
    v_mfma_f32_16x16x32_bf16 v[72:75], v[60:63], a[44:47], v[72:75]
    v_cndmask_b32 v109, v109, v106, s[36:37]
    v_mov_b32 v92, v103
    v_mov_b32 v93, v107
    v_fmac_f32 v248, v80, v108
    v_fmac_f32 v252, v80, v109
    v_fmac_f32 v248, v82, v109
    v_fmac_f32 v252, v81, v108
    v_mfma_f32_16x16x32_bf16 v[76:79], v[60:63], a[124:127], v[76:79]
    v_fmac_f32 v249, v83, v108
    v_fmac_f32 v253, v83, v109
    v_fmac_f32 v249, v85, v109
    v_fmac_f32 v253, v84, v108
    s_waitcnt lgkmcnt(4)
    v_mfma_f32_16x16x32_bf16 v[64:67], v[32:35], a[48:51], v[64:67]
    ds_read_b128 v[56:59], v19 offset:7168
    v_fmac_f32 v250, v86, v108
    v_fmac_f32 v254, v86, v109
    v_fmac_f32 v250, v88, v109
    v_mfma_f32_16x16x32_bf16 v[68:71], v[32:35], a[128:131], v[68:71]
    ds_read_b128 v[60:63], v19 offset:27648
    v_fmac_f32 v254, v87, v108
    v_fmac_f32 v251, v89, v108
    v_fmac_f32 v255, v89, v109
    v_mfma_f32_16x16x32_bf16 v[72:75], v[36:39], a[48:51], v[72:75]
    v_fmac_f32 v251, v91, v109
    v_fmac_f32 v255, v90, v108
    v_mul_f32 v112, v94, v248
    v_mul_f32 v116, v96, v252
    v_fmac_f32 v112, v95, v252
    v_fmac_f32 v116, v95, v248
    v_mul_f32 v113, v94, v249
    v_mfma_f32_16x16x32_bf16 v[76:79], v[36:39], a[128:131], v[76:79]
    v_mul_f32 v117, v96, v253
    v_fmac_f32 v113, v95, v253
    v_fmac_f32 v117, v95, v249
    v_mul_f32 v114, v94, v250
    s_waitcnt lgkmcnt(4)
    v_mfma_f32_16x16x32_bf16 v[64:67], v[40:43], a[52:55], v[64:67]
    ds_read_b128 v[32:35], v17 offset:8192
    v_mul_f32 v118, v96, v254
    v_fmac_f32 v114, v95, v254
    v_fmac_f32 v118, v95, v250
    v_mfma_f32_16x16x32_bf16 v[68:71], v[40:43], a[132:135], v[68:71]
    ds_read_b128 v[36:39], v17 offset:28672
    v_mul_f32 v115, v94, v251
    v_mul_f32 v119, v96, v255
    v_fmac_f32 v115, v95, v255
    v_mfma_f32_16x16x32_bf16 v[72:75], v[44:47], a[52:55], v[72:75]
    v_fmac_f32 v119, v95, v251
    v_cvt_pk_bf16_f32 v100, v112, v113
    v_cvt_pk_bf16_f32 v101, v114, v115
    v_cvt_pk_bf16_f32 v102, v116, v117
    v_cvt_pk_bf16_f32 v103, v118, v119
    ds_write_b64 v18, v[100:101]
    ds_write_b64 v18, v[102:103] offset:512
    v_mfma_f32_16x16x32_bf16 v[76:79], v[44:47], a[132:135], v[76:79]
    s_waitcnt lgkmcnt(6)
    v_mfma_f32_16x16x32_bf16 v[64:67], v[48:51], a[56:59], v[64:67]
    ds_read_b128 v[40:43], v19 offset:8192
    s_waitcnt lgkmcnt(1)
    v_mfma_f32_16x16x32_bf16 v[68:71], v[48:51], a[136:139], v[68:71]
    ds_read_b128 v[44:47], v19 offset:28672
    ds_read_b64_tr_b16 v[24:25], v20
    ds_read_b64_tr_b16 v[26:27], v20 offset:512
    s_add_u32 s28, s77, 81920
    v_mfma_f32_16x16x32_bf16 v[72:75], v[52:55], a[56:59], v[72:75]
    s_waitcnt lgkmcnt(0)
    v_mfma_f32_16x16x32_bf16 v[76:79], v[52:55], a[136:139], v[76:79]
    buffer_store_dwordx4 v[24:27], v4, s[4:7], s28 offen sc1
    s_add_u32 s77, s77, 163840
    v_mfma_f32_16x16x32_bf16 v[64:67], v[56:59], a[60:63], v[64:67]
    ds_read_b128 v[48:51], v17 offset:9216
    v_mfma_f32_16x16x32_bf16 v[68:71], v[56:59], a[140:143], v[68:71]
    ds_read_b128 v[52:55], v17 offset:29696
    v_mfma_f32_16x16x32_bf16 v[72:75], v[60:63], a[60:63], v[72:75]
    v_mfma_f32_16x16x32_bf16 v[76:79], v[60:63], a[140:143], v[76:79]
    v_mfma_f32_16x16x32_bf16 v[64:67], v[32:35], a[64:67], v[64:67]
    ds_read_b128 v[56:59], v19 offset:9216
    v_mfma_f32_16x16x32_bf16 v[68:71], v[32:35], a[144:147], v[68:71]
    ds_read_b128 v[60:63], v19 offset:29696
    v_mfma_f32_16x16x32_bf16 v[72:75], v[36:39], a[64:67], v[72:75]
    v_mfma_f32_16x16x32_bf16 v[76:79], v[36:39], a[144:147], v[76:79]
    s_waitcnt lgkmcnt(0)
L_s5_join:
    s_waitcnt vmcnt(13) lgkmcnt(0)
    s_barrier
    s_add_u32 s87, s87, 1
    s_cmp_eq_u32 s87, 3
    s_cselect_b32 s87, 0, s87
    s_cselect_b32 s28, -2, 1
    s_mul_i32 s28, s28, 40960
    v_add_u32 v17, s28, v17
    v_add_u32 v19, s28, v19
    v_add_u32 v22, s28, v22
    s_sub_u32 s29, s26, 1
    s_cmp_lt_u32 s26, 3
    s_cselect_b32 s29, s26, s29
    v_mfma_f32_16x16x32_bf16 v[64:67], v[40:43], a[68:71], v[64:67]
    v_mov_b32 v6, s29
    s_mov_b64 exec, 1
    buffer_store_dword v6, v5, s[4:7], s89 offen sc1
    s_mov_b64 exec, -1
    v_mfma_f32_16x16x32_bf16 v[68:71], v[40:43], a[148:151], v[68:71]
    v_mfma_f32_16x16x32_bf16 v[72:75], v[44:47], a[68:71], v[72:75]
    v_mfma_f32_16x16x32_bf16 v[76:79], v[44:47], a[148:151], v[76:79]
    v_mfma_f32_16x16x32_bf16 v[64:67], v[48:51], a[72:75], v[64:67]
    v_mfma_f32_16x16x32_bf16 v[68:71], v[48:51], a[152:155], v[68:71]
    v_mfma_f32_16x16x32_bf16 v[72:75], v[52:55], a[72:75], v[72:75]
    v_mfma_f32_16x16x32_bf16 v[76:79], v[52:55], a[152:155], v[76:79]
    v_mfma_f32_16x16x32_bf16 v[64:67], v[56:59], a[76:79], v[64:67]
    v_mfma_f32_16x16x32_bf16 v[68:71], v[56:59], a[156:159], v[68:71]
    v_mfma_f32_16x16x32_bf16 v[72:75], v[60:63], a[76:79], v[72:75]
    v_mfma_f32_16x16x32_bf16 v[76:79], v[60:63], a[156:159], v[76:79]
    ds_read_b128 v[32:35], v17 offset:0
    ds_read_b128 v[36:39], v17 offset:20480
    ds_read_b128 v[40:43], v19 offset:0
    ds_read_b128 v[44:47], v19 offset:20480
    ds_read_b128 v[48:51], v17 offset:1024
    ds_read_b128 v[52:55], v17 offset:21504
    v_mov_b32 v240, v64
    v_mov_b32 v241, v65
    v_mov_b32 v242, v66
    v_mov_b32 v243, v67
    v_mov_b32 v244, v68
    v_mov_b32 v245, v69
    v_mov_b32 v246, v70
    v_mov_b32 v247, v71
    v_mov_b32 v248, v72
    v_mov_b32 v249, v73
    v_mov_b32 v250, v74
    v_mov_b32 v251, v75
    v_mov_b32 v252, v76
    v_mov_b32 v253, v77
    v_mov_b32 v254, v78
    v_mov_b32 v255, v79
    s_waitcnt lgkmcnt(0)
    s_add_u32 s26, s26, 1
    s_sub_u32 s28, s26, 3
    s_cmp_lt_u32 s28, 61
    s_cbranch_scc1 L_s5_top
    s_branch L_s5_now
L_s5_end:
    s_add_u32 s25, s25, 8
    s_branch L_join
L_out:
L_join:
    s_mov_b32 s20, s68
    s_mov_b32 s21, s69
    s_mov_b32 s22, 0x100
    s_mov_b32 s23, 0x20000
    s_cmp_lg_u32 s24, 0
    s_cbranch_scc1 Lgod_113
    v_mov_b32 v5, 132
    s_mov_b32 exec_lo, 0
    v_mov_b32 v5, 140
    s_mov_b64 exec, -1
Lgo_112:
    buffer_load_dword v6, v5, s[20:23], 0 offen sc1
    s_waitcnt vmcnt(0)
    v_cmp_eq_u32 vcc, 0, v6
    s_cbranch_vccz Lgod_113
    s_sleep 2
    s_sub_u32 s27, s27, 1
    s_cbranch_scc1 L_exit
    s_branch Lgo_112
Lgod_113:
    s_barrier
    s_mul_i32 s29, s25, 6554
    s_lshr_b32 s29, s29, 16
    s_mul_i32 s28, s29, 10
    s_sub_u32 s74, s25, s28
    s_lshl_b32 s90, s74, 7
    s_add_u32 s90, s90, 0xba18000
    v_mov_b32 v5, 0
    v_mul_u32_u24 v14, 20480, v1
    s_mul_i32 s76, s24, 20480
    v_mov_b32 v15, s76
    s_cmp_lg_u32 s24, 0
    s_cbranch_scc1 Ltk_114
    v_mov_b32 v27, 1
    s_mov_b64 exec, 1
    buffer_atomic_add v27, v5, s[4:7], s90 offen sc0 sc1
    s_mov_b64 exec, -1
Ltk_114:
    s_waitcnt vmcnt(0)
    s_barrier
    s_cmp_lg_u32 s24, 0
    s_cbranch_scc1 Ltk_115
    v_readfirstlane_b32 s28, v27
    s_nop 1
    v_mov_b32 v27, s28
    s_mov_b64 exec, 15
    ds_write_b32 v14, v27
    s_mov_b64 exec, -1
    s_waitcnt lgkmcnt(0)
Ltk_115:
    s_barrier
    ds_read_b32 v6, v15
    s_waitcnt lgkmcnt(0)
    v_readfirstlane_b32 s26, v6
    s_nop 0
    s_cmp_ge_u32 s26, 64
    s_cbranch_scc1 L_exit
    s_lshl_b32 s74, s74, 2
    s_add_u32 s74, s74, s24
    s_mov_b32 s20, s62
    s_mov_b32 s21, s63
    s_mov_b32 s22, 0x500
    s_mov_b32 s23, 0x20000
    s_mov_b32 s84, s66
    s_mov_b32 s85, s67
    s_mov_b32 s86, 0x500000
    s_mov_b32 s87, 0x20000
    v_lshlrev_b32 v7, 3, v3
    s_lshl_b32 s28, s74, 5
    buffer_load_dwordx2 v[80:81], v7, s[20:23], s28 offen
    v_mul_u32_u24 v16, 1280, v2
    v_add_u32 v16, v16, v7
    s_mul_i32 s29, s74, 40960
    s_add_u32 s29, s29, 0xbe00000
    buffer_load_dwordx4 a[0:3], v4, s[4:7], s29 offen offset:0 sc1
    buffer_load_dwordx4 a[4:7], v4, s[4:7], s29 offen offset:1024 sc1
    buffer_load_dwordx4 a[8:11], v4, s[4:7], s29 offen offset:2048 sc1
    buffer_load_dwordx4 a[12:15], v4, s[4:7], s29 offen offset:3072 sc1
    s_add_u32 s29, s29, 4096
    buffer_load_dwordx4 a[16:19], v4, s[4:7], s29 offen offset:0 sc1
    buffer_load_dwordx4 a[20:23], v4, s[4:7], s29 offen offset:1024 sc1
    buffer_load_dwordx4 a[24:27], v4, s[4:7], s29 offen offset:2048 sc1
    buffer_load_dwordx4 a[28:31], v4, s[4:7], s29 offen offset:3072 sc1
    s_add_u32 s29, s29, 4096
    buffer_load_dwordx4 a[32:35], v4, s[4:7], s29 offen offset:0 sc1
    buffer_load_dwordx4 a[36:39], v4, s[4:7], s29 offen offset:1024 sc1
    buffer_load_dwordx4 a[40:43], v4, s[4:7], s29 offen offset:2048 sc1
    buffer_load_dwordx4 a[44:47], v4, s[4:7], s29 offen offset:3072 sc1
    s_add_u32 s29, s29, 4096
    buffer_load_dwordx4 a[48:51], v4, s[4:7], s29 offen offset:0 sc1
    buffer_load_dwordx4 a[52:55], v4, s[4:7], s29 offen offset:1024 sc1
    buffer_load_dwordx4 a[56:59], v4, s[4:7], s29 offen offset:2048 sc1
    buffer_load_dwordx4 a[60:63], v4, s[4:7], s29 offen offset:3072 sc1
    s_add_u32 s29, s29, 4096
    buffer_load_dwordx4 a[64:67], v4, s[4:7], s29 offen offset:0 sc1
    buffer_load_dwordx4 a[68:71], v4, s[4:7], s29 offen offset:1024 sc1
    buffer_load_dwordx4 a[72:75], v4, s[4:7], s29 offen offset:2048 sc1
    buffer_load_dwordx4 a[76:79], v4, s[4:7], s29 offen offset:3072 sc1
    s_add_u32 s29, s29, 4096
    buffer_load_dwordx4 a[80:83], v4, s[4:7], s29 offen offset:0 sc1
    buffer_load_dwordx4 a[84:87], v4, s[4:7], s29 offen offset:1024 sc1
    buffer_load_dwordx4 a[88:91], v4, s[4:7], s29 offen offset:2048 sc1
    buffer_load_dwordx4 a[92:95], v4, s[4:7], s29 offen offset:3072 sc1
    s_add_u32 s29, s29, 4096
    buffer_load_dwordx4 a[96:99], v4, s[4:7], s29 offen offset:0 sc1
    buffer_load_dwordx4 a[100:103], v4, s[4:7], s29 offen offset:1024 sc1
    buffer_load_dwordx4 a[104:107], v4, s[4:7], s29 offen offset:2048 sc1
    buffer_load_dwordx4 a[108:111], v4, s[4:7], s29 offen offset:3072 sc1
    s_add_u32 s29, s29, 4096
    buffer_load_dwordx4 a[112:115], v4, s[4:7], s29 offen offset:0 sc1
    buffer_load_dwordx4 a[116:119], v4, s[4:7], s29 offen offset:1024 sc1
    buffer_load_dwordx4 a[120:123], v4, s[4:7], s29 offen offset:2048 sc1
    buffer_load_dwordx4 a[124:127], v4, s[4:7], s29 offen offset:3072 sc1
    s_add_u32 s29, s29, 4096
    buffer_load_dwordx4 a[128:131], v4, s[4:7], s29 offen offset:0 sc1
    buffer_load_dwordx4 a[132:135], v4, s[4:7], s29 offen offset:1024 sc1
    buffer_load_dwordx4 a[136:139], v4, s[4:7], s29 offen offset:2048 sc1
    buffer_load_dwordx4 a[140:143], v4, s[4:7], s29 offen offset:3072 sc1
    s_add_u32 s29, s29, 4096
    buffer_load_dwordx4 a[144:147], v4, s[4:7], s29 offen offset:0 sc1
    buffer_load_dwordx4 a[148:151], v4, s[4:7], s29 offen offset:1024 sc1
    buffer_load_dwordx4 a[152:155], v4, s[4:7], s29 offen offset:2048 sc1
    buffer_load_dwordx4 a[156:159], v4, s[4:7], s29 offen offset:3072 sc1
    s_add_u32 s29, s29, 4096
    s_waitcnt vmcnt(0)
    v_lshlrev_b32 v28, 16, v80
    v_and_b32 v29, 0xffff0000, v80
    v_lshlrev_b32 v30, 16, v81
    v_and_b32 v31, 0xffff0000, v81
    v_mov_b32 v5, 0
    v_lshlrev_b32 v23, 2, v2
    v_and_b32 v17, 31, v1
    v_lshlrev_b32 v17, 7, v17
    v_min_u32 v18, 9, v1
    v_lshlrev_b32 v18, 7, v18
    s_mov_b32 s81, 0xba12000
    s_mov_b32 s82, 0xba15800
    s_mov_b32 s83, 0xba16000
    v_mov_b32 v19, v17
    s_lshl_b32 s28, s74, 8
    s_add_u32 s28, s28, 4096
    s_mov_b32 exec_lo, 0
    v_and_b32 v17, 128, v17
    v_add_u32 v17, s28, v17
    s_mov_b64 exec, -1
    v_lshlrev_b32 v22, 1, v16
    v_add_u32 v24, 40960, v4
    v_add_u32 v25, 81920, v4
    v_add_u32 v26, 122880, v4
    s_lshr_b32 s28, s24, 1
    s_mul_i32 s94, s28, 81920
    s_and_b32 s28, s24, 1
    s_mul_i32 s28, s28, 20480
    s_add_u32 s94, s94, s28
    s_add_u32 s94, s94, 0x4800000
    s_mov_b32 s91, 0
    s_mov_b32 s95, 0x10000000
L_out_top:
    buffer_load_dword v7, v19, s[4:7], s83 offen sc1
    buffer_load_dword v20, v17, s[4:7], s81 offen sc1
    s_mul_i32 s75, s26, 163840
    s_add_u32 s75, s75, s94
    s_mul_i32 s28, s74, 2117632
    s_lshl_b32 s77, s26, 15
    s_add_u32 s77, s77, s28
    s_add_u32 s77, s77, 0x5200000
    s_mul_i32 s28, s74, 528384
    s_lshl_b32 s78, s26, 13
    s_add_u32 s78, s78, s28
    s_add_u32 s78, s78, 0xa400000
    s_mul_i32 s79, s26, 40960
    s_lshl_b32 s28, s74, 5
    s_add_u32 s28, s28, s79
    s_lshl_b32 s80, s28, 1
    buffer_load_dwordx2 v[80:81], v16, s[8:11], s28 offen
    s_add_u32 s28, s28, 20480
    buffer_load_dwordx2 v[82:83], v16, s[8:11], s28 offen
    s_cmp_lg_u32 s91, 0
    s_cbranch_scc1 L_out_h1
Lwv_116:
    buffer_load_dword v6, v18, s[4:7], s82 offen sc1
    s_waitcnt vmcnt(0)
    v_cmp_ge_u32 vcc, s26, v6
    s_cbranch_vccz Lwvd_117
    s_sleep 8
    s_sub_u32 s27, s27, 1
    s_cbranch_scc1 L_exit
    s_branch Lwv_116
Lwvd_117:
    s_add_u32 s93, s75, 40960
    s_add_u32 m0, s76, 0
    s_nop 0
    buffer_load_dwordx4 v4, s[4:7], s93 offen offset:0 sc1 lds
    buffer_load_dwordx4 v4, s[4:7], s93 offen offset:1024 sc1 lds
    buffer_load_dwordx4 v4, s[4:7], s93 offen offset:2048 sc1 lds
    buffer_load_dwordx4 v4, s[4:7], s93 offen offset:3072 sc1 lds
    s_add_u32 m0, m0, 4096
    s_add_u32 s93, s93, 4096
    buffer_load_dwordx4 v4, s[4:7], s93 offen offset:0 sc1 lds
    buffer_load_dwordx4 v4, s[4:7], s93 offen offset:1024 sc1 lds
    buffer_load_dwordx4 v4, s[4:7], s93 offen offset:2048 sc1 lds
    buffer_load_dwordx4 v4, s[4:7], s93 offen offset:3072 sc1 lds
    s_add_u32 m0, m0, 4096
    s_add_u32 s93, s93, 4096
    buffer_load_dwordx4 v4, s[4:7], s93 offen offset:0 sc1 lds
    buffer_load_dwordx4 v4, s[4:7], s93 offen offset:1024 sc1 lds
    buffer_load_dwordx4 v4, s[4:7], s93 offen offset:2048 sc1 lds
    buffer_load_dwordx4 v4, s[4:7], s93 offen offset:3072 sc1 lds
    s_add_u32 m0, m0, 4096
    s_add_u32 s93, s93, 4096
    buffer_load_dwordx4 v4, s[4:7], s93 offen offset:0 sc1 lds
    buffer_load_dwordx4 v4, s[4:7], s93 offen offset:1024 sc1 lds
    buffer_load_dwordx4 v4, s[4:7], s93 offen offset:2048 sc1 lds
    buffer_load_dwordx4 v4, s[4:7], s93 offen offset:3072 sc1 lds
    s_add_u32 m0, m0, 4096
    s_add_u32 s93, s93, 4096
    buffer_load_dwordx4 v4, s[4:7], s93 offen offset:0 sc1 lds
    buffer_load_dwordx4 v4, s[4:7], s93 offen offset:1024 sc1 lds
    buffer_load_dwordx4 v4, s[4:7], s93 offen offset:2048 sc1 lds
    buffer_load_dwordx4 v4, s[4:7], s93 offen offset:3072 sc1 lds
L_out_h1:
    s_lshl_b32 s28, s26, 7
    s_add_u32 s28, s28, 0xba30000
    buffer_load_dword v84, v23, s[4:7], s28 offen sc1
    buffer_load_dword v85, v23, s[4:7], s28 offen offset:64 sc1
    s_waitcnt vmcnt(0)
    s_barrier
    v_cmp_ge_u32 vcc, s26, v20
    s_nop 0
    s_cmp_eq_u64 vcc, 0
    s_cselect_b32 s92, 1, 0
    s_cbranch_scc0 L_out_p0
    s_add_u32 s93, s75, 0
    s_add_u32 m0, s76, 81920
    s_nop 0
    buffer_load_dwordx4 v4, s[4:7], s93 offen offset:0 sc1 lds
    buffer_load_dwordx4 v4, s[4:7], s93 offen offset:1024 sc1 lds
    buffer_load_dwordx4 v4, s[4:7], s93 offen offset:2048 sc1 lds
    buffer_load_dwordx4 v4, s[4:7], s93 offen offset:3072 sc1 lds
    s_add_u32 m0, m0, 4096
    s_add_u32 s93, s93, 4096
    buffer_load_dwordx4 v4, s[4:7], s93 offen offset:0 sc1 lds
    buffer_load_dwordx4 v4, s[4:7], s93 offen offset:1024 sc1 lds
    buffer_load_dwordx4 v4, s[4:7], s93 offen offset:2048 sc1 lds
    buffer_load_dwordx4 v4, s[4:7], s93 offen offset:3072 sc1 lds
    s_add_u32 m0, m0, 4096
    s_add_u32 s93, s93, 4096
    buffer_load_dwordx4 v4, s[4:7], s93 offen offset:0 sc1 lds
    buffer_load_dwordx4 v4, s[4:7], s93 offen offset:1024 sc1 lds
    buffer_load_dwordx4 v4, s[4:7], s93 offen offset:2048 sc1 lds
    buffer_load_dwordx4 v4, s[4:7], s93 offen offset:3072 sc1 lds
    s_add_u32 m0, m0, 4096
    s_add_u32 s93, s93, 4096
    buffer_load_dwordx4 v4, s[4:7], s93 offen offset:0 sc1 lds
    buffer_load_dwordx4 v4, s[4:7], s93 offen offset:1024 sc1 lds
    buffer_load_dwordx4 v4, s[4:7], s93 offen offset:2048 sc1 lds
    buffer_load_dwordx4 v4, s[4:7], s93 offen offset:3072 sc1 lds
    s_add_u32 m0, m0, 4096
    s_add_u32 s93, s93, 4096
    buffer_load_dwordx4 v4, s[4:7], s93 offen offset:0 sc1 lds
    buffer_load_dwordx4 v4, s[4:7], s93 offen offset:1024 sc1 lds
    buffer_load_dwordx4 v4, s[4:7], s93 offen offset:2048 sc1 lds
    buffer_load_dwordx4 v4, s[4:7], s93 offen offset:3072 sc1 lds
    buffer_load_dwordx4 v[224:227], v4, s[4:7], s78 offen offset:0 sc1
    buffer_load_dwordx4 v[228:231], v4, s[4:7], s78 offen offset:1024 sc1
    buffer_load_dwordx4 v[232:235], v4, s[4:7], s78 offen offset:2048 sc1
    buffer_load_dwordx4 v[236:239], v4, s[4:7], s78 offen offset:3072 sc1
    s_add_u32 s78, s78, 4096
    buffer_load_dwordx4 v[240:243], v4, s[4:7], s78 offen offset:0 sc1
    buffer_load_dwordx4 v[244:247], v4, s[4:7], s78 offen offset:1024 sc1
    buffer_load_dwordx4 v[248:251], v4, s[4:7], s78 offen offset:2048 sc1
    buffer_load_dwordx4 v[252:255], v4, s[4:7], s78 offen offset:3072 sc1
L_out_p0:
    v_cmp_ge_u32 vcc, s26, v7
    s_nop 0
    s_cmp_eq_u64 vcc, 0
    s_cselect_b32 s88, 1, 0
    s_cselect_b32 s30, s77, s95
    ds_read_b128 v[48:51], v4 offset:0
    ds_read_b128 v[52:55], v24 offset:0
    ds_read_b128 v[56:59], v4 offset:1024
    ds_read_b128 v[60:63], v24 offset:1024
    ds_read_b128 v[64:67], v4 offset:2048
    ds_read_b128 v[68:71], v24 offset:2048
    s_waitcnt lgkmcnt(4)
    v_mfma_f32_16x16x32_bf16 v[32:35], a[0:3], v[48:51], 0
    ds_read_b128 v[72:75], v4 offset:3072
    buffer_load_dwordx4 v[96:99], v4, s[4:7], s30 offen offset:0 sc1
    v_mfma_f32_16x16x32_bf16 v[36:39], a[0:3], v[52:55], 0
    ds_read_b128 v[76:79], v24 offset:3072
    s_waitcnt lgkmcnt(4)
    v_mfma_f32_16x16x32_bf16 v[88:91], a[4:7], v[56:59], 0
    ds_read_b128 v[48:51], v4 offset:4096
    buffer_load_dwordx4 v[100:103], v4, s[4:7], s30 offen offset:1024 sc1
    v_mfma_f32_16x16x32_bf16 v[92:95], a[4:7], v[60:63], 0
    ds_read_b128 v[52:55], v24 offset:4096
    s_waitcnt lgkmcnt(4)
    v_mfma_f32_16x16x32_bf16 v[32:35], a[8:11], v[64:67], v[32:35]
    ds_read_b128 v[56:59], v4 offset:5120
    buffer_load_dwordx4 v[104:107], v4, s[4:7], s30 offen offset:2048 sc1
    v_mfma_f32_16x16x32_bf16 v[36:39], a[8:11], v[68:71], v[36:39]
    ds_read_b128 v[60:63], v24 offset:5120
    s_waitcnt lgkmcnt(4)
    v_mfma_f32_16x16x32_bf16 v[88:91], a[12:15], v[72:75], v[88:91]
    ds_read_b128 v[64:67], v4 offset:6144
    buffer_load_dwordx4 v[108:111], v4, s[4:7], s30 offen offset:3072 sc1
    s_add_u32 s30, s30, 4096
    v_mfma_f32_16x16x32_bf16 v[92:95], a[12:15], v[76:79], v[92:95]
    ds_read_b128 v[68:71], v24 offset:6144
    s_waitcnt lgkmcnt(4)
    v_mfma_f32_16x16x32_bf16 v[32:35], a[16:19], v[48:51], v[32:35]
    ds_read_b128 v[72:75], v4 offset:7168
    buffer_load_dwordx4 v[112:115], v4, s[4:7], s30 offen offset:0 sc1
    v_mfma_f32_16x16x32_bf16 v[36:39], a[16:19], v[52:55], v[36:39]
    ds_read_b128 v[76:79], v24 offset:7168
    s_waitcnt lgkmcnt(4)
    v_mfma_f32_16x16x32_bf16 v[88:91], a[20:23], v[56:59], v[88:91]
    ds_read_b128 v[48:51], v4 offset:8192
    buffer_load_dwordx4 v[116:119], v4, s[4:7], s30 offen offset:1024 sc1
    v_mfma_f32_16x16x32_bf16 v[92:95], a[20:23], v[60:63], v[92:95]
    ds_read_b128 v[52:55], v24 offset:8192
    s_waitcnt lgkmcnt(4)
    v_mfma_f32_16x16x32_bf16 v[32:35], a[24:27], v[64:67], v[32:35]
    ds_read_b128 v[56:59], v4 offset:9216
    buffer_load_dwordx4 v[120:123], v4, s[4:7], s30 offen offset:2048 sc1
    v_mfma_f32_16x16x32_bf16 v[36:39], a[24:27], v[68:71], v[36:39]
    ds_read_b128 v[60:63], v24 offset:9216
    s_waitcnt lgkmcnt(4)
    v_mfma_f32_16x16x32_bf16 v[88:91], a[28:31], v[72:75], v[88:91]
    ds_read_b128 v[64:67], v4 offset:10240
    buffer_load_dwordx4 v[124:127], v4, s[4:7], s30 offen offset:3072 sc1
    s_add_u32 s30, s30, 4096
    v_mfma_f32_16x16x32_bf16 v[92:95], a[28:31], v[76:79], v[92:95]
    ds_read_b128 v[68:71], v24 offset:10240
    s_waitcnt lgkmcnt(4)
    v_mfma_f32_16x16x32_bf16 v[32:35], a[32:35], v[48:51], v[32:35]
    ds_read_b128 v[72:75], v4 offset:11264
    buffer_load_dwordx4 v[128:131], v4, s[4:7], s30 offen offset:0 sc1
    v_mfma_f32_16x16x32_bf16 v[36:39], a[32:35], v[52:55], v[36:39]
    ds_read_b128 v[76:79], v24 offset:11264
    s_waitcnt lgkmcnt(4)
    v_mfma_f32_16x16x32_bf16 v[88:91], a[36:39], v[56:59], v[88:91]
    ds_read_b128 v[48:51], v4 offset:12288
    buffer_load_dwordx4 v[132:135], v4, s[4:7], s30 offen offset:1024 sc1
    v_mfma_f32_16x16x32_bf16 v[92:95], a[36:39], v[60:63], v[92:95]
    ds_read_b128 v[52:55], v24 offset:12288
    s_waitcnt lgkmcnt(4)
    v_mfma_f32_16x16x32_bf16 v[32:35], a[40:43], v[64:67], v[32:35]
    ds_read_b128 v[56:59], v4 offset:13312
    buffer_load_dwordx4 v[136:139], v4, s[4:7], s30 offen offset:2048 sc1
    v_mfma_f32_16x16x32_bf16 v[36:39], a[40:43], v[68:71], v[36:39]
    ds_read_b128 v[60:63], v24 offset:13312
    s_waitcnt lgkmcnt(4)
    v_mfma_f32_16x16x32_bf16 v[88:91], a[44:47], v[72:75], v[88:91]
    ds_read_b128 v[64:67], v4 offset:14336
    buffer_load_dwordx4 v[140:143], v4, s[4:7], s30 offen offset:3072 sc1
    s_add_u32 s30, s30, 4096
    v_mfma_f32_16x16x32_bf16 v[92:95], a[44:47], v[76:79], v[92:95]
    ds_read_b128 v[68:71], v24 offset:14336
    s_waitcnt lgkmcnt(4)
    v_mfma_f32_16x16x32_bf16 v[32:35], a[48:51], v[48:51], v[32:35]
    ds_read_b128 v[72:75], v4 offset:15360
    buffer_load_dwordx4 v[144:147], v4, s[4:7], s30 offen offset:0 sc1
    v_mfma_f32_16x16x32_bf16 v[36:39], a[48:51], v[52:55], v[36:39]
    ds_read_b128 v[76:79], v24 offset:15360
    s_waitcnt lgkmcnt(4)
    v_mfma_f32_16x16x32_bf16 v[88:91], a[52:55], v[56:59], v[88:91]
    ds_read_b128 v[48:51], v4 offset:16384
    buffer_load_dwordx4 v[148:151], v4, s[4:7], s30 offen offset:1024 sc1
    v_mfma_f32_16x16x32_bf16 v[92:95], a[52:55], v[60:63], v[92:95]
    ds_read_b128 v[52:55], v24 offset:16384
    s_waitcnt lgkmcnt(4)
    v_mfma_f32_16x16x32_bf16 v[32:35], a[56:59], v[64:67], v[32:35]
    ds_read_b128 v[56:59], v4 offset:17408
    buffer_load_dwordx4 v[152:155], v4, s[4:7], s30 offen offset:2048 sc1
    v_mfma_f32_16x16x32_bf16 v[36:39], a[56:59], v[68:71], v[36:39]
    ds_read_b128 v[60:63], v24 offset:17408
    s_waitcnt lgkmcnt(4)
    v_mfma_f32_16x16x32_bf16 v[88:91], a[60:63], v[72:75], v[88:91]
    ds_read_b128 v[64:67], v4 offset:18432
    buffer_load_dwordx4 v[156:159], v4, s[4:7], s30 offen offset:3072 sc1
    s_add_u32 s30, s30, 4096
    v_mfma_f32_16x16x32_bf16 v[92:95], a[60:63], v[76:79], v[92:95]
    ds_read_b128 v[68:71], v24 offset:18432
    s_waitcnt lgkmcnt(4)
    v_mfma_f32_16x16x32_bf16 v[32:35], a[64:67], v[48:51], v[32:35]
    ds_read_b128 v[72:75], v4 offset:19456
    s_waitcnt vmcnt(36)
    buffer_load_dwordx4 v[160:163], v4, s[4:7], s30 offen offset:0 sc1
    v_mfma_f32_16x16x32_bf16 v[36:39], a[64:67], v[52:55], v[36:39]
    ds_read_b128 v[76:79], v24 offset:19456
    s_waitcnt lgkmcnt(4)
    v_mfma_f32_16x16x32_bf16 v[88:91], a[68:71], v[56:59], v[88:91]
    ds_read_b128 v[48:51], v4 offset:20480
    buffer_load_dwordx4 v[164:167], v4, s[4:7], s30 offen offset:1024 sc1
    v_mfma_f32_16x16x32_bf16 v[92:95], a[68:71], v[60:63], v[92:95]
    ds_read_b128 v[52:55], v24 offset:20480
    s_waitcnt lgkmcnt(4)
    v_mfma_f32_16x16x32_bf16 v[32:35], a[72:75], v[64:67], v[32:35]
    ds_read_b128 v[56:59], v4 offset:21504
    buffer_load_dwordx4 v[168:171], v4, s[4:7], s30 offen offset:2048 sc1
    v_mfma_f32_16x16x32_bf16 v[36:39], a[72:75], v[68:71], v[36:39]
    ds_read_b128 v[60:63], v24 offset:21504
    s_waitcnt lgkmcnt(4)
    v_mfma_f32_16x16x32_bf16 v[88:91], a[76:79], v[72:75], v[88:91]
    ds_read_b128 v[64:67], v4 offset:22528
    buffer_load_dwordx4 v[172:175], v4, s[4:7], s30 offen offset:3072 sc1
    s_add_u32 s30, s30, 4096
    v_mfma_f32_16x16x32_bf16 v[92:95], a[76:79], v[76:79], v[92:95]
    ds_read_b128 v[68:71], v24 offset:22528
    s_waitcnt lgkmcnt(4)
    v_mfma_f32_16x16x32_bf16 v[32:35], a[80:83], v[48:51], v[32:35]
    ds_read_b128 v[72:75], v4 offset:23552
    buffer_load_dwordx4 v[176:179], v4, s[4:7], s30 offen offset:0 sc1
    v_mfma_f32_16x16x32_bf16 v[36:39], a[80:83], v[52:55], v[36:39]
    ds_read_b128 v[76:79], v24 offset:23552
    s_waitcnt lgkmcnt(4)
    v_mfma_f32_16x16x32_bf16 v[88:91], a[84:87], v[56:59], v[88:91]
    ds_read_b128 v[48:51], v4 offset:24576
    buffer_load_dwordx4 v[180:183], v4, s[4:7], s30 offen offset:1024 sc1
    v_mfma_f32_16x16x32_bf16 v[92:95], a[84:87], v[60:63], v[92:95]
    ds_read_b128 v[52:55], v24 offset:24576
    s_waitcnt lgkmcnt(4)
    v_mfma_f32_16x16x32_bf16 v[32:35], a[88:91], v[64:67], v[32:35]
    ds_read_b128 v[56:59], v4 offset:25600
    buffer_load_dwordx4 v[184:187], v4, s[4:7], s30 offen offset:2048 sc1
    v_mfma_f32_16x16x32_bf16 v[36:39], a[88:91], v[68:71], v[36:39]
    ds_read_b128 v[60:63], v24 offset:25600
    s_waitcnt lgkmcnt(4)
    v_mfma_f32_16x16x32_bf16 v[88:91], a[92:95], v[72:75], v[88:91]
    ds_read_b128 v[64:67], v4 offset:26624
    buffer_load_dwordx4 v[188:191], v4, s[4:7], s30 offen offset:3072 sc1
    s_add_u32 s30, s30, 4096
    v_mfma_f32_16x16x32_bf16 v[92:95], a[92:95], v[76:79], v[92:95]
    ds_read_b128 v[68:71], v24 offset:26624
    s_waitcnt lgkmcnt(4)
    v_mfma_f32_16x16x32_bf16 v[32:35], a[96:99], v[48:51], v[32:35]
    ds_read_b128 v[72:75], v4 offset:27648
    buffer_load_dwordx4 v[192:195], v4, s[4:7], s30 offen offset:0 sc1
    v_mfma_f32_16x16x32_bf16 v[36:39], a[96:99], v[52:55], v[36:39]
    ds_read_b128 v[76:79], v24 offset:27648
    s_waitcnt lgkmcnt(4)
    v_mfma_f32_16x16x32_bf16 v[88:91], a[100:103], v[56:59], v[88:91]
    ds_read_b128 v[48:51], v4 offset:28672
    buffer_load_dwordx4 v[196:199], v4, s[4:7], s30 offen offset:1024 sc1
    v_mfma_f32_16x16x32_bf16 v[92:95], a[100:103], v[60:63], v[92:95]
    ds_read_b128 v[52:55], v24 offset:28672
    s_waitcnt lgkmcnt(4)
    v_mfma_f32_16x16x32_bf16 v[32:35], a[104:107], v[64:67], v[32:35]
    ds_read_b128 v[56:59], v4 offset:29696
    buffer_load_dwordx4 v[200:203], v4, s[4:7], s30 offen offset:2048 sc1
    v_mfma_f32_16x16x32_bf16 v[36:39], a[104:107], v[68:71], v[36:39]
    ds_read_b128 v[60:63], v24 offset:29696
    s_waitcnt lgkmcnt(4)
    v_mfma_f32_16x16x32_bf16 v[88:91], a[108:111], v[72:75], v[88:91]
    ds_read_b128 v[64:67], v4 offset:30720
    buffer_load_dwordx4 v[204:207], v4, s[4:7], s30 offen offset:3072 sc1
    s_add_u32 s30, s30, 4096
    v_mfma_f32_16x16x32_bf16 v[92:95], a[108:111], v[76:79], v[92:95]
    ds_read_b128 v[68:71], v24 offset:30720
    s_waitcnt lgkmcnt(4)
    v_mfma_f32_16x16x32_bf16 v[32:35], a[112:115], v[48:51], v[32:35]
    ds_read_b128 v[72:75], v4 offset:31744
    buffer_load_dwordx4 v[208:211], v4, s[4:7], s30 offen offset:0 sc1
    v_mfma_f32_16x16x32_bf16 v[36:39], a[112:115], v[52:55], v[36:39]
    ds_read_b128 v[76:79], v24 offset:31744
    s_waitcnt lgkmcnt(4)
    v_mfma_f32_16x16x32_bf16 v[88:91], a[116:119], v[56:59], v[88:91]
    ds_read_b128 v[48:51], v4 offset:32768
    buffer_load_dwordx4 v[212:215], v4, s[4:7], s30 offen offset:1024 sc1
    v_mfma_f32_16x16x32_bf16 v[92:95], a[116:119], v[60:63], v[92:95]
    ds_read_b128 v[52:55], v24 offset:32768
    s_waitcnt lgkmcnt(4)
    v_mfma_f32_16x16x32_bf16 v[32:35], a[120:123], v[64:67], v[32:35]
    ds_read_b128 v[56:59], v4 offset:33792
    buffer_load_dwordx4 v[216:219], v4, s[4:7], s30 offen offset:2048 sc1
    v_mfma_f32_16x16x32_bf16 v[36:39], a[120:123], v[68:71], v[36:39]
    ds_read_b128 v[60:63], v24 offset:33792
    s_waitcnt lgkmcnt(4)
    v_mfma_f32_16x16x32_bf16 v[88:91], a[124:127], v[72:75], v[88:91]
    ds_read_b128 v[64:67], v4 offset:34816
    buffer_load_dwordx4 v[220:223], v4, s[4:7], s30 offen offset:3072 sc1
    s_add_u32 s30, s30, 4096
    v_mfma_f32_16x16x32_bf16 v[92:95], a[124:127], v[76:79], v[92:95]
    ds_read_b128 v[68:71], v24 offset:34816
    s_waitcnt lgkmcnt(4)
    v_mfma_f32_16x16x32_bf16 v[32:35], a[128:131], v[48:51], v[32:35]
    ds_read_b128 v[72:75], v4 offset:35840
    v_mfma_f32_16x16x32_bf16 v[36:39], a[128:131], v[52:55], v[36:39]
    ds_read_b128 v[76:79], v24 offset:35840
    s_waitcnt lgkmcnt(4)
    v_mfma_f32_16x16x32_bf16 v[88:91], a[132:135], v[56:59], v[88:91]
    ds_read_b128 v[48:51], v4 offset:36864
    v_mfma_f32_16x16x32_bf16 v[92:95], a[132:135], v[60:63], v[92:95]
    ds_read_b128 v[52:55], v24 offset:36864
    s_waitcnt lgkmcnt(4)
    v_mfma_f32_16x16x32_bf16 v[32:35], a[136:139], v[64:67], v[32:35]
    ds_read_b128 v[56:59], v4 offset:37888
    v_mfma_f32_16x16x32_bf16 v[36:39], a[136:139], v[68:71], v[36:39]
    ds_read_b128 v[60:63], v24 offset:37888
    s_waitcnt lgkmcnt(4)
    v_mfma_f32_16x16x32_bf16 v[88:91], a[140:143], v[72:75], v[88:91]
    ds_read_b128 v[64:67], v4 offset:38912
    v_mfma_f32_16x16x32_bf16 v[92:95], a[140:143], v[76:79], v[92:95]
    ds_read_b128 v[68:71], v24 offset:38912
    s_waitcnt lgkmcnt(4)
    v_mfma_f32_16x16x32_bf16 v[32:35], a[144:147], v[48:51], v[32:35]
    ds_read_b128 v[72:75], v4 offset:39936
    v_mfma_f32_16x16x32_bf16 v[36:39], a[144:147], v[52:55], v[36:39]
    ds_read_b128 v[76:79], v24 offset:39936
    s_waitcnt lgkmcnt(4)
    v_mfma_f32_16x16x32_bf16 v[88:91], a[148:151], v[56:59], v[88:91]
    v_mfma_f32_16x16x32_bf16 v[92:95], a[148:151], v[60:63], v[92:95]
    s_waitcnt lgkmcnt(2)
    v_mfma_f32_16x16x32_bf16 v[32:35], a[152:155], v[64:67], v[32:35]
    v_mfma_f32_16x16x32_bf16 v[36:39], a[152:155], v[68:71], v[36:39]
    s_waitcnt lgkmcnt(0)
    v_mfma_f32_16x16x32_bf16 v[88:91], a[156:159], v[72:75], v[88:91]
    v_mfma_f32_16x16x32_bf16 v[92:95], a[156:159], v[76:79], v[92:95]
    s_nop 4
    v_add_f32 v32, v32, v88
    v_add_f32 v33, v33, v89
    v_add_f32 v34, v34, v90
    v_add_f32 v35, v35, v91
    v_add_f32 v36, v36, v92
    v_add_f32 v37, v37, v93
    v_add_f32 v38, v38, v94
    v_add_f32 v39, v39, v95
    s_barrier
    v_lshlrev_b32 v86, 16, v80
    v_and_b32 v87, 0xffff0000, v80
    v_lshlrev_b32 v88, 16, v81
    v_and_b32 v89, 0xffff0000, v81
    v_mul_f32 v86, v86, v28
    v_mul_f32 v87, v87, v29
    v_mul_f32 v88, v88, v30
    v_mul_f32 v89, v89, v31
    v_cvt_pk_bf16_f32 v90, v86, v87
    v_lshlrev_b32 v86, 16, v90
    v_and_b32 v87, 0xffff0000, v90
    v_cvt_pk_bf16_f32 v90, v88, v89
    v_lshlrev_b32 v88, 16, v90
    v_and_b32 v89, 0xffff0000, v90
    v_sub_f32 v91, 1.0, v84
    v_cvt_pk_bf16_f32 v90, v91, v92
    v_lshlrev_b32 v91, 16, v90
    v_and_b32 v92, 0xffff0000, v90
    v_add_f32 v32, v32, v86
    v_mul_f32 v32, v32, v91
    v_add_f32 v33, v33, v87
    v_mul_f32 v33, v33, v91
    v_add_f32 v34, v34, v88
    v_mul_f32 v34, v34, v91
    v_add_f32 v35, v35, v89
    v_mul_f32 v35, v35, v91
    v_lshlrev_b32 v86, 16, v82
    v_and_b32 v87, 0xffff0000, v82
    v_lshlrev_b32 v88, 16, v83
    v_and_b32 v89, 0xffff0000, v83
    v_mul_f32 v86, v86, v28
    v_mul_f32 v87, v87, v29
    v_mul_f32 v88, v88, v30
    v_mul_f32 v89, v89, v31
    v_cvt_pk_bf16_f32 v90, v86, v87
    v_lshlrev_b32 v86, 16, v90
    v_and_b32 v87, 0xffff0000, v90
    v_cvt_pk_bf16_f32 v90, v88, v89
    v_lshlrev_b32 v88, 16, v90
    v_and_b32 v89, 0xffff0000, v90
    v_sub_f32 v91, 1.0, v85
    v_cvt_pk_bf16_f32 v90, v91, v92
    v_lshlrev_b32 v91, 16, v90
    v_and_b32 v92, 0xffff0000, v90
    v_add_f32 v36, v36, v86
    v_mul_f32 v36, v36, v91
    v_add_f32 v37, v37, v87
    v_mul_f32 v37, v37, v91
    v_add_f32 v38, v38, v88
    v_mul_f32 v38, v38, v91
    v_add_f32 v39, v39, v89
    v_mul_f32 v39, v39, v91
    s_cmp_lg_u32 s88, 0
    s_cbranch_scc1 L_out_z2
Lwv_118:
    buffer_load_dword v6, v19, s[4:7], s83 offen sc1
    s_waitcnt vmcnt(0)
    v_cmp_ge_u32 vcc, s26, v6
    s_cbranch_vccz Lwvd_119
    s_sleep 4
    s_sub_u32 s27, s27, 1
    s_cbranch_scc1 L_exit
    s_branch Lwv_118
Lwvd_119:
    buffer_load_dwordx4 v[96:99], v4, s[4:7], s77 offen offset:0 sc1
    buffer_load_dwordx4 v[100:103], v4, s[4:7], s77 offen offset:1024 sc1
    buffer_load_dwordx4 v[104:107], v4, s[4:7], s77 offen offset:2048 sc1
    buffer_load_dwordx4 v[108:111], v4, s[4:7], s77 offen offset:3072 sc1
    s_add_u32 s77, s77, 4096
    buffer_load_dwordx4 v[112:115], v4, s[4:7], s77 offen offset:0 sc1
    buffer_load_dwordx4 v[116:119], v4, s[4:7], s77 offen offset:1024 sc1
    buffer_load_dwordx4 v[120:123], v4, s[4:7], s77 offen offset:2048 sc1
    buffer_load_dwordx4 v[124:127], v4, s[4:7], s77 offen offset:3072 sc1
    s_add_u32 s77, s77, 4096
    buffer_load_dwordx4 v[128:131], v4, s[4:7], s77 offen offset:0 sc1
    buffer_load_dwordx4 v[132:135], v4, s[4:7], s77 offen offset:1024 sc1
    buffer_load_dwordx4 v[136:139], v4, s[4:7], s77 offen offset:2048 sc1
    buffer_load_dwordx4 v[140:143], v4, s[4:7], s77 offen offset:3072 sc1
    s_add_u32 s77, s77, 4096
    buffer_load_dwordx4 v[144:147], v4, s[4:7], s77 offen offset:0 sc1
    buffer_load_dwordx4 v[148:151], v4, s[4:7], s77 offen offset:1024 sc1
    buffer_load_dwordx4 v[152:155], v4, s[4:7], s77 offen offset:2048 sc1
    buffer_load_dwordx4 v[156:159], v4, s[4:7], s77 offen offset:3072 sc1
    s_add_u32 s77, s77, 4096
    s_waitcnt vmcnt(36)
    buffer_load_dwordx4 v[160:163], v4, s[4:7], s77 offen offset:0 sc1
    buffer_load_dwordx4 v[164:167], v4, s[4:7], s77 offen offset:1024 sc1
    buffer_load_dwordx4 v[168:171], v4, s[4:7], s77 offen offset:2048 sc1
    buffer_load_dwordx4 v[172:175], v4, s[4:7], s77 offen offset:3072 sc1
    s_add_u32 s77, s77, 4096
    buffer_load_dwordx4 v[176:179], v4, s[4:7], s77 offen offset:0 sc1
    buffer_load_dwordx4 v[180:183], v4, s[4:7], s77 offen offset:1024 sc1
    buffer_load_dwordx4 v[184:187], v4, s[4:7], s77 offen offset:2048 sc1
    buffer_load_dwordx4 v[188:191], v4, s[4:7], s77 offen offset:3072 sc1
    s_add_u32 s77, s77, 4096
    buffer_load_dwordx4 v[192:195], v4, s[4:7], s77 offen offset:0 sc1
    buffer_load_dwordx4 v[196:199], v4, s[4:7], s77 offen offset:1024 sc1
    buffer_load_dwordx4 v[200:203], v4, s[4:7], s77 offen offset:2048 sc1
    buffer_load_dwordx4 v[204:207], v4, s[4:7], s77 offen offset:3072 sc1
    s_add_u32 s77, s77, 4096
    buffer_load_dwordx4 v[208:211], v4, s[4:7], s77 offen offset:0 sc1
    buffer_load_dwordx4 v[212:215], v4, s[4:7], s77 offen offset:1024 sc1
    buffer_load_dwordx4 v[216:219], v4, s[4:7], s77 offen offset:2048 sc1
    buffer_load_dwordx4 v[220:223], v4, s[4:7], s77 offen offset:3072 sc1
    s_add_u32 s77, s77, 4096
L_out_z2:
    s_cmp_lg_u32 s92, 0
    s_cbranch_scc1 L_out_p1
Lwv_120:
    buffer_load_dword v6, v17, s[4:7], s81 offen sc1
    s_waitcnt vmcnt(0)
    v_cmp_ge_u32 vcc, s26, v6
    s_cbranch_vccz Lwvd_121
    s_sleep 2
    s_sub_u32 s27, s27, 1
    s_cbranch_scc1 L_exit
    s_branch Lwv_120
Lwvd_121:
    s_add_u32 s93, s75, 0
    s_add_u32 m0, s76, 81920
    s_nop 0
    buffer_load_dwordx4 v4, s[4:7], s93 offen offset:0 sc1 lds
    buffer_load_dwordx4 v4, s[4:7], s93 offen offset:1024 sc1 lds
    buffer_load_dwordx4 v4, s[4:7], s93 offen offset:2048 sc1 lds
    buffer_load_dwordx4 v4, s[4:7], s93 offen offset:3072 sc1 lds
    s_add_u32 m0, m0, 4096
    s_add_u32 s93, s93, 4096
    buffer_load_dwordx4 v4, s[4:7], s93 offen offset:0 sc1 lds
    buffer_load_dwordx4 v4, s[4:7], s93 offen offset:1024 sc1 lds
    buffer_load_dwordx4 v4, s[4:7], s93 offen offset:2048 sc1 lds
    buffer_load_dwordx4 v4, s[4:7], s93 offen offset:3072 sc1 lds
    s_add_u32 m0, m0, 4096
    s_add_u32 s93, s93, 4096
    buffer_load_dwordx4 v4, s[4:7], s93 offen offset:0 sc1 lds
    buffer_load_dwordx4 v4, s[4:7], s93 offen offset:1024 sc1 lds
    buffer_load_dwordx4 v4, s[4:7], s93 offen offset:2048 sc1 lds
    buffer_load_dwordx4 v4, s[4:7], s93 offen offset:3072 sc1 lds
    s_add_u32 m0, m0, 4096
    s_add_u32 s93, s93, 4096
    buffer_load_dwordx4 v4, s[4:7], s93 offen offset:0 sc1 lds
    buffer_load_dwordx4 v4, s[4:7], s93 offen offset:1024 sc1 lds
    buffer_load_dwordx4 v4, s[4:7], s93 offen offset:2048 sc1 lds
    buffer_load_dwordx4 v4, s[4:7], s93 offen offset:3072 sc1 lds
    s_add_u32 m0, m0, 4096
    s_add_u32 s93, s93, 4096
    buffer_load_dwordx4 v4, s[4:7], s93 offen offset:0 sc1 lds
    buffer_load_dwordx4 v4, s[4:7], s93 offen offset:1024 sc1 lds
    buffer_load_dwordx4 v4, s[4:7], s93 offen offset:2048 sc1 lds
    buffer_load_dwordx4 v4, s[4:7], s93 offen offset:3072 sc1 lds
    buffer_load_dwordx4 v[224:227], v4, s[4:7], s78 offen offset:0 sc1
    buffer_load_dwordx4 v[228:231], v4, s[4:7], s78 offen offset:1024 sc1
    buffer_load_dwordx4 v[232:235], v4, s[4:7], s78 offen offset:2048 sc1
    buffer_load_dwordx4 v[236:239], v4, s[4:7], s78 offen offset:3072 sc1
    s_add_u32 s78, s78, 4096
    buffer_load_dwordx4 v[240:243], v4, s[4:7], s78 offen offset:0 sc1
    buffer_load_dwordx4 v[244:247], v4, s[4:7], s78 offen offset:1024 sc1
    buffer_load_dwordx4 v[248:251], v4, s[4:7], s78 offen offset:2048 sc1
    buffer_load_dwordx4 v[252:255], v4, s[4:7], s78 offen offset:3072 sc1
L_out_p1:
    s_waitcnt vmcnt(56)
    buffer_load_dword v7, v18, s[4:7], s82 offen sc1
    s_cmp_lg_u32 s24, 0
    s_cbranch_scc1 Ltk_122
    v_mov_b32 v27, 1
    s_mov_b64 exec, 1
    buffer_atomic_add v27, v5, s[4:7], s90 offen sc0 sc1
    s_mov_b64 exec, -1
Ltk_122:
    s_waitcnt vmcnt(0)
    s_cmp_lg_u32 s24, 0
    s_cbranch_scc1 Ltk_123
    v_readfirstlane_b32 s28, v27
    s_nop 1
    v_mov_b32 v27, s28
    s_mov_b64 exec, 15
    ds_write_b32 v14, v27
    s_mov_b64 exec, -1
    s_waitcnt lgkmcnt(0)
Ltk_123:
    s_barrier
    ds_read_b32 v6, v15
    s_waitcnt lgkmcnt(0)
    v_readfirstlane_b32 s89, v6
    s_nop 1
    v_cmp_ge_u32 vcc, s89, v7
    s_mul_i32 s93, s89, 163840
    s_add_u32 s93, s93, s94
    s_add_u32 s93, s93, 40960
    s_cmp_eq_u64 vcc, 0
    s_cselect_b32 s91, 1, 0
    s_cselect_b32 s93, s93, s95
    ds_read_b128 v[48:51], v25 offset:0
    ds_read_b128 v[52:55], v26 offset:0
    ds_read_b128 v[56:59], v25 offset:1024
    ds_read_b128 v[60:63], v26 offset:1024
    ds_read_b128 v[64:67], v25 offset:2048
    ds_read_b128 v[68:71], v26 offset:2048
    s_waitcnt lgkmcnt(4)
    v_mfma_f32_16x16x32_bf16 v[40:43], v[96:99], v[48:51], 0
    ds_read_b128 v[72:75], v25 offset:3072
    s_add_u32 m0, s76, 0
    s_nop 0
    buffer_load_dwordx4 v4, s[4:7], s93 offen offset:0 sc1 lds
    v_mfma_f32_16x16x32_bf16 v[44:47], v[96:99], v[52:55], 0
    ds_read_b128 v[76:79], v26 offset:3072
    s_waitcnt lgkmcnt(4)
    v_mfma_f32_16x16x32_bf16 v[88:91], v[100:103], v[56:59], 0
    ds_read_b128 v[48:51], v25 offset:4096
    v_mfma_f32_16x16x32_bf16 v[92:95], v[100:103], v[60:63], 0
    ds_read_b128 v[52:55], v26 offset:4096
    s_waitcnt lgkmcnt(4)
    v_mfma_f32_16x16x32_bf16 v[40:43], v[104:107], v[64:67], v[40:43]
    ds_read_b128 v[56:59], v25 offset:5120
    buffer_load_dwordx4 v4, s[4:7], s93 offen offset:1024 sc1 lds
    v_mfma_f32_16x16x32_bf16 v[44:47], v[104:107], v[68:71], v[44:47]
    ds_read_b128 v[60:63], v26 offset:5120
    s_waitcnt lgkmcnt(4)
    v_mfma_f32_16x16x32_bf16 v[88:91], v[108:111], v[72:75], v[88:91]
    ds_read_b128 v[64:67], v25 offset:6144
    v_mfma_f32_16x16x32_bf16 v[92:95], v[108:111], v[76:79], v[92:95]
    ds_read_b128 v[68:71], v26 offset:6144
    s_waitcnt lgkmcnt(4)
    v_mfma_f32_16x16x32_bf16 v[40:43], v[112:115], v[48:51], v[40:43]
    ds_read_b128 v[72:75], v25 offset:7168
    buffer_load_dwordx4 v4, s[4:7], s93 offen offset:2048 sc1 lds
    v_mfma_f32_16x16x32_bf16 v[44:47], v[112:115], v[52:55], v[44:47]
    ds_read_b128 v[76:79], v26 offset:7168
    s_waitcnt lgkmcnt(4)
    v_mfma_f32_16x16x32_bf16 v[88:91], v[116:119], v[56:59], v[88:91]
    ds_read_b128 v[48:51], v25 offset:8192
    v_mfma_f32_16x16x32_bf16 v[92:95], v[116:119], v[60:63], v[92:95]
    ds_read_b128 v[52:55], v26 offset:8192
    s_waitcnt lgkmcnt(4)
    v_mfma_f32_16x16x32_bf16 v[40:43], v[120:123], v[64:67], v[40:43]
    ds_read_b128 v[56:59], v25 offset:9216
    buffer_load_dwordx4 v4, s[4:7], s93 offen offset:3072 sc1 lds
    v_mfma_f32_16x16x32_bf16 v[44:47], v[120:123], v[68:71], v[44:47]
    ds_read_b128 v[60:63], v26 offset:9216
    s_waitcnt lgkmcnt(4)
    v_mfma_f32_16x16x32_bf16 v[88:91], v[124:127], v[72:75], v[88:91]
    ds_read_b128 v[64:67], v25 offset:10240
    v_mfma_f32_16x16x32_bf16 v[92:95], v[124:127], v[76:79], v[92:95]
    ds_read_b128 v[68:71], v26 offset:10240
    s_waitcnt lgkmcnt(4)
    v_mfma_f32_16x16x32_bf16 v[40:43], v[128:131], v[48:51], v[40:43]
    ds_read_b128 v[72:75], v25 offset:11264
    s_add_u32 m0, m0, 4096
    s_add_u32 s93, s93, 4096
    buffer_load_dwordx4 v4, s[4:7], s93 offen offset:0 sc1 lds
    v_mfma_f32_16x16x32_bf16 v[44:47], v[128:131], v[52:55], v[44:47]
    ds_read_b128 v[76:79], v26 offset:11264
    s_waitcnt lgkmcnt(4)
    v_mfma_f32_16x16x32_bf16 v[88:91], v[132:135], v[56:59], v[88:91]
    ds_read_b128 v[48:51], v25 offset:12288
    v_mfma_f32_16x16x32_bf16 v[92:95], v[132:135], v[60:63], v[92:95]
    ds_read_b128 v[52:55], v26 offset:12288
    s_waitcnt lgkmcnt(4)
    v_mfma_f32_16x16x32_bf16 v[40:43], v[136:139], v[64:67], v[40:43]
    ds_read_b128 v[56:59], v25 offset:13312
    buffer_load_dwordx4 v4, s[4:7], s93 offen offset:1024 sc1 lds
    v_mfma_f32_16x16x32_bf16 v[44:47], v[136:139], v[68:71], v[44:47]
    ds_read_b128 v[60:63], v26 offset:13312
    s_waitcnt lgkmcnt(4)
    v_mfma_f32_16x16x32_bf16 v[88:91], v[140:143], v[72:75], v[88:91]
    ds_read_b128 v[64:67], v25 offset:14336
    v_mfma_f32_16x16x32_bf16 v[92:95], v[140:143], v[76:79], v[92:95]
    ds_read_b128 v[68:71], v26 offset:14336
    s_waitcnt lgkmcnt(4)
    v_mfma_f32_16x16x32_bf16 v[40:43], v[144:147], v[48:51], v[40:43]
    ds_read_b128 v[72:75], v25 offset:15360
    buffer_load_dwordx4 v4, s[4:7], s93 offen offset:2048 sc1 lds
    v_mfma_f32_16x16x32_bf16 v[44:47], v[144:147], v[52:55], v[44:47]
    ds_read_b128 v[76:79], v26 offset:15360
    s_waitcnt lgkmcnt(4)
    v_mfma_f32_16x16x32_bf16 v[88:91], v[148:151], v[56:59], v[88:91]
    ds_read_b128 v[48:51], v25 offset:16384
    v_mfma_f32_16x16x32_bf16 v[92:95], v[148:151], v[60:63], v[92:95]
    ds_read_b128 v[52:55], v26 offset:16384
    s_waitcnt lgkmcnt(4)
    v_mfma_f32_16x16x32_bf16 v[40:43], v[152:155], v[64:67], v[40:43]
    ds_read_b128 v[56:59], v25 offset:17408
    buffer_load_dwordx4 v4, s[4:7], s93 offen offset:3072 sc1 lds
    v_mfma_f32_16x16x32_bf16 v[44:47], v[152:155], v[68:71], v[44:47]
    ds_read_b128 v[60:63], v26 offset:17408
    s_waitcnt lgkmcnt(4)
    v_mfma_f32_16x16x32_bf16 v[88:91], v[156:159], v[72:75], v[88:91]
    ds_read_b128 v[64:67], v25 offset:18432
    v_mfma_f32_16x16x32_bf16 v[92:95], v[156:159], v[76:79], v[92:95]
    ds_read_b128 v[68:71], v26 offset:18432
    s_waitcnt lgkmcnt(4)
    v_mfma_f32_16x16x32_bf16 v[40:43], v[160:163], v[48:51], v[40:43]
    ds_read_b128 v[72:75], v25 offset:19456
    s_add_u32 m0, m0, 4096
    s_add_u32 s93, s93, 4096
    buffer_load_dwordx4 v4, s[4:7], s93 offen offset:0 sc1 lds
    v_mfma_f32_16x16x32_bf16 v[44:47], v[160:163], v[52:55], v[44:47]
    ds_read_b128 v[76:79], v26 offset:19456
    s_waitcnt lgkmcnt(4)
    v_mfma_f32_16x16x32_bf16 v[88:91], v[164:167], v[56:59], v[88:91]
    ds_read_b128 v[48:51], v25 offset:20480
    v_mfma_f32_16x16x32_bf16 v[92:95], v[164:167], v[60:63], v[92:95]
    ds_read_b128 v[52:55], v26 offset:20480
    s_waitcnt lgkmcnt(4)
    v_mfma_f32_16x16x32_bf16 v[40:43], v[168:171], v[64:67], v[40:43]
    ds_read_b128 v[56:59], v25 offset:21504
    buffer_load_dwordx4 v4, s[4:7], s93 offen offset:1024 sc1 lds
    v_mfma_f32_16x16x32_bf16 v[44:47], v[168:171], v[68:71], v[44:47]
    ds_read_b128 v[60:63], v26 offset:21504
    s_waitcnt lgkmcnt(4)
    v_mfma_f32_16x16x32_bf16 v[88:91], v[172:175], v[72:75], v[88:91]
    ds_read_b128 v[64:67], v25 offset:22528
    v_mfma_f32_16x16x32_bf16 v[92:95], v[172:175], v[76:79], v[92:95]
    ds_read_b128 v[68:71], v26 offset:22528
    s_waitcnt lgkmcnt(4)
    v_mfma_f32_16x16x32_bf16 v[40:43], v[176:179], v[48:51], v[40:43]
    ds_read_b128 v[72:75], v25 offset:23552
    buffer_load_dwordx4 v4, s[4:7], s93 offen offset:2048 sc1 lds
    v_mfma_f32_16x16x32_bf16 v[44:47], v[176:179], v[52:55], v[44:47]
    ds_read_b128 v[76:79], v26 offset:23552
    s_waitcnt lgkmcnt(4)
    v_mfma_f32_16x16x32_bf16 v[88:91], v[180:183], v[56:59], v[88:91]
    ds_read_b128 v[48:51], v25 offset:24576
    v_mfma_f32_16x16x32_bf16 v[92:95], v[180:183], v[60:63], v[92:95]
    ds_read_b128 v[52:55], v26 offset:24576
    s_waitcnt lgkmcnt(4)
    v_mfma_f32_16x16x32_bf16 v[40:43], v[184:187], v[64:67], v[40:43]
    ds_read_b128 v[56:59], v25 offset:25600
    buffer_load_dwordx4 v4, s[4:7], s93 offen offset:3072 sc1 lds
    v_mfma_f32_16x16x32_bf16 v[44:47], v[184:187], v[68:71], v[44:47]
    ds_read_b128 v[60:63], v26 offset:25600
    s_waitcnt lgkmcnt(4)
    v_mfma_f32_16x16x32_bf16 v[88:91], v[188:191], v[72:75], v[88:91]
    ds_read_b128 v[64:67], v25 offset:26624
    v_mfma_f32_16x16x32_bf16 v[92:95], v[188:191], v[76:79], v[92:95]
    ds_read_b128 v[68:71], v26 offset:26624
    s_waitcnt lgkmcnt(4)
    v_mfma_f32_16x16x32_bf16 v[40:43], v[192:195], v[48:51], v[40:43]
    ds_read_b128 v[72:75], v25 offset:27648
    s_add_u32 m0, m0, 4096
    s_add_u32 s93, s93, 4096
    buffer_load_dwordx4 v4, s[4:7], s93 offen offset:0 sc1 lds
    v_mfma_f32_16x16x32_bf16 v[44:47], v[192:195], v[52:55], v[44:47]
    ds_read_b128 v[76:79], v26 offset:27648
    s_waitcnt lgkmcnt(4)
    v_mfma_f32_16x16x32_bf16 v[88:91], v[196:199], v[56:59], v[88:91]
    ds_read_b128 v[48:51], v25 offset:28672
    v_mfma_f32_16x16x32_bf16 v[92:95], v[196:199], v[60:63], v[92:95]
    ds_read_b128 v[52:55], v26 offset:28672
    s_waitcnt lgkmcnt(4)
    v_mfma_f32_16x16x32_bf16 v[40:43], v[200:203], v[64:67], v[40:43]
    ds_read_b128 v[56:59], v25 offset:29696
    buffer_load_dwordx4 v4, s[4:7], s93 offen offset:1024 sc1 lds
    v_mfma_f32_16x16x32_bf16 v[44:47], v[200:203], v[68:71], v[44:47]
    ds_read_b128 v[60:63], v26 offset:29696
    s_waitcnt lgkmcnt(4)
    v_mfma_f32_16x16x32_bf16 v[88:91], v[204:207], v[72:75], v[88:91]
    ds_read_b128 v[64:67], v25 offset:30720
    v_mfma_f32_16x16x32_bf16 v[92:95], v[204:207], v[76:79], v[92:95]
    ds_read_b128 v[68:71], v26 offset:30720
    s_waitcnt lgkmcnt(4)
    v_mfma_f32_16x16x32_bf16 v[40:43], v[208:211], v[48:51], v[40:43]
    ds_read_b128 v[72:75], v25 offset:31744
    buffer_load_dwordx4 v4, s[4:7], s93 offen offset:2048 sc1 lds
    v_mfma_f32_16x16x32_bf16 v[44:47], v[208:211], v[52:55], v[44:47]
    ds_read_b128 v[76:79], v26 offset:31744
    s_waitcnt lgkmcnt(4)
    v_mfma_f32_16x16x32_bf16 v[88:91], v[212:215], v[56:59], v[88:91]
    ds_read_b128 v[48:51], v25 offset:32768
    v_mfma_f32_16x16x32_bf16 v[92:95], v[212:215], v[60:63], v[92:95]
    ds_read_b128 v[52:55], v26 offset:32768
    s_waitcnt lgkmcnt(4)
    v_mfma_f32_16x16x32_bf16 v[40:43], v[216:219], v[64:67], v[40:43]
    ds_read_b128 v[56:59], v25 offset:33792
    buffer_load_dwordx4 v4, s[4:7], s93 offen offset:3072 sc1 lds
    v_mfma_f32_16x16x32_bf16 v[44:47], v[216:219], v[68:71], v[44:47]
    ds_read_b128 v[60:63], v26 offset:33792
    s_waitcnt lgkmcnt(4)
    v_mfma_f32_16x16x32_bf16 v[88:91], v[220:223], v[72:75], v[88:91]
    ds_read_b128 v[64:67], v25 offset:34816
    v_mfma_f32_16x16x32_bf16 v[92:95], v[220:223], v[76:79], v[92:95]
    ds_read_b128 v[68:71], v26 offset:34816
    s_waitcnt lgkmcnt(4)
    v_mfma_f32_16x16x32_bf16 v[40:43], v[224:227], v[48:51], v[40:43]
    ds_read_b128 v[72:75], v25 offset:35840
    s_add_u32 m0, m0, 4096
    s_add_u32 s93, s93, 4096
    buffer_load_dwordx4 v4, s[4:7], s93 offen offset:0 sc1 lds
    v_mfma_f32_16x16x32_bf16 v[44:47], v[224:227], v[52:55], v[44:47]
    ds_read_b128 v[76:79], v26 offset:35840
    s_waitcnt lgkmcnt(4)
    v_mfma_f32_16x16x32_bf16 v[88:91], v[228:231], v[56:59], v[88:91]
    ds_read_b128 v[48:51], v25 offset:36864
    v_mfma_f32_16x16x32_bf16 v[92:95], v[228:231], v[60:63], v[92:95]
    ds_read_b128 v[52:55], v26 offset:36864
    s_waitcnt lgkmcnt(4)
    v_mfma_f32_16x16x32_bf16 v[40:43], v[232:235], v[64:67], v[40:43]
    ds_read_b128 v[56:59], v25 offset:37888
    buffer_load_dwordx4 v4, s[4:7], s93 offen offset:1024 sc1 lds
    v_mfma_f32_16x16x32_bf16 v[44:47], v[232:235], v[68:71], v[44:47]
    ds_read_b128 v[60:63], v26 offset:37888
    s_waitcnt lgkmcnt(4)
    v_mfma_f32_16x16x32_bf16 v[88:91], v[236:239], v[72:75], v[88:91]
    ds_read_b128 v[64:67], v25 offset:38912
    v_mfma_f32_16x16x32_bf16 v[92:95], v[236:239], v[76:79], v[92:95]
    ds_read_b128 v[68:71], v26 offset:38912
    s_waitcnt lgkmcnt(4)
    v_mfma_f32_16x16x32_bf16 v[40:43], v[240:243], v[48:51], v[40:43]
    ds_read_b128 v[72:75], v25 offset:39936
    buffer_load_dwordx4 v4, s[4:7], s93 offen offset:2048 sc1 lds
    v_mfma_f32_16x16x32_bf16 v[44:47], v[240:243], v[52:55], v[44:47]
    ds_read_b128 v[76:79], v26 offset:39936
    s_waitcnt lgkmcnt(4)
    v_mfma_f32_16x16x32_bf16 v[88:91], v[244:247], v[56:59], v[88:91]
    v_mfma_f32_16x16x32_bf16 v[92:95], v[244:247], v[60:63], v[92:95]
    s_waitcnt lgkmcnt(2)
    v_mfma_f32_16x16x32_bf16 v[40:43], v[248:251], v[64:67], v[40:43]
    buffer_load_dwordx4 v4, s[4:7], s93 offen offset:3072 sc1 lds
    v_mfma_f32_16x16x32_bf16 v[44:47], v[248:251], v[68:71], v[44:47]
    s_waitcnt lgkmcnt(0)
    v_mfma_f32_16x16x32_bf16 v[88:91], v[252:255], v[72:75], v[88:91]
    v_mfma_f32_16x16x32_bf16 v[92:95], v[252:255], v[76:79], v[92:95]
    s_nop 4
    v_add_f32 v40, v40, v88
    v_add_f32 v41, v41, v89
    v_add_f32 v42, v42, v90
    v_add_f32 v43, v43, v91
    v_add_f32 v44, v44, v92
    v_add_f32 v45, v45, v93
    v_add_f32 v46, v46, v94
    v_add_f32 v47, v47, v95
    v_cvt_pk_bf16_f32 v86, v40, v41
    v_lshlrev_b32 v40, 16, v86
    v_and_b32 v41, 0xffff0000, v86
    v_cvt_pk_bf16_f32 v86, v42, v43
    v_lshlrev_b32 v42, 16, v86
    v_and_b32 v43, 0xffff0000, v86
    v_mul_f32 v40, v40, v84
    v_mul_f32 v41, v41, v84
    v_mul_f32 v42, v42, v84
    v_mul_f32 v43, v43, v84
    v_cvt_pk_bf16_f32 v86, v40, v41
    v_lshlrev_b32 v40, 16, v86
    v_and_b32 v41, 0xffff0000, v86
    v_cvt_pk_bf16_f32 v86, v42, v43
    v_lshlrev_b32 v42, 16, v86
    v_and_b32 v43, 0xffff0000, v86
    v_add_f32 v40, v40, v32
    v_add_f32 v41, v41, v33
    v_add_f32 v42, v42, v34
    v_add_f32 v43, v43, v35
    buffer_store_dwordx4 v[40:43], v22, s[84:87], s80 offen
    v_cvt_pk_bf16_f32 v86, v44, v45
    v_lshlrev_b32 v44, 16, v86
    v_and_b32 v45, 0xffff0000, v86
    v_cvt_pk_bf16_f32 v86, v46, v47
    v_lshlrev_b32 v46, 16, v86
    v_and_b32 v47, 0xffff0000, v86
    v_mul_f32 v44, v44, v85
    v_mul_f32 v45, v45, v85
    v_mul_f32 v46, v46, v85
    v_mul_f32 v47, v47, v85
    v_cvt_pk_bf16_f32 v86, v44, v45
    v_lshlrev_b32 v44, 16, v86
    v_and_b32 v45, 0xffff0000, v86
    v_cvt_pk_bf16_f32 v86, v46, v47
    v_lshlrev_b32 v46, 16, v86
    v_and_b32 v47, 0xffff0000, v86
    v_add_f32 v44, v44, v36
    v_add_f32 v45, v45, v37
    v_add_f32 v46, v46, v38
    v_add_f32 v47, v47, v39
    s_add_u32 s80, s80, 40960
    buffer_store_dwordx4 v[44:47], v22, s[84:87], s80 offen
    s_mov_b32 s26, s89
    s_cmp_lt_u32 s26, 64
    s_cbranch_scc1 L_out_top
    s_endpgm
L_exit:
    s_endpgm
L_redo:
    s_mov_b32 s3, s28
    s_waitcnt vmcnt(0)
    s_barrier
    s_branch L_slot
.p2align 6
.type L_tab,@object
L_tab:
.long 0xff0000, 0x1, 0x1c0201, 0x360401, 0x500306, 0x640206, 0x780106, 0x8c0006
.long 0xff0100, 0x10101, 0x1d0301, 0x370501, 0x510706, 0x650606, 0x790506, 0x8d0406
.long 0xff0200, 0x20601, 0x1e0801, 0x380a01, 0x520b06, 0x660a06, 0x7a0906, 0x8e0806
.long 0xff0300, 0x30701, 0x1f0901, 0x390b01, 0x530f06, 0x670e06, 0x7b0d06, 0x8f0c06
.long 0xff0400, 0x40c01, 0x200e01, 0x3a1001, 0x541306, 0x681206, 0x7c1106, 0x901006
.long 0xff0500, 0x50d01, 0x210f01, 0x3b1101, 0x551706, 0x691606, 0x7d1506, 0x911406
.long 0xff0600, 0x61201, 0x221401, 0x3c1601, 0x561b06, 0x6a1a06, 0x7e1906, 0x921806
.long 0xff0700, 0x71301, 0x231501, 0x3d1701, 0x571f06, 0x6b1e06, 0x7f1d06, 0x931c06
.long 0xff0800, 0x81801, 0x241a01, 0x3e1c01, 0xa60607, 0xa50507, 0xa40407, 0xa30307
.long 0xff0900, 0x91901, 0x251b01, 0x3f1d01, 0xaa0a07, 0xa90907, 0xa80807, 0xa70707
.long 0xff0a00, 0xa1e01, 0x262001, 0x402201, 0xae0e07, 0xad0d07, 0xac0c07, 0xab0b07
.long 0xff0b00, 0xb1f01, 0x272101, 0x412301, 0xb21207, 0xb11107, 0xb01007, 0xaf0f07
.long 0xff0c00, 0xc2401, 0x282601, 0x422801, 0xb61607, 0xb51507, 0xb41407, 0xb31307
.long 0xff0d00, 0xd2501, 0x292701, 0x432901, 0xba1a07, 0xb91907, 0xb81807, 0xb71707
.long 0xff0e00, 0xe2a01, 0x2a2c01, 0x442e01, 0xbe1e07, 0xbd1d07, 0xbc1c07, 0xbb1b07
.long 0xff0f00, 0xf2b01, 0x2b2d01, 0x452f01, 0xff0f02, 0xff0e02, 0xff0d02, 0xbf1f07
.long 0xff1000, 0x103001, 0x2c3201, 0x463401, 0xff1302, 0xff1202, 0xff1102, 0xff1002
.long 0xff1100, 0x113101, 0x2d3301, 0x473501, 0xff1702, 0xff1602, 0xff1502, 0xff1402
.long 0xff1200, 0x123601, 0x2e3801, 0x483a01, 0xff1b02, 0xff1a02, 0xff1902, 0xff1802
.long 0xff1300, 0x133701, 0x2f3901, 0x493b01, 0xff1f02, 0xff1e02, 0xff1d02, 0xff1c02
.long 0xff1400, 0x143c01, 0x303e01, 0x4a4001, 0x580303, 0x6c0203, 0x800103, 0x940003
.long 0xff1500, 0x153d01, 0x313f01, 0x4b4101, 0x590703, 0x6d0603, 0x810503, 0x950403
.long 0xff1600, 0x164201, 0x324401, 0x4c4601, 0x5a0b03, 0x6e0a03, 0x820903, 0x960803
.long 0xff1700, 0x174301, 0x334501, 0x4d4701, 0x5b0f03, 0x6f0e03, 0x830d03, 0x970c03
.long 0xff1800, 0x184801, 0x344a01, 0x4e4c01, 0x5c1303, 0x701203, 0x841103, 0x981003
.long 0xff1900, 0x194901, 0x354b01, 0x4f4d01, 0x5d1703, 0x711603, 0x851503, 0x991403
.long 0xff1a00, 0x1a4e01, 0xff0102, 0xff0702, 0x5e1b03, 0x721a03, 0x861903, 0x9a1803
.long 0xff1b00, 0x1b4f01, 0xff0202, 0xff0802, 0x5f1f03, 0x731e03, 0x871d03, 0x9b1c03
.long 0xff1c00, 0xa00007, 0xff0302, 0xff0902, 0x600304, 0x740204, 0x880104, 0x9c0004
.long 0xff1d00, 0xa10107, 0xff0402, 0xff0a02, 0x610704, 0x750604, 0x890504, 0x9d0404
.long 0xff1e00, 0xa20207, 0xff0502, 0xff0b02, 0x620105, 0x760005, 0x8a0904, 0x9e0804
.long 0xff1f00, 0xff0002, 0xff0602, 0xff0c02, 0x630505, 0x770405, 0x8b0305, 0x9f0205
.section .rodata,"a"
.p2align 6
.amdhsa_kernel gated_mix__memory_aug_recurrent_mem_tr__ssm_conv_s5__prompt_kernel
  .amdhsa_next_free_vgpr 512
  .amdhsa_next_free_sgpr 102
  .amdhsa_accum_offset 256
  .amdhsa_group_segment_fixed_size 0
  .amdhsa_kernarg_size 160
  .amdhsa_user_sgpr_count 2
  .amdhsa_user_sgpr_kernarg_segment_ptr 1
  .amdhsa_system_sgpr_workgroup_id_x 1
  .amdhsa_float_denorm_mode_32 3
.end_amdhsa_kernel
```
